```python
import torch

def _softmax(x, axis=-1):
    return torch.softmax(x, dim=axis)

def _gelu(x):
    return torch.nn.functional.gelu(x, approximate='tanh')

def _silu(x):
    return torch.nn.functional.silu(x)

def _sigmoid(x):
    return torch.sigmoid(x)

def _layernorm(x, axis=-1, eps=1e-05):
    m = x.mean(dim=axis, keepdim=True)
    v = x.var(dim=axis, keepdim=True, unbiased=False)
    return (x - m) / torch.sqrt(v + eps)

def _scatter_add(tgt, idx, src, axis=0):
    return tgt.clone().index_add_(axis, idx, src)

def _segment_sum(src, seg, n):
    out = torch.zeros((n,) + src.shape[1:], dtype=src.dtype)
    return out.index_add_(0, seg, src)

def _pad(x, pw):
    flat = tuple((v for pair in reversed(pw) for v in pair))
    return torch.nn.functional.pad(x, flat)
kernel_name = 'gated_mix__sliding_local_dilated__mixer_gmlp__prompt'

def setup_inputs():

    _w = lambda a: (lambda t: t.to(torch.bfloat16) if t.is_floating_point() else t)(torch.as_tensor(a))

    def _A_setup():
        B, S, D = (1, 2048, 640)
        return {'x': _w((lambda *s: torch.randn(*s, dtype=torch.bfloat16) * 0.05)(B, S, D)), 'wqkv': _w((lambda *s: torch.randn(*s, dtype=torch.bfloat16) * 0.8)(D, 3 * D)), 'wo': _w((lambda *s: torch.randn(*s, dtype=torch.bfloat16) * 0.05)(D, D))}
    _A_in = _A_setup()

    def _B_setup():
        B, S, D, F = (1, 2048, 640, 1536)
        Fh = F // 2
        return {'x': _w((lambda *s: torch.randn(*s, dtype=torch.bfloat16) * 0.05)(B, S, D)), 'w_in': _w((lambda *s: torch.randn(*s, dtype=torch.bfloat16) * 0.8)(D, 2 * Fh)), 'w_sp': _w(0.01 * (lambda *s: torch.randn(*s, dtype=torch.bfloat16) * 0.8)(S, S)), 'b_sp': _w(1.0 + 0.01 * (lambda *s: torch.randn(*s, dtype=torch.bfloat16) * 0.05)(S)), 'w_out': _w((lambda *s: torch.randn(*s, dtype=torch.bfloat16) * 0.05)(Fh, D))}
    _B_in = _B_setup()
    return {'A_x': _A_in['x'], 'A_wqkv': _A_in['wqkv'], 'A_wo': _A_in['wo'], 'B_x': _B_in['x'], 'B_w_in': _B_in['w_in'], 'B_w_sp': _B_in['w_sp'], 'B_b_sp': _B_in['b_sp'], 'B_w_out': _B_in['w_out'], 'gate_w': _w((lambda *s: torch.randn(*s, dtype=torch.bfloat16) * 0.05)(640) * 16.0)}

def reference(A_x, A_wqkv, A_wo, B_x, B_w_in, B_w_sp, B_b_sp, B_w_out, gate_w):

    def _A_ref(x, wqkv, wo):
        B, S, D = x.shape
        H = 32
        Dh = D // H
        W, dil = (8, 2)
        qkv = (lambda x, *d: x.permute(*d))((x @ wqkv).reshape(B, S, 3, H, Dh), 2, 0, 3, 1, 4)
        q, k, v = (qkv[0], qkv[1], qkv[2])
        scale = Dh ** (-0.5)
        pos = torch.arange(S)
        off = torch.arange(W) * dil
        idx = pos[:, None] - off[None, :]
        mask = idx >= 0
        idx_c = torch.where(mask, idx, 0).reshape(-1)
        kg = k[:, :, idx_c, :].reshape(B, H, S, W, Dh)
        vg = v[:, :, idx_c, :].reshape(B, H, S, W, Dh)
        logits = torch.einsum('bhsd,bhswd->bhsw', q, kg) * scale
        logits = torch.where(mask[None, None, :, :], logits, -1000000000.0)
        attn = _softmax(logits, axis=-1)
        o = torch.einsum('bhsw,bhswd->bhsd', attn, vg)
        return (lambda x, *d: x.permute(*d))(o, 0, 2, 1, 3).reshape(B, S, D) @ wo

    def _B_ref(x, w_in, w_sp, b_sp, w_out):
        B, S, D = x.shape
        F = w_in.shape[-1]
        Fh = F // 2
        z = _gelu(torch.einsum('bsd,df->bsf', x, w_in))
        z1 = z[..., :Fh].clone()
        z2 = _layernorm(z[..., Fh:], axis=-1)
        g = torch.einsum('ts,bsf->btf', w_sp, z2) + b_sp[None, :, None]
        return torch.einsum('bsf,fd->bsd', z1 * g, w_out)
    x = A_x
    g = _sigmoid((x * gate_w).sum(-1, keepdims=True))
    a = _A_ref(x, A_wqkv, A_wo)
    b = _B_ref(x, B_w_in, B_w_sp, B_b_sp, B_w_out)
    return g * a + (1 - g) * b
```

```asm
; @launch grid=(256,1,1) block=(512,1,1) lds=155712
.amdgcn_target "amdgcn-amd-amdhsa--gfx950"
.text
.p2align 8
.globl gated_mix__sliding_local_dilated__mixer_gmlp__prompt_kernel
.type gated_mix__sliding_local_dilated__mixer_gmlp__prompt_kernel,@function
gated_mix__sliding_local_dilated__mixer_gmlp__prompt_kernel:
    s_cmp_ge_u32 s2, 256
    s_cbranch_scc1 K34_end
    s_load_dwordx2 s[30:31], s[0:1], 0
    s_load_dwordx2 s[32:33], s[0:1], 88
    s_load_dwordx2 s[34:35], s[0:1], 8
    s_load_dwordx2 s[36:37], s[0:1], 32
    s_load_dwordx2 s[38:39], s[0:1], 64
    s_load_dwordx2 s[44:45], s[0:1], 16
    s_load_dwordx2 s[46:47], s[0:1], 56
    s_load_dwordx2 s[52:53], s[0:1], 40
    s_load_dwordx2 s[50:51], s[0:1], 80
    v_lshrrev_b32 v1, 6, v0
    s_nop 0
    v_readfirstlane_b32 s16, v1
    v_and_b32 v0, 63, v0
    s_waitcnt lgkmcnt(0)
    s_add_u32 s96, s32, 24510464
    s_addc_u32 s97, s33, 0
    s_load_dwordx2 s[98:99], s[96:97], 0
    s_and_b32 s40, s2, 7
    s_lshr_b32 s41, s2, 3
    s_and_b32 s48, s40, 1
    s_lshl_b32 s48, s48, 3
    s_and_b32 s42, s41, 7
    s_add_u32 s48, s48, s42
    s_lshr_b32 s49, s40, 1
    s_lshl_b32 s49, s49, 1
    s_lshr_b32 s43, s41, 3
    s_and_b32 s43, s43, 1
    s_add_u32 s49, s49, s43
    s_lshl_b32 s28, s43, 1
    s_add_u32 s28, s28, s42
    s_and_b32 s28, s28, 3
    s_lshl_b32 s28, s28, 2
    s_lshr_b32 s28, 34096, s28
    s_and_b32 s28, s28, 15
    s_cmp_lt_u32 s41, 16
    s_cbranch_scc1 K1_ztype
    s_cmp_lt_u32 s16, 4
    s_cbranch_scc1 K1_qcomp
    s_mov_b32 s4, s30
    s_mov_b32 s5, s31
    s_mov_b32 s6, 2621440
    s_mov_b32 s7, 0x20000
    s_mov_b32 s8, s34
    s_mov_b32 s9, s35
    s_mov_b32 s10, 2457600
    s_mov_b32 s11, 0x20000
    s_cmp_eq_u32 s16, 7
    s_cbranch_scc1 K1_qload3
    s_sub_u32 s21, s16, 4
    v_lshrrev_b32 v7, 3, v0
    v_and_b32 v6, 7, v0
    v_xor_b32 v6, v6, v7
    s_lshl_b32 s20, s48, 7
    s_sub_u32 s20, s20, 16
    s_lshl_b32 s22, s21, 4
    s_add_u32 s20, s20, s22
    v_add_u32 v7, s20, v7
    v_mov_b32 v12, v7
    s_mov_b32 s20, 1280
    v_mul_lo_u32 v7, v7, s20
    v_lshl_add_u32 v2, v6, 4, v7
    v_add_u32 v3, 10240, v2
    v_add_u32 v5, 92160, v2
    v_add_u32 v6, 102400, v2
    v_mov_b32 v13, 1073741824
    v_add_u32 v14, 0, v12
    v_cmp_gt_i32 vcc, 0, v14
    s_nop 1
    v_cndmask_b32 v2, v2, v13, vcc
    v_add_u32 v14, 8, v12
    v_cmp_gt_i32 vcc, 0, v14
    s_nop 1
    v_cndmask_b32 v3, v3, v13, vcc
    s_mul_i32 s24, s49, 160
    s_lshl_b32 s23, s21, 11
    s_lshl_b32 s26, s21, 12
    s_add_u32 s26, s26, 55296
    s_add_u32 s27, s28, 0
    s_cmp_ge_u32 s27, 10
    s_cselect_b32 s29, 10, 0
    s_sub_u32 s27, s27, s29
    s_lshl_b32 s27, s27, 7
    s_add_u32 m0, s23, 0
    s_nop 0
    buffer_load_dwordx4 v2, s[4:7], s27 offen lds
    s_add_u32 m0, m0, 1024
    s_nop 0
    buffer_load_dwordx4 v3, s[4:7], s27 offen lds
    s_add_u32 s27, s28, 0
    s_cmp_ge_u32 s27, 10
    s_cselect_b32 s29, 10, 0
    s_sub_u32 s27, s27, s29
    s_lshl_b32 s27, s27, 7
    s_add_u32 m0, s23, 9216
    s_nop 0
    buffer_load_dwordx4 v5, s[4:7], s27 offen lds
    s_add_u32 m0, m0, 1024
    s_nop 0
    buffer_load_dwordx4 v6, s[4:7], s27 offen lds
    s_lshl_b32 s20, s21, 8
    v_add_u32 v12, s20, v0
    v_add_u32 v12, 0, v12
    v_mul_u32_u24 v13, 2185, v12
    v_lshrrev_b32 v13, 16, v13
    v_mul_u32_u24 v14, 30, v13
    v_sub_u32 v14, v12, v14
    v_and_b32 v15, 0x13, v13
    v_and_b32 v16, 4, v13
    v_lshl_or_b32 v15, v16, 1, v15
    v_and_b32 v16, 8, v13
    v_lshrrev_b32 v16, 1, v16
    v_or_b32 v15, v15, v16
    v_mul_u32_u24 v16, 205, v14
    v_lshrrev_b32 v16, 11, v16
    v_mul_u32_u24 v17, 10, v16
    v_sub_u32 v14, v14, v17
    v_mul_u32_u24 v15, 3840, v15
    v_mul_u32_u24 v16, 1280, v16
    v_lshlrev_b32 v14, 4, v14
    v_add3_u32 v8, v15, v16, v14
    v_add_u32 v12, s20, v0
    v_add_u32 v12, 64, v12
    v_mul_u32_u24 v13, 2185, v12
    v_lshrrev_b32 v13, 16, v13
    v_mul_u32_u24 v14, 30, v13
    v_sub_u32 v14, v12, v14
    v_and_b32 v15, 0x13, v13
    v_and_b32 v16, 4, v13
    v_lshl_or_b32 v15, v16, 1, v15
    v_and_b32 v16, 8, v13
    v_lshrrev_b32 v16, 1, v16
    v_or_b32 v15, v15, v16
    v_mul_u32_u24 v16, 205, v14
    v_lshrrev_b32 v16, 11, v16
    v_mul_u32_u24 v17, 10, v16
    v_sub_u32 v14, v14, v17
    v_mul_u32_u24 v15, 3840, v15
    v_mul_u32_u24 v16, 1280, v16
    v_lshlrev_b32 v14, 4, v14
    v_add3_u32 v9, v15, v16, v14
    v_add_u32 v12, s20, v0
    v_add_u32 v12, 128, v12
    v_mul_u32_u24 v13, 2185, v12
    v_lshrrev_b32 v13, 16, v13
    v_mul_u32_u24 v14, 30, v13
    v_sub_u32 v14, v12, v14
    v_and_b32 v15, 0x13, v13
    v_and_b32 v16, 4, v13
    v_lshl_or_b32 v15, v16, 1, v15
    v_and_b32 v16, 8, v13
    v_lshrrev_b32 v16, 1, v16
    v_or_b32 v15, v15, v16
    v_mul_u32_u24 v16, 205, v14
    v_lshrrev_b32 v16, 11, v16
    v_mul_u32_u24 v17, 10, v16
    v_sub_u32 v14, v14, v17
    v_mul_u32_u24 v15, 3840, v15
    v_mul_u32_u24 v16, 1280, v16
    v_lshlrev_b32 v14, 4, v14
    v_add3_u32 v10, v15, v16, v14
    v_add_u32 v12, s20, v0
    v_add_u32 v12, 192, v12
    v_mul_u32_u24 v13, 2185, v12
    v_lshrrev_b32 v13, 16, v13
    v_mul_u32_u24 v14, 30, v13
    v_sub_u32 v14, v12, v14
    v_and_b32 v15, 0x13, v13
    v_and_b32 v16, 4, v13
    v_lshl_or_b32 v15, v16, 1, v15
    v_and_b32 v16, 8, v13
    v_lshrrev_b32 v16, 1, v16
    v_or_b32 v15, v15, v16
    v_mul_u32_u24 v16, 205, v14
    v_lshrrev_b32 v16, 11, v16
    v_mul_u32_u24 v17, 10, v16
    v_sub_u32 v14, v14, v17
    v_mul_u32_u24 v15, 3840, v15
    v_mul_u32_u24 v16, 1280, v16
    v_lshlrev_b32 v14, 4, v14
    v_add3_u32 v11, v15, v16, v14
    s_lshl_b32 s27, s28, 1
    s_add_u32 s27, s27, 0
    s_cmp_ge_u32 s27, 20
    s_cselect_b32 s29, 20, 0
    s_sub_u32 s27, s27, s29
    s_mul_i32 s27, s27, 122880
    s_add_u32 s27, s27, s24
    s_add_u32 m0, s26, 0
    s_nop 0
    buffer_load_dwordx4 v8, s[8:11], s27 offen lds
    s_add_u32 m0, m0, 1024
    s_nop 0
    buffer_load_dwordx4 v9, s[8:11], s27 offen lds
    s_add_u32 m0, m0, 1024
    s_nop 0
    buffer_load_dwordx4 v10, s[8:11], s27 offen lds
    s_add_u32 m0, m0, 1024
    s_nop 0
    buffer_load_dwordx4 v11, s[8:11], s27 offen lds
    s_lshl_b32 s27, s28, 1
    s_add_u32 s27, s27, 1
    s_cmp_ge_u32 s27, 20
    s_cselect_b32 s29, 20, 0
    s_sub_u32 s27, s27, s29
    s_mul_i32 s27, s27, 122880
    s_add_u32 s27, s27, s24
    s_add_u32 m0, s26, 15360
    s_nop 0
    buffer_load_dwordx4 v8, s[8:11], s27 offen lds
    s_add_u32 m0, m0, 1024
    s_nop 0
    buffer_load_dwordx4 v9, s[8:11], s27 offen lds
    s_add_u32 m0, m0, 1024
    s_nop 0
    buffer_load_dwordx4 v10, s[8:11], s27 offen lds
    s_add_u32 m0, m0, 1024
    s_nop 0
    buffer_load_dwordx4 v11, s[8:11], s27 offen lds
    s_add_u32 s27, s28, 1
    s_cmp_ge_u32 s27, 10
    s_cselect_b32 s29, 10, 0
    s_sub_u32 s27, s27, s29
    s_lshl_b32 s27, s27, 7
    s_add_u32 m0, s23, 18432
    s_nop 0
    buffer_load_dwordx4 v2, s[4:7], s27 offen lds
    s_add_u32 m0, m0, 1024
    s_nop 0
    buffer_load_dwordx4 v3, s[4:7], s27 offen lds
    s_add_u32 s27, s28, 1
    s_cmp_ge_u32 s27, 10
    s_cselect_b32 s29, 10, 0
    s_sub_u32 s27, s27, s29
    s_lshl_b32 s27, s27, 7
    s_add_u32 m0, s23, 27648
    s_nop 0
    buffer_load_dwordx4 v5, s[4:7], s27 offen lds
    s_add_u32 m0, m0, 1024
    s_nop 0
    buffer_load_dwordx4 v6, s[4:7], s27 offen lds
    s_lshl_b32 s27, s28, 1
    s_add_u32 s27, s27, 2
    s_cmp_ge_u32 s27, 20
    s_cselect_b32 s29, 20, 0
    s_sub_u32 s27, s27, s29
    s_mul_i32 s27, s27, 122880
    s_add_u32 s27, s27, s24
    s_add_u32 m0, s26, 30720
    s_nop 0
    buffer_load_dwordx4 v8, s[8:11], s27 offen lds
    s_add_u32 m0, m0, 1024
    s_nop 0
    buffer_load_dwordx4 v9, s[8:11], s27 offen lds
    s_add_u32 m0, m0, 1024
    s_nop 0
    buffer_load_dwordx4 v10, s[8:11], s27 offen lds
    s_add_u32 m0, m0, 1024
    s_nop 0
    buffer_load_dwordx4 v11, s[8:11], s27 offen lds
    s_lshl_b32 s27, s28, 1
    s_add_u32 s27, s27, 3
    s_cmp_ge_u32 s27, 20
    s_cselect_b32 s29, 20, 0
    s_sub_u32 s27, s27, s29
    s_mul_i32 s27, s27, 122880
    s_add_u32 s27, s27, s24
    s_add_u32 m0, s26, 46080
    s_nop 0
    buffer_load_dwordx4 v8, s[8:11], s27 offen lds
    s_add_u32 m0, m0, 1024
    s_nop 0
    buffer_load_dwordx4 v9, s[8:11], s27 offen lds
    s_add_u32 m0, m0, 1024
    s_nop 0
    buffer_load_dwordx4 v10, s[8:11], s27 offen lds
    s_add_u32 m0, m0, 1024
    s_nop 0
    buffer_load_dwordx4 v11, s[8:11], s27 offen lds
    s_waitcnt vmcnt(16)
    s_barrier
    s_add_u32 s27, s28, 2
    s_cmp_ge_u32 s27, 10
    s_cselect_b32 s29, 10, 0
    s_sub_u32 s27, s27, s29
    s_lshl_b32 s27, s27, 7
    s_add_u32 m0, s23, 36864
    s_nop 0
    buffer_load_dwordx4 v2, s[4:7], s27 offen lds
    s_add_u32 m0, m0, 1024
    s_nop 0
    buffer_load_dwordx4 v3, s[4:7], s27 offen lds
    s_waitcnt vmcnt(14)
    s_barrier
    s_lshl_b32 s27, s28, 1
    s_add_u32 s27, s27, 4
    s_cmp_ge_u32 s27, 20
    s_cselect_b32 s29, 20, 0
    s_sub_u32 s27, s27, s29
    s_mul_i32 s27, s27, 122880
    s_add_u32 s27, s27, s24
    s_add_u32 m0, s26, 61440
    s_nop 0
    buffer_load_dwordx4 v8, s[8:11], s27 offen lds
    s_add_u32 m0, m0, 1024
    s_nop 0
    buffer_load_dwordx4 v9, s[8:11], s27 offen lds
    s_add_u32 m0, m0, 1024
    s_nop 0
    buffer_load_dwordx4 v10, s[8:11], s27 offen lds
    s_add_u32 m0, m0, 1024
    s_nop 0
    buffer_load_dwordx4 v11, s[8:11], s27 offen lds
    s_add_u32 s27, s28, 2
    s_cmp_ge_u32 s27, 10
    s_cselect_b32 s29, 10, 0
    s_sub_u32 s27, s27, s29
    s_lshl_b32 s27, s27, 7
    s_add_u32 m0, s23, 46080
    s_nop 0
    buffer_load_dwordx4 v5, s[4:7], s27 offen lds
    s_add_u32 m0, m0, 1024
    s_nop 0
    buffer_load_dwordx4 v6, s[4:7], s27 offen lds
    s_waitcnt vmcnt(12)
    s_barrier
    s_lshl_b32 s27, s28, 1
    s_add_u32 s27, s27, 5
    s_cmp_ge_u32 s27, 20
    s_cselect_b32 s29, 20, 0
    s_sub_u32 s27, s27, s29
    s_mul_i32 s27, s27, 122880
    s_add_u32 s27, s27, s24
    s_add_u32 m0, s26, 76800
    s_nop 0
    buffer_load_dwordx4 v8, s[8:11], s27 offen lds
    s_add_u32 m0, m0, 1024
    s_nop 0
    buffer_load_dwordx4 v9, s[8:11], s27 offen lds
    s_add_u32 m0, m0, 1024
    s_nop 0
    buffer_load_dwordx4 v10, s[8:11], s27 offen lds
    s_add_u32 m0, m0, 1024
    s_nop 0
    buffer_load_dwordx4 v11, s[8:11], s27 offen lds
    s_add_u32 s27, s28, 3
    s_cmp_ge_u32 s27, 10
    s_cselect_b32 s29, 10, 0
    s_sub_u32 s27, s27, s29
    s_lshl_b32 s27, s27, 7
    s_add_u32 m0, s23, 0
    s_nop 0
    buffer_load_dwordx4 v2, s[4:7], s27 offen lds
    s_add_u32 m0, m0, 1024
    s_nop 0
    buffer_load_dwordx4 v3, s[4:7], s27 offen lds
    s_waitcnt vmcnt(14)
    s_barrier
    s_lshl_b32 s27, s28, 1
    s_add_u32 s27, s27, 6
    s_cmp_ge_u32 s27, 20
    s_cselect_b32 s29, 20, 0
    s_sub_u32 s27, s27, s29
    s_mul_i32 s27, s27, 122880
    s_add_u32 s27, s27, s24
    s_add_u32 m0, s26, 0
    s_nop 0
    buffer_load_dwordx4 v8, s[8:11], s27 offen lds
    s_add_u32 m0, m0, 1024
    s_nop 0
    buffer_load_dwordx4 v9, s[8:11], s27 offen lds
    s_add_u32 m0, m0, 1024
    s_nop 0
    buffer_load_dwordx4 v10, s[8:11], s27 offen lds
    s_add_u32 m0, m0, 1024
    s_nop 0
    buffer_load_dwordx4 v11, s[8:11], s27 offen lds
    s_add_u32 s27, s28, 3
    s_cmp_ge_u32 s27, 10
    s_cselect_b32 s29, 10, 0
    s_sub_u32 s27, s27, s29
    s_lshl_b32 s27, s27, 7
    s_add_u32 m0, s23, 9216
    s_nop 0
    buffer_load_dwordx4 v5, s[4:7], s27 offen lds
    s_add_u32 m0, m0, 1024
    s_nop 0
    buffer_load_dwordx4 v6, s[4:7], s27 offen lds
    s_waitcnt vmcnt(12)
    s_barrier
    s_lshl_b32 s27, s28, 1
    s_add_u32 s27, s27, 7
    s_cmp_ge_u32 s27, 20
    s_cselect_b32 s29, 20, 0
    s_sub_u32 s27, s27, s29
    s_mul_i32 s27, s27, 122880
    s_add_u32 s27, s27, s24
    s_add_u32 m0, s26, 15360
    s_nop 0
    buffer_load_dwordx4 v8, s[8:11], s27 offen lds
    s_add_u32 m0, m0, 1024
    s_nop 0
    buffer_load_dwordx4 v9, s[8:11], s27 offen lds
    s_add_u32 m0, m0, 1024
    s_nop 0
    buffer_load_dwordx4 v10, s[8:11], s27 offen lds
    s_add_u32 m0, m0, 1024
    s_nop 0
    buffer_load_dwordx4 v11, s[8:11], s27 offen lds
    s_add_u32 s27, s28, 4
    s_cmp_ge_u32 s27, 10
    s_cselect_b32 s29, 10, 0
    s_sub_u32 s27, s27, s29
    s_lshl_b32 s27, s27, 7
    s_add_u32 m0, s23, 18432
    s_nop 0
    buffer_load_dwordx4 v2, s[4:7], s27 offen lds
    s_add_u32 m0, m0, 1024
    s_nop 0
    buffer_load_dwordx4 v3, s[4:7], s27 offen lds
    s_waitcnt vmcnt(14)
    s_barrier
    s_lshl_b32 s27, s28, 1
    s_add_u32 s27, s27, 8
    s_cmp_ge_u32 s27, 20
    s_cselect_b32 s29, 20, 0
    s_sub_u32 s27, s27, s29
    s_mul_i32 s27, s27, 122880
    s_add_u32 s27, s27, s24
    s_add_u32 m0, s26, 30720
    s_nop 0
    buffer_load_dwordx4 v8, s[8:11], s27 offen lds
    s_add_u32 m0, m0, 1024
    s_nop 0
    buffer_load_dwordx4 v9, s[8:11], s27 offen lds
    s_add_u32 m0, m0, 1024
    s_nop 0
    buffer_load_dwordx4 v10, s[8:11], s27 offen lds
    s_add_u32 m0, m0, 1024
    s_nop 0
    buffer_load_dwordx4 v11, s[8:11], s27 offen lds
    s_add_u32 s27, s28, 4
    s_cmp_ge_u32 s27, 10
    s_cselect_b32 s29, 10, 0
    s_sub_u32 s27, s27, s29
    s_lshl_b32 s27, s27, 7
    s_add_u32 m0, s23, 27648
    s_nop 0
    buffer_load_dwordx4 v5, s[4:7], s27 offen lds
    s_add_u32 m0, m0, 1024
    s_nop 0
    buffer_load_dwordx4 v6, s[4:7], s27 offen lds
    s_waitcnt vmcnt(12)
    s_barrier
    s_lshl_b32 s27, s28, 1
    s_add_u32 s27, s27, 9
    s_cmp_ge_u32 s27, 20
    s_cselect_b32 s29, 20, 0
    s_sub_u32 s27, s27, s29
    s_mul_i32 s27, s27, 122880
    s_add_u32 s27, s27, s24
    s_add_u32 m0, s26, 46080
    s_nop 0
    buffer_load_dwordx4 v8, s[8:11], s27 offen lds
    s_add_u32 m0, m0, 1024
    s_nop 0
    buffer_load_dwordx4 v9, s[8:11], s27 offen lds
    s_add_u32 m0, m0, 1024
    s_nop 0
    buffer_load_dwordx4 v10, s[8:11], s27 offen lds
    s_add_u32 m0, m0, 1024
    s_nop 0
    buffer_load_dwordx4 v11, s[8:11], s27 offen lds
    s_add_u32 s27, s28, 5
    s_cmp_ge_u32 s27, 10
    s_cselect_b32 s29, 10, 0
    s_sub_u32 s27, s27, s29
    s_lshl_b32 s27, s27, 7
    s_add_u32 m0, s23, 36864
    s_nop 0
    buffer_load_dwordx4 v2, s[4:7], s27 offen lds
    s_add_u32 m0, m0, 1024
    s_nop 0
    buffer_load_dwordx4 v3, s[4:7], s27 offen lds
    s_waitcnt vmcnt(14)
    s_barrier
    s_lshl_b32 s27, s28, 1
    s_add_u32 s27, s27, 10
    s_cmp_ge_u32 s27, 20
    s_cselect_b32 s29, 20, 0
    s_sub_u32 s27, s27, s29
    s_mul_i32 s27, s27, 122880
    s_add_u32 s27, s27, s24
    s_add_u32 m0, s26, 61440
    s_nop 0
    buffer_load_dwordx4 v8, s[8:11], s27 offen lds
    s_add_u32 m0, m0, 1024
    s_nop 0
    buffer_load_dwordx4 v9, s[8:11], s27 offen lds
    s_add_u32 m0, m0, 1024
    s_nop 0
    buffer_load_dwordx4 v10, s[8:11], s27 offen lds
    s_add_u32 m0, m0, 1024
    s_nop 0
    buffer_load_dwordx4 v11, s[8:11], s27 offen lds
    s_add_u32 s27, s28, 5
    s_cmp_ge_u32 s27, 10
    s_cselect_b32 s29, 10, 0
    s_sub_u32 s27, s27, s29
    s_lshl_b32 s27, s27, 7
    s_add_u32 m0, s23, 46080
    s_nop 0
    buffer_load_dwordx4 v5, s[4:7], s27 offen lds
    s_add_u32 m0, m0, 1024
    s_nop 0
    buffer_load_dwordx4 v6, s[4:7], s27 offen lds
    s_waitcnt vmcnt(12)
    s_barrier
    s_lshl_b32 s27, s28, 1
    s_add_u32 s27, s27, 11
    s_cmp_ge_u32 s27, 20
    s_cselect_b32 s29, 20, 0
    s_sub_u32 s27, s27, s29
    s_mul_i32 s27, s27, 122880
    s_add_u32 s27, s27, s24
    s_add_u32 m0, s26, 76800
    s_nop 0
    buffer_load_dwordx4 v8, s[8:11], s27 offen lds
    s_add_u32 m0, m0, 1024
    s_nop 0
    buffer_load_dwordx4 v9, s[8:11], s27 offen lds
    s_add_u32 m0, m0, 1024
    s_nop 0
    buffer_load_dwordx4 v10, s[8:11], s27 offen lds
    s_add_u32 m0, m0, 1024
    s_nop 0
    buffer_load_dwordx4 v11, s[8:11], s27 offen lds
    s_add_u32 s27, s28, 6
    s_cmp_ge_u32 s27, 10
    s_cselect_b32 s29, 10, 0
    s_sub_u32 s27, s27, s29
    s_lshl_b32 s27, s27, 7
    s_add_u32 m0, s23, 0
    s_nop 0
    buffer_load_dwordx4 v2, s[4:7], s27 offen lds
    s_add_u32 m0, m0, 1024
    s_nop 0
    buffer_load_dwordx4 v3, s[4:7], s27 offen lds
    s_waitcnt vmcnt(14)
    s_barrier
    s_lshl_b32 s27, s28, 1
    s_add_u32 s27, s27, 12
    s_cmp_ge_u32 s27, 20
    s_cselect_b32 s29, 20, 0
    s_sub_u32 s27, s27, s29
    s_mul_i32 s27, s27, 122880
    s_add_u32 s27, s27, s24
    s_add_u32 m0, s26, 0
    s_nop 0
    buffer_load_dwordx4 v8, s[8:11], s27 offen lds
    s_add_u32 m0, m0, 1024
    s_nop 0
    buffer_load_dwordx4 v9, s[8:11], s27 offen lds
    s_add_u32 m0, m0, 1024
    s_nop 0
    buffer_load_dwordx4 v10, s[8:11], s27 offen lds
    s_add_u32 m0, m0, 1024
    s_nop 0
    buffer_load_dwordx4 v11, s[8:11], s27 offen lds
    s_add_u32 s27, s28, 6
    s_cmp_ge_u32 s27, 10
    s_cselect_b32 s29, 10, 0
    s_sub_u32 s27, s27, s29
    s_lshl_b32 s27, s27, 7
    s_add_u32 m0, s23, 9216
    s_nop 0
    buffer_load_dwordx4 v5, s[4:7], s27 offen lds
    s_add_u32 m0, m0, 1024
    s_nop 0
    buffer_load_dwordx4 v6, s[4:7], s27 offen lds
    s_waitcnt vmcnt(12)
    s_barrier
    s_lshl_b32 s27, s28, 1
    s_add_u32 s27, s27, 13
    s_cmp_ge_u32 s27, 20
    s_cselect_b32 s29, 20, 0
    s_sub_u32 s27, s27, s29
    s_mul_i32 s27, s27, 122880
    s_add_u32 s27, s27, s24
    s_add_u32 m0, s26, 15360
    s_nop 0
    buffer_load_dwordx4 v8, s[8:11], s27 offen lds
    s_add_u32 m0, m0, 1024
    s_nop 0
    buffer_load_dwordx4 v9, s[8:11], s27 offen lds
    s_add_u32 m0, m0, 1024
    s_nop 0
    buffer_load_dwordx4 v10, s[8:11], s27 offen lds
    s_add_u32 m0, m0, 1024
    s_nop 0
    buffer_load_dwordx4 v11, s[8:11], s27 offen lds
    s_add_u32 s27, s28, 7
    s_cmp_ge_u32 s27, 10
    s_cselect_b32 s29, 10, 0
    s_sub_u32 s27, s27, s29
    s_lshl_b32 s27, s27, 7
    s_add_u32 m0, s23, 18432
    s_nop 0
    buffer_load_dwordx4 v2, s[4:7], s27 offen lds
    s_add_u32 m0, m0, 1024
    s_nop 0
    buffer_load_dwordx4 v3, s[4:7], s27 offen lds
    s_waitcnt vmcnt(14)
    s_barrier
    s_lshl_b32 s27, s28, 1
    s_add_u32 s27, s27, 14
    s_cmp_ge_u32 s27, 20
    s_cselect_b32 s29, 20, 0
    s_sub_u32 s27, s27, s29
    s_mul_i32 s27, s27, 122880
    s_add_u32 s27, s27, s24
    s_add_u32 m0, s26, 30720
    s_nop 0
    buffer_load_dwordx4 v8, s[8:11], s27 offen lds
    s_add_u32 m0, m0, 1024
    s_nop 0
    buffer_load_dwordx4 v9, s[8:11], s27 offen lds
    s_add_u32 m0, m0, 1024
    s_nop 0
    buffer_load_dwordx4 v10, s[8:11], s27 offen lds
    s_add_u32 m0, m0, 1024
    s_nop 0
    buffer_load_dwordx4 v11, s[8:11], s27 offen lds
    s_add_u32 s27, s28, 7
    s_cmp_ge_u32 s27, 10
    s_cselect_b32 s29, 10, 0
    s_sub_u32 s27, s27, s29
    s_lshl_b32 s27, s27, 7
    s_add_u32 m0, s23, 27648
    s_nop 0
    buffer_load_dwordx4 v5, s[4:7], s27 offen lds
    s_add_u32 m0, m0, 1024
    s_nop 0
    buffer_load_dwordx4 v6, s[4:7], s27 offen lds
    s_waitcnt vmcnt(12)
    s_barrier
    s_lshl_b32 s27, s28, 1
    s_add_u32 s27, s27, 15
    s_cmp_ge_u32 s27, 20
    s_cselect_b32 s29, 20, 0
    s_sub_u32 s27, s27, s29
    s_mul_i32 s27, s27, 122880
    s_add_u32 s27, s27, s24
    s_add_u32 m0, s26, 46080
    s_nop 0
    buffer_load_dwordx4 v8, s[8:11], s27 offen lds
    s_add_u32 m0, m0, 1024
    s_nop 0
    buffer_load_dwordx4 v9, s[8:11], s27 offen lds
    s_add_u32 m0, m0, 1024
    s_nop 0
    buffer_load_dwordx4 v10, s[8:11], s27 offen lds
    s_add_u32 m0, m0, 1024
    s_nop 0
    buffer_load_dwordx4 v11, s[8:11], s27 offen lds
    s_add_u32 s27, s28, 8
    s_cmp_ge_u32 s27, 10
    s_cselect_b32 s29, 10, 0
    s_sub_u32 s27, s27, s29
    s_lshl_b32 s27, s27, 7
    s_add_u32 m0, s23, 36864
    s_nop 0
    buffer_load_dwordx4 v2, s[4:7], s27 offen lds
    s_add_u32 m0, m0, 1024
    s_nop 0
    buffer_load_dwordx4 v3, s[4:7], s27 offen lds
    s_waitcnt vmcnt(14)
    s_barrier
    s_lshl_b32 s27, s28, 1
    s_add_u32 s27, s27, 16
    s_cmp_ge_u32 s27, 20
    s_cselect_b32 s29, 20, 0
    s_sub_u32 s27, s27, s29
    s_mul_i32 s27, s27, 122880
    s_add_u32 s27, s27, s24
    s_add_u32 m0, s26, 61440
    s_nop 0
    buffer_load_dwordx4 v8, s[8:11], s27 offen lds
    s_add_u32 m0, m0, 1024
    s_nop 0
    buffer_load_dwordx4 v9, s[8:11], s27 offen lds
    s_add_u32 m0, m0, 1024
    s_nop 0
    buffer_load_dwordx4 v10, s[8:11], s27 offen lds
    s_add_u32 m0, m0, 1024
    s_nop 0
    buffer_load_dwordx4 v11, s[8:11], s27 offen lds
    s_add_u32 s27, s28, 8
    s_cmp_ge_u32 s27, 10
    s_cselect_b32 s29, 10, 0
    s_sub_u32 s27, s27, s29
    s_lshl_b32 s27, s27, 7
    s_add_u32 m0, s23, 46080
    s_nop 0
    buffer_load_dwordx4 v5, s[4:7], s27 offen lds
    s_add_u32 m0, m0, 1024
    s_nop 0
    buffer_load_dwordx4 v6, s[4:7], s27 offen lds
    s_waitcnt vmcnt(12)
    s_barrier
    s_lshl_b32 s27, s28, 1
    s_add_u32 s27, s27, 17
    s_cmp_ge_u32 s27, 20
    s_cselect_b32 s29, 20, 0
    s_sub_u32 s27, s27, s29
    s_mul_i32 s27, s27, 122880
    s_add_u32 s27, s27, s24
    s_add_u32 m0, s26, 76800
    s_nop 0
    buffer_load_dwordx4 v8, s[8:11], s27 offen lds
    s_add_u32 m0, m0, 1024
    s_nop 0
    buffer_load_dwordx4 v9, s[8:11], s27 offen lds
    s_add_u32 m0, m0, 1024
    s_nop 0
    buffer_load_dwordx4 v10, s[8:11], s27 offen lds
    s_add_u32 m0, m0, 1024
    s_nop 0
    buffer_load_dwordx4 v11, s[8:11], s27 offen lds
    s_add_u32 s27, s28, 9
    s_cmp_ge_u32 s27, 10
    s_cselect_b32 s29, 10, 0
    s_sub_u32 s27, s27, s29
    s_lshl_b32 s27, s27, 7
    s_add_u32 m0, s23, 0
    s_nop 0
    buffer_load_dwordx4 v2, s[4:7], s27 offen lds
    s_add_u32 m0, m0, 1024
    s_nop 0
    buffer_load_dwordx4 v3, s[4:7], s27 offen lds
    s_waitcnt vmcnt(14)
    s_barrier
    s_lshl_b32 s27, s28, 1
    s_add_u32 s27, s27, 18
    s_cmp_ge_u32 s27, 20
    s_cselect_b32 s29, 20, 0
    s_sub_u32 s27, s27, s29
    s_mul_i32 s27, s27, 122880
    s_add_u32 s27, s27, s24
    s_add_u32 m0, s26, 0
    s_nop 0
    buffer_load_dwordx4 v8, s[8:11], s27 offen lds
    s_add_u32 m0, m0, 1024
    s_nop 0
    buffer_load_dwordx4 v9, s[8:11], s27 offen lds
    s_add_u32 m0, m0, 1024
    s_nop 0
    buffer_load_dwordx4 v10, s[8:11], s27 offen lds
    s_add_u32 m0, m0, 1024
    s_nop 0
    buffer_load_dwordx4 v11, s[8:11], s27 offen lds
    s_add_u32 s27, s28, 9
    s_cmp_ge_u32 s27, 10
    s_cselect_b32 s29, 10, 0
    s_sub_u32 s27, s27, s29
    s_lshl_b32 s27, s27, 7
    s_add_u32 m0, s23, 9216
    s_nop 0
    buffer_load_dwordx4 v5, s[4:7], s27 offen lds
    s_add_u32 m0, m0, 1024
    s_nop 0
    buffer_load_dwordx4 v6, s[4:7], s27 offen lds
    s_waitcnt vmcnt(12)
    s_barrier
    s_lshl_b32 s27, s28, 1
    s_add_u32 s27, s27, 19
    s_cmp_ge_u32 s27, 20
    s_cselect_b32 s29, 20, 0
    s_sub_u32 s27, s27, s29
    s_mul_i32 s27, s27, 122880
    s_add_u32 s27, s27, s24
    s_add_u32 m0, s26, 15360
    s_nop 0
    buffer_load_dwordx4 v8, s[8:11], s27 offen lds
    s_add_u32 m0, m0, 1024
    s_nop 0
    buffer_load_dwordx4 v9, s[8:11], s27 offen lds
    s_add_u32 m0, m0, 1024
    s_nop 0
    buffer_load_dwordx4 v10, s[8:11], s27 offen lds
    s_add_u32 m0, m0, 1024
    s_nop 0
    buffer_load_dwordx4 v11, s[8:11], s27 offen lds
    s_waitcnt vmcnt(12)
    s_barrier
    s_mov_b32 s4, s52
    s_mov_b32 s5, s53
    s_mov_b32 s6, 8388608
    s_mov_b32 s7, 0x20000
    s_and_b32 s40, s2, 7
    s_lshr_b32 s40, s40, 1
    s_lshl_b32 s40, s40, 14
    s_lshr_b32 s41, s2, 3
    s_and_b32 s41, s41, 15
    s_lshl_b32 s41, s41, 10
    s_add_u32 s40, s40, s41
    s_sub_u32 s41, s16, 4
    s_lshl_b32 s41, s41, 8
    s_add_u32 s40, s40, s41
    s_lshl_b32 s40, s40, 7
    v_lshlrev_b32 v249, 7, v0
    buffer_load_dword v250, v249, s[4:7], s40 offen
    s_waitcnt vmcnt(5)
    s_barrier
    s_add_u32 s40, s40, 8192
    buffer_load_dword v251, v249, s[4:7], s40 offen
    s_waitcnt vmcnt(2)
    s_barrier
    s_add_u32 s40, s40, 8192
    buffer_load_dword v250, v249, s[4:7], s40 offen
    s_barrier
    s_add_u32 s40, s40, 8192
    buffer_load_dword v251, v249, s[4:7], s40 offen
    s_barrier
    s_branch K1_att
K1_qload3:
    s_sub_u32 s21, s16, 4
    v_lshrrev_b32 v7, 3, v0
    v_and_b32 v6, 7, v0
    v_xor_b32 v6, v6, v7
    s_lshl_b32 s20, s48, 7
    s_sub_u32 s20, s20, 16
    s_lshl_b32 s22, s21, 4
    s_add_u32 s20, s20, s22
    v_add_u32 v7, s20, v7
    v_mov_b32 v12, v7
    s_mov_b32 s20, 1280
    v_mul_lo_u32 v7, v7, s20
    v_lshl_add_u32 v2, v6, 4, v7
    v_add_u32 v3, 10240, v2
    v_add_u32 v4, 20480, v2
    v_add_u32 v5, 92160, v2
    v_add_u32 v6, 102400, v2
    v_add_u32 v7, 112640, v2
    v_mov_b32 v13, 1073741824
    v_add_u32 v14, 0, v12
    v_cmp_gt_i32 vcc, 0, v14
    s_nop 1
    v_cndmask_b32 v2, v2, v13, vcc
    v_add_u32 v14, 8, v12
    v_cmp_gt_i32 vcc, 0, v14
    s_nop 1
    v_cndmask_b32 v3, v3, v13, vcc
    s_mul_i32 s24, s49, 160
    s_lshl_b32 s23, s21, 11
    s_lshl_b32 s26, s21, 12
    s_add_u32 s26, s26, 55296
    s_add_u32 s27, s28, 0
    s_cmp_ge_u32 s27, 10
    s_cselect_b32 s29, 10, 0
    s_sub_u32 s27, s27, s29
    s_lshl_b32 s27, s27, 7
    s_add_u32 m0, s23, 0
    s_nop 0
    buffer_load_dwordx4 v2, s[4:7], s27 offen lds
    s_add_u32 m0, m0, 1024
    s_nop 0
    buffer_load_dwordx4 v3, s[4:7], s27 offen lds
    s_add_u32 m0, m0, 1024
    s_nop 0
    buffer_load_dwordx4 v4, s[4:7], s27 offen lds
    s_add_u32 s27, s28, 0
    s_cmp_ge_u32 s27, 10
    s_cselect_b32 s29, 10, 0
    s_sub_u32 s27, s27, s29
    s_lshl_b32 s27, s27, 7
    s_add_u32 m0, s23, 9216
    s_nop 0
    buffer_load_dwordx4 v5, s[4:7], s27 offen lds
    s_add_u32 m0, m0, 1024
    s_nop 0
    buffer_load_dwordx4 v6, s[4:7], s27 offen lds
    s_add_u32 m0, m0, 1024
    s_nop 0
    buffer_load_dwordx4 v7, s[4:7], s27 offen lds
    s_lshl_b32 s20, s21, 8
    v_add_u32 v12, s20, v0
    v_add_u32 v12, 0, v12
    v_mul_u32_u24 v13, 2185, v12
    v_lshrrev_b32 v13, 16, v13
    v_mul_u32_u24 v14, 30, v13
    v_sub_u32 v14, v12, v14
    v_and_b32 v15, 0x13, v13
    v_and_b32 v16, 4, v13
    v_lshl_or_b32 v15, v16, 1, v15
    v_and_b32 v16, 8, v13
    v_lshrrev_b32 v16, 1, v16
    v_or_b32 v15, v15, v16
    v_mul_u32_u24 v16, 205, v14
    v_lshrrev_b32 v16, 11, v16
    v_mul_u32_u24 v17, 10, v16
    v_sub_u32 v14, v14, v17
    v_mul_u32_u24 v15, 3840, v15
    v_mul_u32_u24 v16, 1280, v16
    v_lshlrev_b32 v14, 4, v14
    v_add3_u32 v8, v15, v16, v14
    v_add_u32 v12, s20, v0
    v_add_u32 v12, 64, v12
    v_mul_u32_u24 v13, 2185, v12
    v_lshrrev_b32 v13, 16, v13
    v_mul_u32_u24 v14, 30, v13
    v_sub_u32 v14, v12, v14
    v_and_b32 v15, 0x13, v13
    v_and_b32 v16, 4, v13
    v_lshl_or_b32 v15, v16, 1, v15
    v_and_b32 v16, 8, v13
    v_lshrrev_b32 v16, 1, v16
    v_or_b32 v15, v15, v16
    v_mul_u32_u24 v16, 205, v14
    v_lshrrev_b32 v16, 11, v16
    v_mul_u32_u24 v17, 10, v16
    v_sub_u32 v14, v14, v17
    v_mul_u32_u24 v15, 3840, v15
    v_mul_u32_u24 v16, 1280, v16
    v_lshlrev_b32 v14, 4, v14
    v_add3_u32 v9, v15, v16, v14
    v_add_u32 v12, s20, v0
    v_add_u32 v12, 128, v12
    v_mul_u32_u24 v13, 2185, v12
    v_lshrrev_b32 v13, 16, v13
    v_mul_u32_u24 v14, 30, v13
    v_sub_u32 v14, v12, v14
    v_and_b32 v15, 0x13, v13
    v_and_b32 v16, 4, v13
    v_lshl_or_b32 v15, v16, 1, v15
    v_and_b32 v16, 8, v13
    v_lshrrev_b32 v16, 1, v16
    v_or_b32 v15, v15, v16
    v_mul_u32_u24 v16, 205, v14
    v_lshrrev_b32 v16, 11, v16
    v_mul_u32_u24 v17, 10, v16
    v_sub_u32 v14, v14, v17
    v_mul_u32_u24 v15, 3840, v15
    v_mul_u32_u24 v16, 1280, v16
    v_lshlrev_b32 v14, 4, v14
    v_add3_u32 v10, v15, v16, v14
    s_lshl_b32 s27, s28, 1
    s_add_u32 s27, s27, 0
    s_cmp_ge_u32 s27, 20
    s_cselect_b32 s29, 20, 0
    s_sub_u32 s27, s27, s29
    s_mul_i32 s27, s27, 122880
    s_add_u32 s27, s27, s24
    s_add_u32 m0, s26, 0
    s_nop 0
    buffer_load_dwordx4 v8, s[8:11], s27 offen lds
    s_add_u32 m0, m0, 1024
    s_nop 0
    buffer_load_dwordx4 v9, s[8:11], s27 offen lds
    s_add_u32 m0, m0, 1024
    s_nop 0
    buffer_load_dwordx4 v10, s[8:11], s27 offen lds
    s_lshl_b32 s27, s28, 1
    s_add_u32 s27, s27, 1
    s_cmp_ge_u32 s27, 20
    s_cselect_b32 s29, 20, 0
    s_sub_u32 s27, s27, s29
    s_mul_i32 s27, s27, 122880
    s_add_u32 s27, s27, s24
    s_add_u32 m0, s26, 15360
    s_nop 0
    buffer_load_dwordx4 v8, s[8:11], s27 offen lds
    s_add_u32 m0, m0, 1024
    s_nop 0
    buffer_load_dwordx4 v9, s[8:11], s27 offen lds
    s_add_u32 m0, m0, 1024
    s_nop 0
    buffer_load_dwordx4 v10, s[8:11], s27 offen lds
    s_add_u32 s27, s28, 1
    s_cmp_ge_u32 s27, 10
    s_cselect_b32 s29, 10, 0
    s_sub_u32 s27, s27, s29
    s_lshl_b32 s27, s27, 7
    s_add_u32 m0, s23, 18432
    s_nop 0
    buffer_load_dwordx4 v2, s[4:7], s27 offen lds
    s_add_u32 m0, m0, 1024
    s_nop 0
    buffer_load_dwordx4 v3, s[4:7], s27 offen lds
    s_add_u32 m0, m0, 1024
    s_nop 0
    buffer_load_dwordx4 v4, s[4:7], s27 offen lds
    s_add_u32 s27, s28, 1
    s_cmp_ge_u32 s27, 10
    s_cselect_b32 s29, 10, 0
    s_sub_u32 s27, s27, s29
    s_lshl_b32 s27, s27, 7
    s_add_u32 m0, s23, 27648
    s_nop 0
    buffer_load_dwordx4 v5, s[4:7], s27 offen lds
    s_add_u32 m0, m0, 1024
    s_nop 0
    buffer_load_dwordx4 v6, s[4:7], s27 offen lds
    s_add_u32 m0, m0, 1024
    s_nop 0
    buffer_load_dwordx4 v7, s[4:7], s27 offen lds
    s_lshl_b32 s27, s28, 1
    s_add_u32 s27, s27, 2
    s_cmp_ge_u32 s27, 20
    s_cselect_b32 s29, 20, 0
    s_sub_u32 s27, s27, s29
    s_mul_i32 s27, s27, 122880
    s_add_u32 s27, s27, s24
    s_add_u32 m0, s26, 30720
    s_nop 0
    buffer_load_dwordx4 v8, s[8:11], s27 offen lds
    s_add_u32 m0, m0, 1024
    s_nop 0
    buffer_load_dwordx4 v9, s[8:11], s27 offen lds
    s_add_u32 m0, m0, 1024
    s_nop 0
    buffer_load_dwordx4 v10, s[8:11], s27 offen lds
    s_lshl_b32 s27, s28, 1
    s_add_u32 s27, s27, 3
    s_cmp_ge_u32 s27, 20
    s_cselect_b32 s29, 20, 0
    s_sub_u32 s27, s27, s29
    s_mul_i32 s27, s27, 122880
    s_add_u32 s27, s27, s24
    s_add_u32 m0, s26, 46080
    s_nop 0
    buffer_load_dwordx4 v8, s[8:11], s27 offen lds
    s_add_u32 m0, m0, 1024
    s_nop 0
    buffer_load_dwordx4 v9, s[8:11], s27 offen lds
    s_add_u32 m0, m0, 1024
    s_nop 0
    buffer_load_dwordx4 v10, s[8:11], s27 offen lds
    s_waitcnt vmcnt(15)
    s_barrier
    s_add_u32 s27, s28, 2
    s_cmp_ge_u32 s27, 10
    s_cselect_b32 s29, 10, 0
    s_sub_u32 s27, s27, s29
    s_lshl_b32 s27, s27, 7
    s_add_u32 m0, s23, 36864
    s_nop 0
    buffer_load_dwordx4 v2, s[4:7], s27 offen lds
    s_add_u32 m0, m0, 1024
    s_nop 0
    buffer_load_dwordx4 v3, s[4:7], s27 offen lds
    s_add_u32 m0, m0, 1024
    s_nop 0
    buffer_load_dwordx4 v4, s[4:7], s27 offen lds
    s_waitcnt vmcnt(15)
    s_barrier
    s_lshl_b32 s27, s28, 1
    s_add_u32 s27, s27, 4
    s_cmp_ge_u32 s27, 20
    s_cselect_b32 s29, 20, 0
    s_sub_u32 s27, s27, s29
    s_mul_i32 s27, s27, 122880
    s_add_u32 s27, s27, s24
    s_add_u32 m0, s26, 61440
    s_nop 0
    buffer_load_dwordx4 v8, s[8:11], s27 offen lds
    s_add_u32 m0, m0, 1024
    s_nop 0
    buffer_load_dwordx4 v9, s[8:11], s27 offen lds
    s_add_u32 m0, m0, 1024
    s_nop 0
    buffer_load_dwordx4 v10, s[8:11], s27 offen lds
    s_add_u32 s27, s28, 2
    s_cmp_ge_u32 s27, 10
    s_cselect_b32 s29, 10, 0
    s_sub_u32 s27, s27, s29
    s_lshl_b32 s27, s27, 7
    s_add_u32 m0, s23, 46080
    s_nop 0
    buffer_load_dwordx4 v5, s[4:7], s27 offen lds
    s_add_u32 m0, m0, 1024
    s_nop 0
    buffer_load_dwordx4 v6, s[4:7], s27 offen lds
    s_add_u32 m0, m0, 1024
    s_nop 0
    buffer_load_dwordx4 v7, s[4:7], s27 offen lds
    s_waitcnt vmcnt(12)
    s_barrier
    s_lshl_b32 s27, s28, 1
    s_add_u32 s27, s27, 5
    s_cmp_ge_u32 s27, 20
    s_cselect_b32 s29, 20, 0
    s_sub_u32 s27, s27, s29
    s_mul_i32 s27, s27, 122880
    s_add_u32 s27, s27, s24
    s_add_u32 m0, s26, 76800
    s_nop 0
    buffer_load_dwordx4 v8, s[8:11], s27 offen lds
    s_add_u32 m0, m0, 1024
    s_nop 0
    buffer_load_dwordx4 v9, s[8:11], s27 offen lds
    s_add_u32 m0, m0, 1024
    s_nop 0
    buffer_load_dwordx4 v10, s[8:11], s27 offen lds
    s_add_u32 s27, s28, 3
    s_cmp_ge_u32 s27, 10
    s_cselect_b32 s29, 10, 0
    s_sub_u32 s27, s27, s29
    s_lshl_b32 s27, s27, 7
    s_add_u32 m0, s23, 0
    s_nop 0
    buffer_load_dwordx4 v2, s[4:7], s27 offen lds
    s_add_u32 m0, m0, 1024
    s_nop 0
    buffer_load_dwordx4 v3, s[4:7], s27 offen lds
    s_add_u32 m0, m0, 1024
    s_nop 0
    buffer_load_dwordx4 v4, s[4:7], s27 offen lds
    s_waitcnt vmcnt(15)
    s_barrier
    s_lshl_b32 s27, s28, 1
    s_add_u32 s27, s27, 6
    s_cmp_ge_u32 s27, 20
    s_cselect_b32 s29, 20, 0
    s_sub_u32 s27, s27, s29
    s_mul_i32 s27, s27, 122880
    s_add_u32 s27, s27, s24
    s_add_u32 m0, s26, 0
    s_nop 0
    buffer_load_dwordx4 v8, s[8:11], s27 offen lds
    s_add_u32 m0, m0, 1024
    s_nop 0
    buffer_load_dwordx4 v9, s[8:11], s27 offen lds
    s_add_u32 m0, m0, 1024
    s_nop 0
    buffer_load_dwordx4 v10, s[8:11], s27 offen lds
    s_add_u32 s27, s28, 3
    s_cmp_ge_u32 s27, 10
    s_cselect_b32 s29, 10, 0
    s_sub_u32 s27, s27, s29
    s_lshl_b32 s27, s27, 7
    s_add_u32 m0, s23, 9216
    s_nop 0
    buffer_load_dwordx4 v5, s[4:7], s27 offen lds
    s_add_u32 m0, m0, 1024
    s_nop 0
    buffer_load_dwordx4 v6, s[4:7], s27 offen lds
    s_add_u32 m0, m0, 1024
    s_nop 0
    buffer_load_dwordx4 v7, s[4:7], s27 offen lds
    s_waitcnt vmcnt(12)
    s_barrier
    s_lshl_b32 s27, s28, 1
    s_add_u32 s27, s27, 7
    s_cmp_ge_u32 s27, 20
    s_cselect_b32 s29, 20, 0
    s_sub_u32 s27, s27, s29
    s_mul_i32 s27, s27, 122880
    s_add_u32 s27, s27, s24
    s_add_u32 m0, s26, 15360
    s_nop 0
    buffer_load_dwordx4 v8, s[8:11], s27 offen lds
    s_add_u32 m0, m0, 1024
    s_nop 0
    buffer_load_dwordx4 v9, s[8:11], s27 offen lds
    s_add_u32 m0, m0, 1024
    s_nop 0
    buffer_load_dwordx4 v10, s[8:11], s27 offen lds
    s_add_u32 s27, s28, 4
    s_cmp_ge_u32 s27, 10
    s_cselect_b32 s29, 10, 0
    s_sub_u32 s27, s27, s29
    s_lshl_b32 s27, s27, 7
    s_add_u32 m0, s23, 18432
    s_nop 0
    buffer_load_dwordx4 v2, s[4:7], s27 offen lds
    s_add_u32 m0, m0, 1024
    s_nop 0
    buffer_load_dwordx4 v3, s[4:7], s27 offen lds
    s_add_u32 m0, m0, 1024
    s_nop 0
    buffer_load_dwordx4 v4, s[4:7], s27 offen lds
    s_waitcnt vmcnt(15)
    s_barrier
    s_lshl_b32 s27, s28, 1
    s_add_u32 s27, s27, 8
    s_cmp_ge_u32 s27, 20
    s_cselect_b32 s29, 20, 0
    s_sub_u32 s27, s27, s29
    s_mul_i32 s27, s27, 122880
    s_add_u32 s27, s27, s24
    s_add_u32 m0, s26, 30720
    s_nop 0
    buffer_load_dwordx4 v8, s[8:11], s27 offen lds
    s_add_u32 m0, m0, 1024
    s_nop 0
    buffer_load_dwordx4 v9, s[8:11], s27 offen lds
    s_add_u32 m0, m0, 1024
    s_nop 0
    buffer_load_dwordx4 v10, s[8:11], s27 offen lds
    s_add_u32 s27, s28, 4
    s_cmp_ge_u32 s27, 10
    s_cselect_b32 s29, 10, 0
    s_sub_u32 s27, s27, s29
    s_lshl_b32 s27, s27, 7
    s_add_u32 m0, s23, 27648
    s_nop 0
    buffer_load_dwordx4 v5, s[4:7], s27 offen lds
    s_add_u32 m0, m0, 1024
    s_nop 0
    buffer_load_dwordx4 v6, s[4:7], s27 offen lds
    s_add_u32 m0, m0, 1024
    s_nop 0
    buffer_load_dwordx4 v7, s[4:7], s27 offen lds
    s_waitcnt vmcnt(12)
    s_barrier
    s_lshl_b32 s27, s28, 1
    s_add_u32 s27, s27, 9
    s_cmp_ge_u32 s27, 20
    s_cselect_b32 s29, 20, 0
    s_sub_u32 s27, s27, s29
    s_mul_i32 s27, s27, 122880
    s_add_u32 s27, s27, s24
    s_add_u32 m0, s26, 46080
    s_nop 0
    buffer_load_dwordx4 v8, s[8:11], s27 offen lds
    s_add_u32 m0, m0, 1024
    s_nop 0
    buffer_load_dwordx4 v9, s[8:11], s27 offen lds
    s_add_u32 m0, m0, 1024
    s_nop 0
    buffer_load_dwordx4 v10, s[8:11], s27 offen lds
    s_add_u32 s27, s28, 5
    s_cmp_ge_u32 s27, 10
    s_cselect_b32 s29, 10, 0
    s_sub_u32 s27, s27, s29
    s_lshl_b32 s27, s27, 7
    s_add_u32 m0, s23, 36864
    s_nop 0
    buffer_load_dwordx4 v2, s[4:7], s27 offen lds
    s_add_u32 m0, m0, 1024
    s_nop 0
    buffer_load_dwordx4 v3, s[4:7], s27 offen lds
    s_add_u32 m0, m0, 1024
    s_nop 0
    buffer_load_dwordx4 v4, s[4:7], s27 offen lds
    s_waitcnt vmcnt(15)
    s_barrier
    s_lshl_b32 s27, s28, 1
    s_add_u32 s27, s27, 10
    s_cmp_ge_u32 s27, 20
    s_cselect_b32 s29, 20, 0
    s_sub_u32 s27, s27, s29
    s_mul_i32 s27, s27, 122880
    s_add_u32 s27, s27, s24
    s_add_u32 m0, s26, 61440
    s_nop 0
    buffer_load_dwordx4 v8, s[8:11], s27 offen lds
    s_add_u32 m0, m0, 1024
    s_nop 0
    buffer_load_dwordx4 v9, s[8:11], s27 offen lds
    s_add_u32 m0, m0, 1024
    s_nop 0
    buffer_load_dwordx4 v10, s[8:11], s27 offen lds
    s_add_u32 s27, s28, 5
    s_cmp_ge_u32 s27, 10
    s_cselect_b32 s29, 10, 0
    s_sub_u32 s27, s27, s29
    s_lshl_b32 s27, s27, 7
    s_add_u32 m0, s23, 46080
    s_nop 0
    buffer_load_dwordx4 v5, s[4:7], s27 offen lds
    s_add_u32 m0, m0, 1024
    s_nop 0
    buffer_load_dwordx4 v6, s[4:7], s27 offen lds
    s_add_u32 m0, m0, 1024
    s_nop 0
    buffer_load_dwordx4 v7, s[4:7], s27 offen lds
    s_waitcnt vmcnt(12)
    s_barrier
    s_lshl_b32 s27, s28, 1
    s_add_u32 s27, s27, 11
    s_cmp_ge_u32 s27, 20
    s_cselect_b32 s29, 20, 0
    s_sub_u32 s27, s27, s29
    s_mul_i32 s27, s27, 122880
    s_add_u32 s27, s27, s24
    s_add_u32 m0, s26, 76800
    s_nop 0
    buffer_load_dwordx4 v8, s[8:11], s27 offen lds
    s_add_u32 m0, m0, 1024
    s_nop 0
    buffer_load_dwordx4 v9, s[8:11], s27 offen lds
    s_add_u32 m0, m0, 1024
    s_nop 0
    buffer_load_dwordx4 v10, s[8:11], s27 offen lds
    s_add_u32 s27, s28, 6
    s_cmp_ge_u32 s27, 10
    s_cselect_b32 s29, 10, 0
    s_sub_u32 s27, s27, s29
    s_lshl_b32 s27, s27, 7
    s_add_u32 m0, s23, 0
    s_nop 0
    buffer_load_dwordx4 v2, s[4:7], s27 offen lds
    s_add_u32 m0, m0, 1024
    s_nop 0
    buffer_load_dwordx4 v3, s[4:7], s27 offen lds
    s_add_u32 m0, m0, 1024
    s_nop 0
    buffer_load_dwordx4 v4, s[4:7], s27 offen lds
    s_waitcnt vmcnt(15)
    s_barrier
    s_lshl_b32 s27, s28, 1
    s_add_u32 s27, s27, 12
    s_cmp_ge_u32 s27, 20
    s_cselect_b32 s29, 20, 0
    s_sub_u32 s27, s27, s29
    s_mul_i32 s27, s27, 122880
    s_add_u32 s27, s27, s24
    s_add_u32 m0, s26, 0
    s_nop 0
    buffer_load_dwordx4 v8, s[8:11], s27 offen lds
    s_add_u32 m0, m0, 1024
    s_nop 0
    buffer_load_dwordx4 v9, s[8:11], s27 offen lds
    s_add_u32 m0, m0, 1024
    s_nop 0
    buffer_load_dwordx4 v10, s[8:11], s27 offen lds
    s_add_u32 s27, s28, 6
    s_cmp_ge_u32 s27, 10
    s_cselect_b32 s29, 10, 0
    s_sub_u32 s27, s27, s29
    s_lshl_b32 s27, s27, 7
    s_add_u32 m0, s23, 9216
    s_nop 0
    buffer_load_dwordx4 v5, s[4:7], s27 offen lds
    s_add_u32 m0, m0, 1024
    s_nop 0
    buffer_load_dwordx4 v6, s[4:7], s27 offen lds
    s_add_u32 m0, m0, 1024
    s_nop 0
    buffer_load_dwordx4 v7, s[4:7], s27 offen lds
    s_waitcnt vmcnt(12)
    s_barrier
    s_lshl_b32 s27, s28, 1
    s_add_u32 s27, s27, 13
    s_cmp_ge_u32 s27, 20
    s_cselect_b32 s29, 20, 0
    s_sub_u32 s27, s27, s29
    s_mul_i32 s27, s27, 122880
    s_add_u32 s27, s27, s24
    s_add_u32 m0, s26, 15360
    s_nop 0
    buffer_load_dwordx4 v8, s[8:11], s27 offen lds
    s_add_u32 m0, m0, 1024
    s_nop 0
    buffer_load_dwordx4 v9, s[8:11], s27 offen lds
    s_add_u32 m0, m0, 1024
    s_nop 0
    buffer_load_dwordx4 v10, s[8:11], s27 offen lds
    s_add_u32 s27, s28, 7
    s_cmp_ge_u32 s27, 10
    s_cselect_b32 s29, 10, 0
    s_sub_u32 s27, s27, s29
    s_lshl_b32 s27, s27, 7
    s_add_u32 m0, s23, 18432
    s_nop 0
    buffer_load_dwordx4 v2, s[4:7], s27 offen lds
    s_add_u32 m0, m0, 1024
    s_nop 0
    buffer_load_dwordx4 v3, s[4:7], s27 offen lds
    s_add_u32 m0, m0, 1024
    s_nop 0
    buffer_load_dwordx4 v4, s[4:7], s27 offen lds
    s_waitcnt vmcnt(15)
    s_barrier
    s_lshl_b32 s27, s28, 1
    s_add_u32 s27, s27, 14
    s_cmp_ge_u32 s27, 20
    s_cselect_b32 s29, 20, 0
    s_sub_u32 s27, s27, s29
    s_mul_i32 s27, s27, 122880
    s_add_u32 s27, s27, s24
    s_add_u32 m0, s26, 30720
    s_nop 0
    buffer_load_dwordx4 v8, s[8:11], s27 offen lds
    s_add_u32 m0, m0, 1024
    s_nop 0
    buffer_load_dwordx4 v9, s[8:11], s27 offen lds
    s_add_u32 m0, m0, 1024
    s_nop 0
    buffer_load_dwordx4 v10, s[8:11], s27 offen lds
    s_add_u32 s27, s28, 7
    s_cmp_ge_u32 s27, 10
    s_cselect_b32 s29, 10, 0
    s_sub_u32 s27, s27, s29
    s_lshl_b32 s27, s27, 7
    s_add_u32 m0, s23, 27648
    s_nop 0
    buffer_load_dwordx4 v5, s[4:7], s27 offen lds
    s_add_u32 m0, m0, 1024
    s_nop 0
    buffer_load_dwordx4 v6, s[4:7], s27 offen lds
    s_add_u32 m0, m0, 1024
    s_nop 0
    buffer_load_dwordx4 v7, s[4:7], s27 offen lds
    s_waitcnt vmcnt(12)
    s_barrier
    s_lshl_b32 s27, s28, 1
    s_add_u32 s27, s27, 15
    s_cmp_ge_u32 s27, 20
    s_cselect_b32 s29, 20, 0
    s_sub_u32 s27, s27, s29
    s_mul_i32 s27, s27, 122880
    s_add_u32 s27, s27, s24
    s_add_u32 m0, s26, 46080
    s_nop 0
    buffer_load_dwordx4 v8, s[8:11], s27 offen lds
    s_add_u32 m0, m0, 1024
    s_nop 0
    buffer_load_dwordx4 v9, s[8:11], s27 offen lds
    s_add_u32 m0, m0, 1024
    s_nop 0
    buffer_load_dwordx4 v10, s[8:11], s27 offen lds
    s_add_u32 s27, s28, 8
    s_cmp_ge_u32 s27, 10
    s_cselect_b32 s29, 10, 0
    s_sub_u32 s27, s27, s29
    s_lshl_b32 s27, s27, 7
    s_add_u32 m0, s23, 36864
    s_nop 0
    buffer_load_dwordx4 v2, s[4:7], s27 offen lds
    s_add_u32 m0, m0, 1024
    s_nop 0
    buffer_load_dwordx4 v3, s[4:7], s27 offen lds
    s_add_u32 m0, m0, 1024
    s_nop 0
    buffer_load_dwordx4 v4, s[4:7], s27 offen lds
    s_waitcnt vmcnt(15)
    s_barrier
    s_lshl_b32 s27, s28, 1
    s_add_u32 s27, s27, 16
    s_cmp_ge_u32 s27, 20
    s_cselect_b32 s29, 20, 0
    s_sub_u32 s27, s27, s29
    s_mul_i32 s27, s27, 122880
    s_add_u32 s27, s27, s24
    s_add_u32 m0, s26, 61440
    s_nop 0
    buffer_load_dwordx4 v8, s[8:11], s27 offen lds
    s_add_u32 m0, m0, 1024
    s_nop 0
    buffer_load_dwordx4 v9, s[8:11], s27 offen lds
    s_add_u32 m0, m0, 1024
    s_nop 0
    buffer_load_dwordx4 v10, s[8:11], s27 offen lds
    s_add_u32 s27, s28, 8
    s_cmp_ge_u32 s27, 10
    s_cselect_b32 s29, 10, 0
    s_sub_u32 s27, s27, s29
    s_lshl_b32 s27, s27, 7
    s_add_u32 m0, s23, 46080
    s_nop 0
    buffer_load_dwordx4 v5, s[4:7], s27 offen lds
    s_add_u32 m0, m0, 1024
    s_nop 0
    buffer_load_dwordx4 v6, s[4:7], s27 offen lds
    s_add_u32 m0, m0, 1024
    s_nop 0
    buffer_load_dwordx4 v7, s[4:7], s27 offen lds
    s_waitcnt vmcnt(12)
    s_barrier
    s_lshl_b32 s27, s28, 1
    s_add_u32 s27, s27, 17
    s_cmp_ge_u32 s27, 20
    s_cselect_b32 s29, 20, 0
    s_sub_u32 s27, s27, s29
    s_mul_i32 s27, s27, 122880
    s_add_u32 s27, s27, s24
    s_add_u32 m0, s26, 76800
    s_nop 0
    buffer_load_dwordx4 v8, s[8:11], s27 offen lds
    s_add_u32 m0, m0, 1024
    s_nop 0
    buffer_load_dwordx4 v9, s[8:11], s27 offen lds
    s_add_u32 m0, m0, 1024
    s_nop 0
    buffer_load_dwordx4 v10, s[8:11], s27 offen lds
    s_add_u32 s27, s28, 9
    s_cmp_ge_u32 s27, 10
    s_cselect_b32 s29, 10, 0
    s_sub_u32 s27, s27, s29
    s_lshl_b32 s27, s27, 7
    s_add_u32 m0, s23, 0
    s_nop 0
    buffer_load_dwordx4 v2, s[4:7], s27 offen lds
    s_add_u32 m0, m0, 1024
    s_nop 0
    buffer_load_dwordx4 v3, s[4:7], s27 offen lds
    s_add_u32 m0, m0, 1024
    s_nop 0
    buffer_load_dwordx4 v4, s[4:7], s27 offen lds
    s_waitcnt vmcnt(15)
    s_barrier
    s_lshl_b32 s27, s28, 1
    s_add_u32 s27, s27, 18
    s_cmp_ge_u32 s27, 20
    s_cselect_b32 s29, 20, 0
    s_sub_u32 s27, s27, s29
    s_mul_i32 s27, s27, 122880
    s_add_u32 s27, s27, s24
    s_add_u32 m0, s26, 0
    s_nop 0
    buffer_load_dwordx4 v8, s[8:11], s27 offen lds
    s_add_u32 m0, m0, 1024
    s_nop 0
    buffer_load_dwordx4 v9, s[8:11], s27 offen lds
    s_add_u32 m0, m0, 1024
    s_nop 0
    buffer_load_dwordx4 v10, s[8:11], s27 offen lds
    s_add_u32 s27, s28, 9
    s_cmp_ge_u32 s27, 10
    s_cselect_b32 s29, 10, 0
    s_sub_u32 s27, s27, s29
    s_lshl_b32 s27, s27, 7
    s_add_u32 m0, s23, 9216
    s_nop 0
    buffer_load_dwordx4 v5, s[4:7], s27 offen lds
    s_add_u32 m0, m0, 1024
    s_nop 0
    buffer_load_dwordx4 v6, s[4:7], s27 offen lds
    s_add_u32 m0, m0, 1024
    s_nop 0
    buffer_load_dwordx4 v7, s[4:7], s27 offen lds
    s_waitcnt vmcnt(12)
    s_barrier
    s_lshl_b32 s27, s28, 1
    s_add_u32 s27, s27, 19
    s_cmp_ge_u32 s27, 20
    s_cselect_b32 s29, 20, 0
    s_sub_u32 s27, s27, s29
    s_mul_i32 s27, s27, 122880
    s_add_u32 s27, s27, s24
    s_add_u32 m0, s26, 15360
    s_nop 0
    buffer_load_dwordx4 v8, s[8:11], s27 offen lds
    s_add_u32 m0, m0, 1024
    s_nop 0
    buffer_load_dwordx4 v9, s[8:11], s27 offen lds
    s_add_u32 m0, m0, 1024
    s_nop 0
    buffer_load_dwordx4 v10, s[8:11], s27 offen lds
    s_waitcnt vmcnt(12)
    s_barrier
    s_mov_b32 s4, s52
    s_mov_b32 s5, s53
    s_mov_b32 s6, 8388608
    s_mov_b32 s7, 0x20000
    s_and_b32 s40, s2, 7
    s_lshr_b32 s40, s40, 1
    s_lshl_b32 s40, s40, 14
    s_lshr_b32 s41, s2, 3
    s_and_b32 s41, s41, 15
    s_lshl_b32 s41, s41, 10
    s_add_u32 s40, s40, s41
    s_sub_u32 s41, s16, 4
    s_lshl_b32 s41, s41, 8
    s_add_u32 s40, s40, s41
    s_lshl_b32 s40, s40, 7
    v_lshlrev_b32 v249, 7, v0
    buffer_load_dword v250, v249, s[4:7], s40 offen
    s_waitcnt vmcnt(4)
    s_barrier
    s_add_u32 s40, s40, 8192
    buffer_load_dword v251, v249, s[4:7], s40 offen
    s_waitcnt vmcnt(2)
    s_barrier
    s_add_u32 s40, s40, 8192
    buffer_load_dword v250, v249, s[4:7], s40 offen
    s_barrier
    s_add_u32 s40, s40, 8192
    buffer_load_dword v251, v249, s[4:7], s40 offen
    s_barrier
    s_branch K1_att
K1_qcomp:
    s_cmp_eq_u32 s16, 1
    s_cbranch_scc1 K1_q10
    s_cmp_eq_u32 s16, 2
    s_cbranch_scc1 K1_q01
    s_cmp_eq_u32 s16, 3
    s_cbranch_scc1 K1_q11
    v_and_b32 v14, 15, v0
    v_lshrrev_b32 v15, 4, v0
    v_and_b32 v6, 7, v14
    v_xor_b32 v6, v15, v6
    v_lshlrev_b32 v14, 7, v14
    v_lshl_add_u32 v2, v6, 4, v14
    v_xor_b32 v3, 64, v2
    v_lshrrev_b32 v6, 1, v15
    v_lshlrev_b32 v6, 4, v6
    v_and_b32 v7, 1, v15
    v_lshl_add_u32 v6, v7, 2, v6
    v_lshrrev_b32 v7, 2, v0
    v_and_b32 v7, 3, v7
    v_add_u32 v6, v6, v7
    v_mul_u32_u24 v6, 480, v6
    v_and_b32 v7, 3, v0
    v_lshl_add_u32 v6, v7, 3, v6
    v_add_u32 v4, 55296, v6
    v_add_u32 v5, 101376, v6
    v_mov_b32 v120, 0
    v_mov_b32 v121, 0
    v_mov_b32 v122, 0
    v_mov_b32 v123, 0
    v_mov_b32 v124, 0
    v_mov_b32 v125, 0
    v_mov_b32 v126, 0
    v_mov_b32 v127, 0
    v_mov_b32 v128, 0
    v_mov_b32 v129, 0
    v_mov_b32 v130, 0
    v_mov_b32 v131, 0
    v_mov_b32 v132, 0
    v_mov_b32 v133, 0
    v_mov_b32 v134, 0
    v_mov_b32 v135, 0
    v_mov_b32 v136, 0
    v_mov_b32 v137, 0
    v_mov_b32 v138, 0
    v_mov_b32 v139, 0
    v_mov_b32 v140, 0
    v_mov_b32 v141, 0
    v_mov_b32 v142, 0
    v_mov_b32 v143, 0
    v_mov_b32 v144, 0
    v_mov_b32 v145, 0
    v_mov_b32 v146, 0
    v_mov_b32 v147, 0
    v_mov_b32 v148, 0
    v_mov_b32 v149, 0
    v_mov_b32 v150, 0
    v_mov_b32 v151, 0
    v_mov_b32 v152, 0
    v_mov_b32 v153, 0
    v_mov_b32 v154, 0
    v_mov_b32 v155, 0
    v_mov_b32 v156, 0
    v_mov_b32 v157, 0
    v_mov_b32 v158, 0
    v_mov_b32 v159, 0
    v_mov_b32 v160, 0
    v_mov_b32 v161, 0
    v_mov_b32 v162, 0
    v_mov_b32 v163, 0
    v_mov_b32 v164, 0
    v_mov_b32 v165, 0
    v_mov_b32 v166, 0
    v_mov_b32 v167, 0
    v_mov_b32 v168, 0
    v_mov_b32 v169, 0
    v_mov_b32 v170, 0
    v_mov_b32 v171, 0
    v_mov_b32 v172, 0
    v_mov_b32 v173, 0
    v_mov_b32 v174, 0
    v_mov_b32 v175, 0
    v_mov_b32 v176, 0
    v_mov_b32 v177, 0
    v_mov_b32 v178, 0
    v_mov_b32 v179, 0
    v_mov_b32 v180, 0
    v_mov_b32 v181, 0
    v_mov_b32 v182, 0
    v_mov_b32 v183, 0
    v_mov_b32 v184, 0
    v_mov_b32 v185, 0
    v_mov_b32 v186, 0
    v_mov_b32 v187, 0
    v_mov_b32 v188, 0
    v_mov_b32 v189, 0
    v_mov_b32 v190, 0
    v_mov_b32 v191, 0
    v_mov_b32 v192, 0
    v_mov_b32 v193, 0
    v_mov_b32 v194, 0
    v_mov_b32 v195, 0
    v_mov_b32 v196, 0
    v_mov_b32 v197, 0
    v_mov_b32 v198, 0
    v_mov_b32 v199, 0
    v_mov_b32 v200, 0
    v_mov_b32 v201, 0
    v_mov_b32 v202, 0
    v_mov_b32 v203, 0
    v_mov_b32 v204, 0
    v_mov_b32 v205, 0
    v_mov_b32 v206, 0
    v_mov_b32 v207, 0
    v_mov_b32 v208, 0
    v_mov_b32 v209, 0
    v_mov_b32 v210, 0
    v_mov_b32 v211, 0
    v_mov_b32 v212, 0
    v_mov_b32 v213, 0
    v_mov_b32 v214, 0
    v_mov_b32 v215, 0
    v_mov_b32 v216, 0
    v_mov_b32 v217, 0
    v_mov_b32 v218, 0
    v_mov_b32 v219, 0
    v_mov_b32 v220, 0
    v_mov_b32 v221, 0
    v_mov_b32 v222, 0
    v_mov_b32 v223, 0
    v_mov_b32 v224, 0
    v_mov_b32 v225, 0
    v_mov_b32 v226, 0
    v_mov_b32 v227, 0
    v_mov_b32 v228, 0
    v_mov_b32 v229, 0
    v_mov_b32 v230, 0
    v_mov_b32 v231, 0
    v_mov_b32 v232, 0
    v_mov_b32 v233, 0
    v_mov_b32 v234, 0
    v_mov_b32 v235, 0
    v_mov_b32 v236, 0
    v_mov_b32 v237, 0
    v_mov_b32 v238, 0
    v_mov_b32 v239, 0
    v_mov_b32 v240, 0
    v_mov_b32 v241, 0
    v_mov_b32 v242, 0
    v_mov_b32 v243, 0
    v_mov_b32 v244, 0
    v_mov_b32 v245, 0
    v_mov_b32 v246, 0
    v_mov_b32 v247, 0
    v_mov_b32 v248, 0
    v_mov_b32 v249, 0
    v_mov_b32 v250, 0
    v_mov_b32 v251, 0
    v_mov_b32 v252, 0
    v_mov_b32 v253, 0
    v_mov_b32 v254, 0
    v_mov_b32 v255, 0
    s_barrier
    ds_read_b128 v[16:19], v2 offset:2048
    ds_read_b128 v[20:23], v2 offset:4096
    ds_read_b128 v[24:27], v2 offset:6144
    ds_read_b128 v[28:31], v2 offset:8192
    ds_read_b128 v[32:35], v2 offset:0
    ds_read_b64_tr_b16 v[36:37], v4 offset:0
    ds_read_b64_tr_b16 v[38:39], v4 offset:3840
    ds_read_b64_tr_b16 v[40:41], v4 offset:32
    ds_read_b64_tr_b16 v[42:43], v4 offset:3872
    ds_read_b64_tr_b16 v[44:45], v4 offset:64
    ds_read_b64_tr_b16 v[46:47], v4 offset:3904
    ds_read_b64_tr_b16 v[48:49], v4 offset:96
    ds_read_b64_tr_b16 v[50:51], v4 offset:3936
    ds_read_b64_tr_b16 v[52:53], v4 offset:128
    ds_read_b64_tr_b16 v[54:55], v4 offset:3968
    ds_read_b64_tr_b16 v[56:57], v4 offset:160
    ds_read_b64_tr_b16 v[58:59], v4 offset:4000
    ds_read_b64_tr_b16 v[60:61], v4 offset:192
    ds_read_b64_tr_b16 v[62:63], v4 offset:4032
    ds_read_b64_tr_b16 v[64:65], v4 offset:224
    ds_read_b64_tr_b16 v[66:67], v4 offset:4064
    s_waitcnt lgkmcnt(0)
    s_barrier
    s_mov_b32 s26, 0
K1q00_cloop:
    v_mfma_f32_16x16x32_bf16 v[120:123], v[36:39], v[16:19], v[120:123]
    ds_read_b128 v[68:71], v3 offset:2048
    v_mfma_f32_16x16x32_bf16 v[124:127], v[40:43], v[16:19], v[124:127]
    ds_read_b128 v[72:75], v3 offset:4096
    v_mfma_f32_16x16x32_bf16 v[128:131], v[44:47], v[16:19], v[128:131]
    ds_read_b128 v[76:79], v3 offset:6144
    v_mfma_f32_16x16x32_bf16 v[132:135], v[48:51], v[16:19], v[132:135]
    ds_read_b128 v[80:83], v3 offset:8192
    v_mfma_f32_16x16x32_bf16 v[136:139], v[52:55], v[16:19], v[136:139]
    ds_read_b128 v[84:87], v3 offset:0
    v_mfma_f32_16x16x32_bf16 v[140:143], v[56:59], v[16:19], v[140:143]
    ds_read_b64_tr_b16 v[88:89], v4 offset:15360
    v_mfma_f32_16x16x32_bf16 v[144:147], v[60:63], v[16:19], v[144:147]
    ds_read_b64_tr_b16 v[90:91], v4 offset:19200
    v_mfma_f32_16x16x32_bf16 v[148:151], v[64:67], v[16:19], v[148:151]
    ds_read_b64_tr_b16 v[92:93], v4 offset:15392
    v_mfma_f32_16x16x32_bf16 v[152:155], v[36:39], v[20:23], v[152:155]
    ds_read_b64_tr_b16 v[94:95], v4 offset:19232
    v_mfma_f32_16x16x32_bf16 v[156:159], v[40:43], v[20:23], v[156:159]
    ds_read_b64_tr_b16 v[96:97], v4 offset:15424
    v_mfma_f32_16x16x32_bf16 v[160:163], v[44:47], v[20:23], v[160:163]
    ds_read_b64_tr_b16 v[98:99], v4 offset:19264
    v_mfma_f32_16x16x32_bf16 v[164:167], v[48:51], v[20:23], v[164:167]
    ds_read_b64_tr_b16 v[100:101], v4 offset:15456
    v_mfma_f32_16x16x32_bf16 v[168:171], v[52:55], v[20:23], v[168:171]
    ds_read_b64_tr_b16 v[102:103], v4 offset:19296
    v_mfma_f32_16x16x32_bf16 v[172:175], v[56:59], v[20:23], v[172:175]
    ds_read_b64_tr_b16 v[104:105], v4 offset:15488
    v_mfma_f32_16x16x32_bf16 v[176:179], v[60:63], v[20:23], v[176:179]
    ds_read_b64_tr_b16 v[106:107], v4 offset:19328
    v_mfma_f32_16x16x32_bf16 v[180:183], v[64:67], v[20:23], v[180:183]
    ds_read_b64_tr_b16 v[108:109], v4 offset:15520
    v_mfma_f32_16x16x32_bf16 v[184:187], v[36:39], v[24:27], v[184:187]
    ds_read_b64_tr_b16 v[110:111], v4 offset:19360
    v_mfma_f32_16x16x32_bf16 v[188:191], v[40:43], v[24:27], v[188:191]
    ds_read_b64_tr_b16 v[112:113], v4 offset:15552
    v_mfma_f32_16x16x32_bf16 v[192:195], v[44:47], v[24:27], v[192:195]
    ds_read_b64_tr_b16 v[114:115], v4 offset:19392
    v_mfma_f32_16x16x32_bf16 v[196:199], v[48:51], v[24:27], v[196:199]
    ds_read_b64_tr_b16 v[116:117], v4 offset:15584
    v_mfma_f32_16x16x32_bf16 v[200:203], v[52:55], v[24:27], v[200:203]
    ds_read_b64_tr_b16 v[118:119], v4 offset:19424
    v_mfma_f32_16x16x32_bf16 v[204:207], v[56:59], v[24:27], v[204:207]
    v_mfma_f32_16x16x32_bf16 v[208:211], v[60:63], v[24:27], v[208:211]
    v_mfma_f32_16x16x32_bf16 v[212:215], v[64:67], v[24:27], v[212:215]
    v_mfma_f32_16x16x32_bf16 v[216:219], v[36:39], v[28:31], v[216:219]
    v_mfma_f32_16x16x32_bf16 v[220:223], v[40:43], v[28:31], v[220:223]
    s_waitcnt lgkmcnt(0)
    s_barrier
    v_mfma_f32_16x16x32_bf16 v[224:227], v[44:47], v[28:31], v[224:227]
    v_mfma_f32_16x16x32_bf16 v[228:231], v[48:51], v[28:31], v[228:231]
    v_mfma_f32_16x16x32_bf16 v[232:235], v[52:55], v[28:31], v[232:235]
    v_mfma_f32_16x16x32_bf16 v[236:239], v[56:59], v[28:31], v[236:239]
    v_mfma_f32_16x16x32_bf16 v[240:243], v[60:63], v[28:31], v[240:243]
    v_mfma_f32_16x16x32_bf16 v[244:247], v[64:67], v[28:31], v[244:247]
    v_mfma_f32_16x16x32_bf16 v[248:251], v[56:59], v[32:35], v[248:251]
    v_mfma_f32_16x16x32_bf16 v[252:255], v[60:63], v[32:35], v[252:255]
    v_mfma_f32_16x16x32_bf16 v[120:123], v[88:91], v[68:71], v[120:123]
    ds_read_b128 v[16:19], v2 offset:20480
    v_mfma_f32_16x16x32_bf16 v[124:127], v[92:95], v[68:71], v[124:127]
    ds_read_b128 v[20:23], v2 offset:22528
    v_mfma_f32_16x16x32_bf16 v[128:131], v[96:99], v[68:71], v[128:131]
    ds_read_b128 v[24:27], v2 offset:24576
    v_mfma_f32_16x16x32_bf16 v[132:135], v[100:103], v[68:71], v[132:135]
    ds_read_b128 v[28:31], v2 offset:26624
    v_mfma_f32_16x16x32_bf16 v[136:139], v[104:107], v[68:71], v[136:139]
    ds_read_b128 v[32:35], v2 offset:18432
    v_mfma_f32_16x16x32_bf16 v[140:143], v[108:111], v[68:71], v[140:143]
    ds_read_b64_tr_b16 v[36:37], v4 offset:30720
    v_mfma_f32_16x16x32_bf16 v[144:147], v[112:115], v[68:71], v[144:147]
    ds_read_b64_tr_b16 v[38:39], v4 offset:34560
    v_mfma_f32_16x16x32_bf16 v[148:151], v[116:119], v[68:71], v[148:151]
    ds_read_b64_tr_b16 v[40:41], v4 offset:30752
    v_mfma_f32_16x16x32_bf16 v[152:155], v[88:91], v[72:75], v[152:155]
    ds_read_b64_tr_b16 v[42:43], v4 offset:34592
    v_mfma_f32_16x16x32_bf16 v[156:159], v[92:95], v[72:75], v[156:159]
    ds_read_b64_tr_b16 v[44:45], v4 offset:30784
    v_mfma_f32_16x16x32_bf16 v[160:163], v[96:99], v[72:75], v[160:163]
    ds_read_b64_tr_b16 v[46:47], v4 offset:34624
    v_mfma_f32_16x16x32_bf16 v[164:167], v[100:103], v[72:75], v[164:167]
    ds_read_b64_tr_b16 v[48:49], v4 offset:30816
    v_mfma_f32_16x16x32_bf16 v[168:171], v[104:107], v[72:75], v[168:171]
    ds_read_b64_tr_b16 v[50:51], v4 offset:34656
    v_mfma_f32_16x16x32_bf16 v[172:175], v[108:111], v[72:75], v[172:175]
    ds_read_b64_tr_b16 v[52:53], v4 offset:30848
    v_mfma_f32_16x16x32_bf16 v[176:179], v[112:115], v[72:75], v[176:179]
    ds_read_b64_tr_b16 v[54:55], v4 offset:34688
    v_mfma_f32_16x16x32_bf16 v[180:183], v[116:119], v[72:75], v[180:183]
    ds_read_b64_tr_b16 v[56:57], v4 offset:30880
    v_mfma_f32_16x16x32_bf16 v[184:187], v[88:91], v[76:79], v[184:187]
    ds_read_b64_tr_b16 v[58:59], v4 offset:34720
    v_mfma_f32_16x16x32_bf16 v[188:191], v[92:95], v[76:79], v[188:191]
    ds_read_b64_tr_b16 v[60:61], v4 offset:30912
    v_mfma_f32_16x16x32_bf16 v[192:195], v[96:99], v[76:79], v[192:195]
    ds_read_b64_tr_b16 v[62:63], v4 offset:34752
    v_mfma_f32_16x16x32_bf16 v[196:199], v[100:103], v[76:79], v[196:199]
    ds_read_b64_tr_b16 v[64:65], v4 offset:30944
    v_mfma_f32_16x16x32_bf16 v[200:203], v[104:107], v[76:79], v[200:203]
    ds_read_b64_tr_b16 v[66:67], v4 offset:34784
    v_mfma_f32_16x16x32_bf16 v[204:207], v[108:111], v[76:79], v[204:207]
    v_mfma_f32_16x16x32_bf16 v[208:211], v[112:115], v[76:79], v[208:211]
    v_mfma_f32_16x16x32_bf16 v[212:215], v[116:119], v[76:79], v[212:215]
    v_mfma_f32_16x16x32_bf16 v[216:219], v[88:91], v[80:83], v[216:219]
    v_mfma_f32_16x16x32_bf16 v[220:223], v[92:95], v[80:83], v[220:223]
    s_waitcnt lgkmcnt(0)
    s_barrier
    v_mfma_f32_16x16x32_bf16 v[224:227], v[96:99], v[80:83], v[224:227]
    v_mfma_f32_16x16x32_bf16 v[228:231], v[100:103], v[80:83], v[228:231]
    v_mfma_f32_16x16x32_bf16 v[232:235], v[104:107], v[80:83], v[232:235]
    v_mfma_f32_16x16x32_bf16 v[236:239], v[108:111], v[80:83], v[236:239]
    v_mfma_f32_16x16x32_bf16 v[240:243], v[112:115], v[80:83], v[240:243]
    v_mfma_f32_16x16x32_bf16 v[244:247], v[116:119], v[80:83], v[244:247]
    v_mfma_f32_16x16x32_bf16 v[248:251], v[108:111], v[84:87], v[248:251]
    v_mfma_f32_16x16x32_bf16 v[252:255], v[112:115], v[84:87], v[252:255]
    v_mfma_f32_16x16x32_bf16 v[120:123], v[36:39], v[16:19], v[120:123]
    ds_read_b128 v[68:71], v3 offset:20480
    v_mfma_f32_16x16x32_bf16 v[124:127], v[40:43], v[16:19], v[124:127]
    ds_read_b128 v[72:75], v3 offset:22528
    v_mfma_f32_16x16x32_bf16 v[128:131], v[44:47], v[16:19], v[128:131]
    ds_read_b128 v[76:79], v3 offset:24576
    v_mfma_f32_16x16x32_bf16 v[132:135], v[48:51], v[16:19], v[132:135]
    ds_read_b128 v[80:83], v3 offset:26624
    v_mfma_f32_16x16x32_bf16 v[136:139], v[52:55], v[16:19], v[136:139]
    ds_read_b128 v[84:87], v3 offset:18432
    v_mfma_f32_16x16x32_bf16 v[140:143], v[56:59], v[16:19], v[140:143]
    ds_read_b64_tr_b16 v[88:89], v5 offset:0
    v_mfma_f32_16x16x32_bf16 v[144:147], v[60:63], v[16:19], v[144:147]
    ds_read_b64_tr_b16 v[90:91], v5 offset:3840
    v_mfma_f32_16x16x32_bf16 v[148:151], v[64:67], v[16:19], v[148:151]
    ds_read_b64_tr_b16 v[92:93], v5 offset:32
    v_mfma_f32_16x16x32_bf16 v[152:155], v[36:39], v[20:23], v[152:155]
    ds_read_b64_tr_b16 v[94:95], v5 offset:3872
    v_mfma_f32_16x16x32_bf16 v[156:159], v[40:43], v[20:23], v[156:159]
    ds_read_b64_tr_b16 v[96:97], v5 offset:64
    v_mfma_f32_16x16x32_bf16 v[160:163], v[44:47], v[20:23], v[160:163]
    ds_read_b64_tr_b16 v[98:99], v5 offset:3904
    v_mfma_f32_16x16x32_bf16 v[164:167], v[48:51], v[20:23], v[164:167]
    ds_read_b64_tr_b16 v[100:101], v5 offset:96
    v_mfma_f32_16x16x32_bf16 v[168:171], v[52:55], v[20:23], v[168:171]
    ds_read_b64_tr_b16 v[102:103], v5 offset:3936
    v_mfma_f32_16x16x32_bf16 v[172:175], v[56:59], v[20:23], v[172:175]
    ds_read_b64_tr_b16 v[104:105], v5 offset:128
    v_mfma_f32_16x16x32_bf16 v[176:179], v[60:63], v[20:23], v[176:179]
    ds_read_b64_tr_b16 v[106:107], v5 offset:3968
    v_mfma_f32_16x16x32_bf16 v[180:183], v[64:67], v[20:23], v[180:183]
    ds_read_b64_tr_b16 v[108:109], v5 offset:160
    v_mfma_f32_16x16x32_bf16 v[184:187], v[36:39], v[24:27], v[184:187]
    ds_read_b64_tr_b16 v[110:111], v5 offset:4000
    v_mfma_f32_16x16x32_bf16 v[188:191], v[40:43], v[24:27], v[188:191]
    ds_read_b64_tr_b16 v[112:113], v5 offset:192
    v_mfma_f32_16x16x32_bf16 v[192:195], v[44:47], v[24:27], v[192:195]
    ds_read_b64_tr_b16 v[114:115], v5 offset:4032
    v_mfma_f32_16x16x32_bf16 v[196:199], v[48:51], v[24:27], v[196:199]
    ds_read_b64_tr_b16 v[116:117], v5 offset:224
    v_mfma_f32_16x16x32_bf16 v[200:203], v[52:55], v[24:27], v[200:203]
    ds_read_b64_tr_b16 v[118:119], v5 offset:4064
    v_mfma_f32_16x16x32_bf16 v[204:207], v[56:59], v[24:27], v[204:207]
    v_mfma_f32_16x16x32_bf16 v[208:211], v[60:63], v[24:27], v[208:211]
    v_mfma_f32_16x16x32_bf16 v[212:215], v[64:67], v[24:27], v[212:215]
    v_mfma_f32_16x16x32_bf16 v[216:219], v[36:39], v[28:31], v[216:219]
    v_mfma_f32_16x16x32_bf16 v[220:223], v[40:43], v[28:31], v[220:223]
    s_waitcnt lgkmcnt(0)
    s_barrier
    v_mfma_f32_16x16x32_bf16 v[224:227], v[44:47], v[28:31], v[224:227]
    v_mfma_f32_16x16x32_bf16 v[228:231], v[48:51], v[28:31], v[228:231]
    v_mfma_f32_16x16x32_bf16 v[232:235], v[52:55], v[28:31], v[232:235]
    v_mfma_f32_16x16x32_bf16 v[236:239], v[56:59], v[28:31], v[236:239]
    v_mfma_f32_16x16x32_bf16 v[240:243], v[60:63], v[28:31], v[240:243]
    v_mfma_f32_16x16x32_bf16 v[244:247], v[64:67], v[28:31], v[244:247]
    v_mfma_f32_16x16x32_bf16 v[248:251], v[56:59], v[32:35], v[248:251]
    v_mfma_f32_16x16x32_bf16 v[252:255], v[60:63], v[32:35], v[252:255]
    v_mfma_f32_16x16x32_bf16 v[120:123], v[88:91], v[68:71], v[120:123]
    ds_read_b128 v[16:19], v2 offset:38912
    v_mfma_f32_16x16x32_bf16 v[124:127], v[92:95], v[68:71], v[124:127]
    ds_read_b128 v[20:23], v2 offset:40960
    v_mfma_f32_16x16x32_bf16 v[128:131], v[96:99], v[68:71], v[128:131]
    ds_read_b128 v[24:27], v2 offset:43008
    v_mfma_f32_16x16x32_bf16 v[132:135], v[100:103], v[68:71], v[132:135]
    ds_read_b128 v[28:31], v2 offset:45056
    v_mfma_f32_16x16x32_bf16 v[136:139], v[104:107], v[68:71], v[136:139]
    ds_read_b128 v[32:35], v2 offset:36864
    v_mfma_f32_16x16x32_bf16 v[140:143], v[108:111], v[68:71], v[140:143]
    ds_read_b64_tr_b16 v[36:37], v5 offset:15360
    v_mfma_f32_16x16x32_bf16 v[144:147], v[112:115], v[68:71], v[144:147]
    ds_read_b64_tr_b16 v[38:39], v5 offset:19200
    v_mfma_f32_16x16x32_bf16 v[148:151], v[116:119], v[68:71], v[148:151]
    ds_read_b64_tr_b16 v[40:41], v5 offset:15392
    v_mfma_f32_16x16x32_bf16 v[152:155], v[88:91], v[72:75], v[152:155]
    ds_read_b64_tr_b16 v[42:43], v5 offset:19232
    v_mfma_f32_16x16x32_bf16 v[156:159], v[92:95], v[72:75], v[156:159]
    ds_read_b64_tr_b16 v[44:45], v5 offset:15424
    v_mfma_f32_16x16x32_bf16 v[160:163], v[96:99], v[72:75], v[160:163]
    ds_read_b64_tr_b16 v[46:47], v5 offset:19264
    v_mfma_f32_16x16x32_bf16 v[164:167], v[100:103], v[72:75], v[164:167]
    ds_read_b64_tr_b16 v[48:49], v5 offset:15456
    v_mfma_f32_16x16x32_bf16 v[168:171], v[104:107], v[72:75], v[168:171]
    ds_read_b64_tr_b16 v[50:51], v5 offset:19296
    v_mfma_f32_16x16x32_bf16 v[172:175], v[108:111], v[72:75], v[172:175]
    ds_read_b64_tr_b16 v[52:53], v5 offset:15488
    v_mfma_f32_16x16x32_bf16 v[176:179], v[112:115], v[72:75], v[176:179]
    ds_read_b64_tr_b16 v[54:55], v5 offset:19328
    v_mfma_f32_16x16x32_bf16 v[180:183], v[116:119], v[72:75], v[180:183]
    ds_read_b64_tr_b16 v[56:57], v5 offset:15520
    v_mfma_f32_16x16x32_bf16 v[184:187], v[88:91], v[76:79], v[184:187]
    ds_read_b64_tr_b16 v[58:59], v5 offset:19360
    v_mfma_f32_16x16x32_bf16 v[188:191], v[92:95], v[76:79], v[188:191]
    ds_read_b64_tr_b16 v[60:61], v5 offset:15552
    v_mfma_f32_16x16x32_bf16 v[192:195], v[96:99], v[76:79], v[192:195]
    ds_read_b64_tr_b16 v[62:63], v5 offset:19392
    v_mfma_f32_16x16x32_bf16 v[196:199], v[100:103], v[76:79], v[196:199]
    ds_read_b64_tr_b16 v[64:65], v5 offset:15584
    v_mfma_f32_16x16x32_bf16 v[200:203], v[104:107], v[76:79], v[200:203]
    ds_read_b64_tr_b16 v[66:67], v5 offset:19424
    v_mfma_f32_16x16x32_bf16 v[204:207], v[108:111], v[76:79], v[204:207]
    v_mfma_f32_16x16x32_bf16 v[208:211], v[112:115], v[76:79], v[208:211]
    v_mfma_f32_16x16x32_bf16 v[212:215], v[116:119], v[76:79], v[212:215]
    v_mfma_f32_16x16x32_bf16 v[216:219], v[88:91], v[80:83], v[216:219]
    v_mfma_f32_16x16x32_bf16 v[220:223], v[92:95], v[80:83], v[220:223]
    s_waitcnt lgkmcnt(0)
    s_barrier
    v_mfma_f32_16x16x32_bf16 v[224:227], v[96:99], v[80:83], v[224:227]
    v_mfma_f32_16x16x32_bf16 v[228:231], v[100:103], v[80:83], v[228:231]
    v_mfma_f32_16x16x32_bf16 v[232:235], v[104:107], v[80:83], v[232:235]
    v_mfma_f32_16x16x32_bf16 v[236:239], v[108:111], v[80:83], v[236:239]
    v_mfma_f32_16x16x32_bf16 v[240:243], v[112:115], v[80:83], v[240:243]
    v_mfma_f32_16x16x32_bf16 v[244:247], v[116:119], v[80:83], v[244:247]
    v_mfma_f32_16x16x32_bf16 v[248:251], v[108:111], v[84:87], v[248:251]
    v_mfma_f32_16x16x32_bf16 v[252:255], v[112:115], v[84:87], v[252:255]
    v_mfma_f32_16x16x32_bf16 v[120:123], v[36:39], v[16:19], v[120:123]
    ds_read_b128 v[68:71], v3 offset:38912
    v_mfma_f32_16x16x32_bf16 v[124:127], v[40:43], v[16:19], v[124:127]
    ds_read_b128 v[72:75], v3 offset:40960
    v_mfma_f32_16x16x32_bf16 v[128:131], v[44:47], v[16:19], v[128:131]
    ds_read_b128 v[76:79], v3 offset:43008
    v_mfma_f32_16x16x32_bf16 v[132:135], v[48:51], v[16:19], v[132:135]
    ds_read_b128 v[80:83], v3 offset:45056
    v_mfma_f32_16x16x32_bf16 v[136:139], v[52:55], v[16:19], v[136:139]
    ds_read_b128 v[84:87], v3 offset:36864
    v_mfma_f32_16x16x32_bf16 v[140:143], v[56:59], v[16:19], v[140:143]
    ds_read_b64_tr_b16 v[88:89], v5 offset:30720
    v_mfma_f32_16x16x32_bf16 v[144:147], v[60:63], v[16:19], v[144:147]
    ds_read_b64_tr_b16 v[90:91], v5 offset:34560
    v_mfma_f32_16x16x32_bf16 v[148:151], v[64:67], v[16:19], v[148:151]
    ds_read_b64_tr_b16 v[92:93], v5 offset:30752
    v_mfma_f32_16x16x32_bf16 v[152:155], v[36:39], v[20:23], v[152:155]
    ds_read_b64_tr_b16 v[94:95], v5 offset:34592
    v_mfma_f32_16x16x32_bf16 v[156:159], v[40:43], v[20:23], v[156:159]
    ds_read_b64_tr_b16 v[96:97], v5 offset:30784
    v_mfma_f32_16x16x32_bf16 v[160:163], v[44:47], v[20:23], v[160:163]
    ds_read_b64_tr_b16 v[98:99], v5 offset:34624
    v_mfma_f32_16x16x32_bf16 v[164:167], v[48:51], v[20:23], v[164:167]
    ds_read_b64_tr_b16 v[100:101], v5 offset:30816
    v_mfma_f32_16x16x32_bf16 v[168:171], v[52:55], v[20:23], v[168:171]
    ds_read_b64_tr_b16 v[102:103], v5 offset:34656
    v_mfma_f32_16x16x32_bf16 v[172:175], v[56:59], v[20:23], v[172:175]
    ds_read_b64_tr_b16 v[104:105], v5 offset:30848
    v_mfma_f32_16x16x32_bf16 v[176:179], v[60:63], v[20:23], v[176:179]
    ds_read_b64_tr_b16 v[106:107], v5 offset:34688
    v_mfma_f32_16x16x32_bf16 v[180:183], v[64:67], v[20:23], v[180:183]
    ds_read_b64_tr_b16 v[108:109], v5 offset:30880
    v_mfma_f32_16x16x32_bf16 v[184:187], v[36:39], v[24:27], v[184:187]
    ds_read_b64_tr_b16 v[110:111], v5 offset:34720
    v_mfma_f32_16x16x32_bf16 v[188:191], v[40:43], v[24:27], v[188:191]
    ds_read_b64_tr_b16 v[112:113], v5 offset:30912
    v_mfma_f32_16x16x32_bf16 v[192:195], v[44:47], v[24:27], v[192:195]
    ds_read_b64_tr_b16 v[114:115], v5 offset:34752
    v_mfma_f32_16x16x32_bf16 v[196:199], v[48:51], v[24:27], v[196:199]
    ds_read_b64_tr_b16 v[116:117], v5 offset:30944
    v_mfma_f32_16x16x32_bf16 v[200:203], v[52:55], v[24:27], v[200:203]
    ds_read_b64_tr_b16 v[118:119], v5 offset:34784
    v_mfma_f32_16x16x32_bf16 v[204:207], v[56:59], v[24:27], v[204:207]
    v_mfma_f32_16x16x32_bf16 v[208:211], v[60:63], v[24:27], v[208:211]
    v_mfma_f32_16x16x32_bf16 v[212:215], v[64:67], v[24:27], v[212:215]
    v_mfma_f32_16x16x32_bf16 v[216:219], v[36:39], v[28:31], v[216:219]
    v_mfma_f32_16x16x32_bf16 v[220:223], v[40:43], v[28:31], v[220:223]
    s_waitcnt lgkmcnt(0)
    s_barrier
    v_mfma_f32_16x16x32_bf16 v[224:227], v[44:47], v[28:31], v[224:227]
    v_mfma_f32_16x16x32_bf16 v[228:231], v[48:51], v[28:31], v[228:231]
    v_mfma_f32_16x16x32_bf16 v[232:235], v[52:55], v[28:31], v[232:235]
    v_mfma_f32_16x16x32_bf16 v[236:239], v[56:59], v[28:31], v[236:239]
    v_mfma_f32_16x16x32_bf16 v[240:243], v[60:63], v[28:31], v[240:243]
    v_mfma_f32_16x16x32_bf16 v[244:247], v[64:67], v[28:31], v[244:247]
    v_mfma_f32_16x16x32_bf16 v[248:251], v[56:59], v[32:35], v[248:251]
    v_mfma_f32_16x16x32_bf16 v[252:255], v[60:63], v[32:35], v[252:255]
    v_mfma_f32_16x16x32_bf16 v[120:123], v[88:91], v[68:71], v[120:123]
    ds_read_b128 v[16:19], v2 offset:2048
    v_mfma_f32_16x16x32_bf16 v[124:127], v[92:95], v[68:71], v[124:127]
    ds_read_b128 v[20:23], v2 offset:4096
    v_mfma_f32_16x16x32_bf16 v[128:131], v[96:99], v[68:71], v[128:131]
    ds_read_b128 v[24:27], v2 offset:6144
    v_mfma_f32_16x16x32_bf16 v[132:135], v[100:103], v[68:71], v[132:135]
    ds_read_b128 v[28:31], v2 offset:8192
    v_mfma_f32_16x16x32_bf16 v[136:139], v[104:107], v[68:71], v[136:139]
    ds_read_b128 v[32:35], v2 offset:0
    v_mfma_f32_16x16x32_bf16 v[140:143], v[108:111], v[68:71], v[140:143]
    ds_read_b64_tr_b16 v[36:37], v4 offset:0
    v_mfma_f32_16x16x32_bf16 v[144:147], v[112:115], v[68:71], v[144:147]
    ds_read_b64_tr_b16 v[38:39], v4 offset:3840
    v_mfma_f32_16x16x32_bf16 v[148:151], v[116:119], v[68:71], v[148:151]
    ds_read_b64_tr_b16 v[40:41], v4 offset:32
    v_mfma_f32_16x16x32_bf16 v[152:155], v[88:91], v[72:75], v[152:155]
    ds_read_b64_tr_b16 v[42:43], v4 offset:3872
    v_mfma_f32_16x16x32_bf16 v[156:159], v[92:95], v[72:75], v[156:159]
    ds_read_b64_tr_b16 v[44:45], v4 offset:64
    v_mfma_f32_16x16x32_bf16 v[160:163], v[96:99], v[72:75], v[160:163]
    ds_read_b64_tr_b16 v[46:47], v4 offset:3904
    v_mfma_f32_16x16x32_bf16 v[164:167], v[100:103], v[72:75], v[164:167]
    ds_read_b64_tr_b16 v[48:49], v4 offset:96
    v_mfma_f32_16x16x32_bf16 v[168:171], v[104:107], v[72:75], v[168:171]
    ds_read_b64_tr_b16 v[50:51], v4 offset:3936
    v_mfma_f32_16x16x32_bf16 v[172:175], v[108:111], v[72:75], v[172:175]
    ds_read_b64_tr_b16 v[52:53], v4 offset:128
    v_mfma_f32_16x16x32_bf16 v[176:179], v[112:115], v[72:75], v[176:179]
    ds_read_b64_tr_b16 v[54:55], v4 offset:3968
    v_mfma_f32_16x16x32_bf16 v[180:183], v[116:119], v[72:75], v[180:183]
    ds_read_b64_tr_b16 v[56:57], v4 offset:160
    v_mfma_f32_16x16x32_bf16 v[184:187], v[88:91], v[76:79], v[184:187]
    ds_read_b64_tr_b16 v[58:59], v4 offset:4000
    v_mfma_f32_16x16x32_bf16 v[188:191], v[92:95], v[76:79], v[188:191]
    ds_read_b64_tr_b16 v[60:61], v4 offset:192
    v_mfma_f32_16x16x32_bf16 v[192:195], v[96:99], v[76:79], v[192:195]
    ds_read_b64_tr_b16 v[62:63], v4 offset:4032
    v_mfma_f32_16x16x32_bf16 v[196:199], v[100:103], v[76:79], v[196:199]
    ds_read_b64_tr_b16 v[64:65], v4 offset:224
    v_mfma_f32_16x16x32_bf16 v[200:203], v[104:107], v[76:79], v[200:203]
    ds_read_b64_tr_b16 v[66:67], v4 offset:4064
    v_mfma_f32_16x16x32_bf16 v[204:207], v[108:111], v[76:79], v[204:207]
    v_mfma_f32_16x16x32_bf16 v[208:211], v[112:115], v[76:79], v[208:211]
    v_mfma_f32_16x16x32_bf16 v[212:215], v[116:119], v[76:79], v[212:215]
    v_mfma_f32_16x16x32_bf16 v[216:219], v[88:91], v[80:83], v[216:219]
    v_mfma_f32_16x16x32_bf16 v[220:223], v[92:95], v[80:83], v[220:223]
    s_waitcnt lgkmcnt(0)
    s_barrier
    v_mfma_f32_16x16x32_bf16 v[224:227], v[96:99], v[80:83], v[224:227]
    v_mfma_f32_16x16x32_bf16 v[228:231], v[100:103], v[80:83], v[228:231]
    v_mfma_f32_16x16x32_bf16 v[232:235], v[104:107], v[80:83], v[232:235]
    v_mfma_f32_16x16x32_bf16 v[236:239], v[108:111], v[80:83], v[236:239]
    v_mfma_f32_16x16x32_bf16 v[240:243], v[112:115], v[80:83], v[240:243]
    v_mfma_f32_16x16x32_bf16 v[244:247], v[116:119], v[80:83], v[244:247]
    v_mfma_f32_16x16x32_bf16 v[248:251], v[108:111], v[84:87], v[248:251]
    v_mfma_f32_16x16x32_bf16 v[252:255], v[112:115], v[84:87], v[252:255]
    s_add_u32 s26, s26, 1
    s_cmp_lt_u32 s26, 3
    s_cbranch_scc1 K1q00_cloop
    v_mfma_f32_16x16x32_bf16 v[120:123], v[36:39], v[16:19], v[120:123]
    ds_read_b128 v[68:71], v3 offset:2048
    v_mfma_f32_16x16x32_bf16 v[124:127], v[40:43], v[16:19], v[124:127]
    ds_read_b128 v[72:75], v3 offset:4096
    v_mfma_f32_16x16x32_bf16 v[128:131], v[44:47], v[16:19], v[128:131]
    ds_read_b128 v[76:79], v3 offset:6144
    v_mfma_f32_16x16x32_bf16 v[132:135], v[48:51], v[16:19], v[132:135]
    ds_read_b128 v[80:83], v3 offset:8192
    v_mfma_f32_16x16x32_bf16 v[136:139], v[52:55], v[16:19], v[136:139]
    ds_read_b128 v[84:87], v3 offset:0
    v_mfma_f32_16x16x32_bf16 v[140:143], v[56:59], v[16:19], v[140:143]
    ds_read_b64_tr_b16 v[88:89], v4 offset:15360
    v_mfma_f32_16x16x32_bf16 v[144:147], v[60:63], v[16:19], v[144:147]
    ds_read_b64_tr_b16 v[90:91], v4 offset:19200
    v_mfma_f32_16x16x32_bf16 v[148:151], v[64:67], v[16:19], v[148:151]
    ds_read_b64_tr_b16 v[92:93], v4 offset:15392
    v_mfma_f32_16x16x32_bf16 v[152:155], v[36:39], v[20:23], v[152:155]
    ds_read_b64_tr_b16 v[94:95], v4 offset:19232
    v_mfma_f32_16x16x32_bf16 v[156:159], v[40:43], v[20:23], v[156:159]
    ds_read_b64_tr_b16 v[96:97], v4 offset:15424
    v_mfma_f32_16x16x32_bf16 v[160:163], v[44:47], v[20:23], v[160:163]
    ds_read_b64_tr_b16 v[98:99], v4 offset:19264
    v_mfma_f32_16x16x32_bf16 v[164:167], v[48:51], v[20:23], v[164:167]
    ds_read_b64_tr_b16 v[100:101], v4 offset:15456
    v_mfma_f32_16x16x32_bf16 v[168:171], v[52:55], v[20:23], v[168:171]
    ds_read_b64_tr_b16 v[102:103], v4 offset:19296
    v_mfma_f32_16x16x32_bf16 v[172:175], v[56:59], v[20:23], v[172:175]
    ds_read_b64_tr_b16 v[104:105], v4 offset:15488
    v_mfma_f32_16x16x32_bf16 v[176:179], v[60:63], v[20:23], v[176:179]
    ds_read_b64_tr_b16 v[106:107], v4 offset:19328
    v_mfma_f32_16x16x32_bf16 v[180:183], v[64:67], v[20:23], v[180:183]
    ds_read_b64_tr_b16 v[108:109], v4 offset:15520
    v_mfma_f32_16x16x32_bf16 v[184:187], v[36:39], v[24:27], v[184:187]
    ds_read_b64_tr_b16 v[110:111], v4 offset:19360
    v_mfma_f32_16x16x32_bf16 v[188:191], v[40:43], v[24:27], v[188:191]
    ds_read_b64_tr_b16 v[112:113], v4 offset:15552
    v_mfma_f32_16x16x32_bf16 v[192:195], v[44:47], v[24:27], v[192:195]
    ds_read_b64_tr_b16 v[114:115], v4 offset:19392
    v_mfma_f32_16x16x32_bf16 v[196:199], v[48:51], v[24:27], v[196:199]
    ds_read_b64_tr_b16 v[116:117], v4 offset:15584
    v_mfma_f32_16x16x32_bf16 v[200:203], v[52:55], v[24:27], v[200:203]
    ds_read_b64_tr_b16 v[118:119], v4 offset:19424
    v_mfma_f32_16x16x32_bf16 v[204:207], v[56:59], v[24:27], v[204:207]
    v_mfma_f32_16x16x32_bf16 v[208:211], v[60:63], v[24:27], v[208:211]
    v_mfma_f32_16x16x32_bf16 v[212:215], v[64:67], v[24:27], v[212:215]
    v_mfma_f32_16x16x32_bf16 v[216:219], v[36:39], v[28:31], v[216:219]
    v_mfma_f32_16x16x32_bf16 v[220:223], v[40:43], v[28:31], v[220:223]
    s_waitcnt lgkmcnt(0)
    s_barrier
    v_mfma_f32_16x16x32_bf16 v[224:227], v[44:47], v[28:31], v[224:227]
    v_mfma_f32_16x16x32_bf16 v[228:231], v[48:51], v[28:31], v[228:231]
    v_mfma_f32_16x16x32_bf16 v[232:235], v[52:55], v[28:31], v[232:235]
    v_mfma_f32_16x16x32_bf16 v[236:239], v[56:59], v[28:31], v[236:239]
    v_mfma_f32_16x16x32_bf16 v[240:243], v[60:63], v[28:31], v[240:243]
    v_mfma_f32_16x16x32_bf16 v[244:247], v[64:67], v[28:31], v[244:247]
    v_mfma_f32_16x16x32_bf16 v[248:251], v[56:59], v[32:35], v[248:251]
    v_mfma_f32_16x16x32_bf16 v[252:255], v[60:63], v[32:35], v[252:255]
    v_mfma_f32_16x16x32_bf16 v[120:123], v[88:91], v[68:71], v[120:123]
    v_mfma_f32_16x16x32_bf16 v[124:127], v[92:95], v[68:71], v[124:127]
    v_mfma_f32_16x16x32_bf16 v[128:131], v[96:99], v[68:71], v[128:131]
    v_mfma_f32_16x16x32_bf16 v[132:135], v[100:103], v[68:71], v[132:135]
    v_mfma_f32_16x16x32_bf16 v[136:139], v[104:107], v[68:71], v[136:139]
    v_mfma_f32_16x16x32_bf16 v[140:143], v[108:111], v[68:71], v[140:143]
    v_mfma_f32_16x16x32_bf16 v[144:147], v[112:115], v[68:71], v[144:147]
    v_mfma_f32_16x16x32_bf16 v[148:151], v[116:119], v[68:71], v[148:151]
    v_mfma_f32_16x16x32_bf16 v[152:155], v[88:91], v[72:75], v[152:155]
    v_mfma_f32_16x16x32_bf16 v[156:159], v[92:95], v[72:75], v[156:159]
    v_mfma_f32_16x16x32_bf16 v[160:163], v[96:99], v[72:75], v[160:163]
    v_mfma_f32_16x16x32_bf16 v[164:167], v[100:103], v[72:75], v[164:167]
    v_mfma_f32_16x16x32_bf16 v[168:171], v[104:107], v[72:75], v[168:171]
    v_mfma_f32_16x16x32_bf16 v[172:175], v[108:111], v[72:75], v[172:175]
    v_mfma_f32_16x16x32_bf16 v[176:179], v[112:115], v[72:75], v[176:179]
    v_mfma_f32_16x16x32_bf16 v[180:183], v[116:119], v[72:75], v[180:183]
    v_mfma_f32_16x16x32_bf16 v[184:187], v[88:91], v[76:79], v[184:187]
    v_mfma_f32_16x16x32_bf16 v[188:191], v[92:95], v[76:79], v[188:191]
    v_mfma_f32_16x16x32_bf16 v[192:195], v[96:99], v[76:79], v[192:195]
    v_mfma_f32_16x16x32_bf16 v[196:199], v[100:103], v[76:79], v[196:199]
    v_mfma_f32_16x16x32_bf16 v[200:203], v[104:107], v[76:79], v[200:203]
    v_mfma_f32_16x16x32_bf16 v[204:207], v[108:111], v[76:79], v[204:207]
    v_mfma_f32_16x16x32_bf16 v[208:211], v[112:115], v[76:79], v[208:211]
    v_mfma_f32_16x16x32_bf16 v[212:215], v[116:119], v[76:79], v[212:215]
    v_mfma_f32_16x16x32_bf16 v[216:219], v[88:91], v[80:83], v[216:219]
    v_mfma_f32_16x16x32_bf16 v[220:223], v[92:95], v[80:83], v[220:223]
    s_waitcnt lgkmcnt(0)
    s_barrier
    v_mfma_f32_16x16x32_bf16 v[224:227], v[96:99], v[80:83], v[224:227]
    v_mfma_f32_16x16x32_bf16 v[228:231], v[100:103], v[80:83], v[228:231]
    v_mfma_f32_16x16x32_bf16 v[232:235], v[104:107], v[80:83], v[232:235]
    v_mfma_f32_16x16x32_bf16 v[236:239], v[108:111], v[80:83], v[236:239]
    v_mfma_f32_16x16x32_bf16 v[240:243], v[112:115], v[80:83], v[240:243]
    v_mfma_f32_16x16x32_bf16 v[244:247], v[116:119], v[80:83], v[244:247]
    v_mfma_f32_16x16x32_bf16 v[248:251], v[108:111], v[84:87], v[248:251]
    v_mfma_f32_16x16x32_bf16 v[252:255], v[112:115], v[84:87], v[252:255]
    v_and_b32 v6, 15, v0
    v_mul_u32_u24 v6, 504, v6
    v_lshrrev_b32 v7, 4, v0
    v_lshl_add_u32 v6, v7, 3, v6
    v_cvt_pk_bf16_f32 v16, v120, v121
    v_cvt_pk_bf16_f32 v17, v122, v123
    v_cvt_pk_bf16_f32 v18, v124, v125
    v_cvt_pk_bf16_f32 v19, v126, v127
    v_cvt_pk_bf16_f32 v20, v128, v129
    v_cvt_pk_bf16_f32 v21, v130, v131
    v_cvt_pk_bf16_f32 v22, v132, v133
    v_cvt_pk_bf16_f32 v23, v134, v135
    v_cvt_pk_bf16_f32 v24, v136, v137
    v_cvt_pk_bf16_f32 v25, v138, v139
    v_cvt_pk_bf16_f32 v26, v140, v141
    v_cvt_pk_bf16_f32 v27, v142, v143
    v_cvt_pk_bf16_f32 v28, v144, v145
    v_cvt_pk_bf16_f32 v29, v146, v147
    v_cvt_pk_bf16_f32 v30, v148, v149
    v_cvt_pk_bf16_f32 v31, v150, v151
    v_cvt_pk_bf16_f32 v32, v152, v153
    v_cvt_pk_bf16_f32 v33, v154, v155
    v_cvt_pk_bf16_f32 v34, v156, v157
    v_cvt_pk_bf16_f32 v35, v158, v159
    v_cvt_pk_bf16_f32 v36, v160, v161
    v_cvt_pk_bf16_f32 v37, v162, v163
    v_cvt_pk_bf16_f32 v38, v164, v165
    v_cvt_pk_bf16_f32 v39, v166, v167
    v_cvt_pk_bf16_f32 v40, v168, v169
    v_cvt_pk_bf16_f32 v41, v170, v171
    v_cvt_pk_bf16_f32 v42, v172, v173
    v_cvt_pk_bf16_f32 v43, v174, v175
    v_cvt_pk_bf16_f32 v44, v176, v177
    v_cvt_pk_bf16_f32 v45, v178, v179
    v_cvt_pk_bf16_f32 v46, v180, v181
    v_cvt_pk_bf16_f32 v47, v182, v183
    v_cvt_pk_bf16_f32 v48, v184, v185
    v_cvt_pk_bf16_f32 v49, v186, v187
    v_cvt_pk_bf16_f32 v50, v188, v189
    v_cvt_pk_bf16_f32 v51, v190, v191
    v_cvt_pk_bf16_f32 v52, v192, v193
    v_cvt_pk_bf16_f32 v53, v194, v195
    v_cvt_pk_bf16_f32 v54, v196, v197
    v_cvt_pk_bf16_f32 v55, v198, v199
    v_cvt_pk_bf16_f32 v56, v200, v201
    v_cvt_pk_bf16_f32 v57, v202, v203
    v_cvt_pk_bf16_f32 v58, v204, v205
    v_cvt_pk_bf16_f32 v59, v206, v207
    v_cvt_pk_bf16_f32 v60, v208, v209
    v_cvt_pk_bf16_f32 v61, v210, v211
    v_cvt_pk_bf16_f32 v62, v212, v213
    v_cvt_pk_bf16_f32 v63, v214, v215
    v_cvt_pk_bf16_f32 v64, v216, v217
    v_cvt_pk_bf16_f32 v65, v218, v219
    v_cvt_pk_bf16_f32 v66, v220, v221
    v_cvt_pk_bf16_f32 v67, v222, v223
    v_cvt_pk_bf16_f32 v68, v224, v225
    v_cvt_pk_bf16_f32 v69, v226, v227
    v_cvt_pk_bf16_f32 v70, v228, v229
    v_cvt_pk_bf16_f32 v71, v230, v231
    v_cvt_pk_bf16_f32 v72, v232, v233
    v_cvt_pk_bf16_f32 v73, v234, v235
    v_cvt_pk_bf16_f32 v74, v236, v237
    v_cvt_pk_bf16_f32 v75, v238, v239
    v_cvt_pk_bf16_f32 v76, v240, v241
    v_cvt_pk_bf16_f32 v77, v242, v243
    v_cvt_pk_bf16_f32 v78, v244, v245
    v_cvt_pk_bf16_f32 v79, v246, v247
    v_cvt_pk_bf16_f32 v80, v248, v249
    v_cvt_pk_bf16_f32 v81, v250, v251
    v_cvt_pk_bf16_f32 v82, v252, v253
    v_cvt_pk_bf16_f32 v83, v254, v255
    v_add_u32 v7, 0x8000, v6
    ds_write_b64 v6, v[16:17] offset:8064
    ds_write_b64 v6, v[18:19] offset:8096
    ds_write_b64 v6, v[20:21] offset:8128
    ds_write_b64 v6, v[22:23] offset:8160
    ds_write_b64 v6, v[24:25] offset:8192
    ds_write_b64 v6, v[26:27] offset:8224
    ds_write_b64 v6, v[28:29] offset:8256
    ds_write_b64 v6, v[30:31] offset:8288
    ds_write_b64 v6, v[32:33] offset:16128
    ds_write_b64 v6, v[34:35] offset:16160
    ds_write_b64 v6, v[36:37] offset:16192
    ds_write_b64 v6, v[38:39] offset:16224
    ds_write_b64 v6, v[40:41] offset:16256
    ds_write_b64 v6, v[42:43] offset:16288
    ds_write_b64 v6, v[44:45] offset:16320
    ds_write_b64 v6, v[46:47] offset:16352
    ds_write_b64 v6, v[48:49] offset:24192
    ds_write_b64 v6, v[50:51] offset:24224
    ds_write_b64 v6, v[52:53] offset:24256
    ds_write_b64 v6, v[54:55] offset:24288
    ds_write_b64 v6, v[56:57] offset:24320
    ds_write_b64 v6, v[58:59] offset:24352
    ds_write_b64 v6, v[60:61] offset:24384
    ds_write_b64 v6, v[62:63] offset:24416
    ds_write_b64 v6, v[64:65] offset:32256
    ds_write_b64 v6, v[66:67] offset:32288
    ds_write_b64 v6, v[68:69] offset:32320
    ds_write_b64 v6, v[70:71] offset:32352
    ds_write_b64 v6, v[72:73] offset:32384
    ds_write_b64 v6, v[74:75] offset:32416
    ds_write_b64 v6, v[76:77] offset:32448
    ds_write_b64 v6, v[78:79] offset:32480
    ds_write_b64 v6, v[80:81] offset:160
    ds_write_b64 v6, v[82:83] offset:192
    s_branch K1_att
K1_q10:
    v_and_b32 v14, 15, v0
    v_lshrrev_b32 v15, 4, v0
    v_and_b32 v6, 7, v14
    v_xor_b32 v6, v15, v6
    v_lshlrev_b32 v14, 7, v14
    v_lshl_add_u32 v2, v6, 4, v14
    v_xor_b32 v3, 64, v2
    v_lshrrev_b32 v6, 1, v15
    v_lshlrev_b32 v6, 4, v6
    v_and_b32 v7, 1, v15
    v_lshl_add_u32 v6, v7, 2, v6
    v_lshrrev_b32 v7, 2, v0
    v_and_b32 v7, 3, v7
    v_add_u32 v6, v6, v7
    v_mul_u32_u24 v6, 480, v6
    v_and_b32 v7, 3, v0
    v_lshl_add_u32 v6, v7, 3, v6
    v_add_u32 v4, 55296, v6
    v_add_u32 v5, 101376, v6
    v_mov_b32 v120, 0
    v_mov_b32 v121, 0
    v_mov_b32 v122, 0
    v_mov_b32 v123, 0
    v_mov_b32 v124, 0
    v_mov_b32 v125, 0
    v_mov_b32 v126, 0
    v_mov_b32 v127, 0
    v_mov_b32 v128, 0
    v_mov_b32 v129, 0
    v_mov_b32 v130, 0
    v_mov_b32 v131, 0
    v_mov_b32 v132, 0
    v_mov_b32 v133, 0
    v_mov_b32 v134, 0
    v_mov_b32 v135, 0
    v_mov_b32 v136, 0
    v_mov_b32 v137, 0
    v_mov_b32 v138, 0
    v_mov_b32 v139, 0
    v_mov_b32 v140, 0
    v_mov_b32 v141, 0
    v_mov_b32 v142, 0
    v_mov_b32 v143, 0
    v_mov_b32 v144, 0
    v_mov_b32 v145, 0
    v_mov_b32 v146, 0
    v_mov_b32 v147, 0
    v_mov_b32 v148, 0
    v_mov_b32 v149, 0
    v_mov_b32 v150, 0
    v_mov_b32 v151, 0
    v_mov_b32 v152, 0
    v_mov_b32 v153, 0
    v_mov_b32 v154, 0
    v_mov_b32 v155, 0
    v_mov_b32 v156, 0
    v_mov_b32 v157, 0
    v_mov_b32 v158, 0
    v_mov_b32 v159, 0
    v_mov_b32 v160, 0
    v_mov_b32 v161, 0
    v_mov_b32 v162, 0
    v_mov_b32 v163, 0
    v_mov_b32 v164, 0
    v_mov_b32 v165, 0
    v_mov_b32 v166, 0
    v_mov_b32 v167, 0
    v_mov_b32 v168, 0
    v_mov_b32 v169, 0
    v_mov_b32 v170, 0
    v_mov_b32 v171, 0
    v_mov_b32 v172, 0
    v_mov_b32 v173, 0
    v_mov_b32 v174, 0
    v_mov_b32 v175, 0
    v_mov_b32 v176, 0
    v_mov_b32 v177, 0
    v_mov_b32 v178, 0
    v_mov_b32 v179, 0
    v_mov_b32 v180, 0
    v_mov_b32 v181, 0
    v_mov_b32 v182, 0
    v_mov_b32 v183, 0
    v_mov_b32 v184, 0
    v_mov_b32 v185, 0
    v_mov_b32 v186, 0
    v_mov_b32 v187, 0
    v_mov_b32 v188, 0
    v_mov_b32 v189, 0
    v_mov_b32 v190, 0
    v_mov_b32 v191, 0
    v_mov_b32 v192, 0
    v_mov_b32 v193, 0
    v_mov_b32 v194, 0
    v_mov_b32 v195, 0
    v_mov_b32 v196, 0
    v_mov_b32 v197, 0
    v_mov_b32 v198, 0
    v_mov_b32 v199, 0
    v_mov_b32 v200, 0
    v_mov_b32 v201, 0
    v_mov_b32 v202, 0
    v_mov_b32 v203, 0
    v_mov_b32 v204, 0
    v_mov_b32 v205, 0
    v_mov_b32 v206, 0
    v_mov_b32 v207, 0
    v_mov_b32 v208, 0
    v_mov_b32 v209, 0
    v_mov_b32 v210, 0
    v_mov_b32 v211, 0
    v_mov_b32 v212, 0
    v_mov_b32 v213, 0
    v_mov_b32 v214, 0
    v_mov_b32 v215, 0
    v_mov_b32 v216, 0
    v_mov_b32 v217, 0
    v_mov_b32 v218, 0
    v_mov_b32 v219, 0
    v_mov_b32 v220, 0
    v_mov_b32 v221, 0
    v_mov_b32 v222, 0
    v_mov_b32 v223, 0
    v_mov_b32 v224, 0
    v_mov_b32 v225, 0
    v_mov_b32 v226, 0
    v_mov_b32 v227, 0
    v_mov_b32 v228, 0
    v_mov_b32 v229, 0
    v_mov_b32 v230, 0
    v_mov_b32 v231, 0
    v_mov_b32 v232, 0
    v_mov_b32 v233, 0
    v_mov_b32 v234, 0
    v_mov_b32 v235, 0
    v_mov_b32 v236, 0
    v_mov_b32 v237, 0
    v_mov_b32 v238, 0
    v_mov_b32 v239, 0
    v_mov_b32 v240, 0
    v_mov_b32 v241, 0
    v_mov_b32 v242, 0
    v_mov_b32 v243, 0
    v_mov_b32 v244, 0
    v_mov_b32 v245, 0
    v_mov_b32 v246, 0
    v_mov_b32 v247, 0
    v_mov_b32 v248, 0
    v_mov_b32 v249, 0
    v_mov_b32 v250, 0
    v_mov_b32 v251, 0
    s_barrier
    ds_read_b128 v[16:19], v2 offset:10240
    ds_read_b128 v[20:23], v2 offset:12288
    ds_read_b128 v[24:27], v2 offset:14336
    ds_read_b128 v[28:31], v2 offset:16384
    ds_read_b128 v[32:35], v2 offset:0
    ds_read_b64_tr_b16 v[36:37], v4 offset:0
    ds_read_b64_tr_b16 v[38:39], v4 offset:3840
    ds_read_b64_tr_b16 v[40:41], v4 offset:32
    ds_read_b64_tr_b16 v[42:43], v4 offset:3872
    ds_read_b64_tr_b16 v[44:45], v4 offset:64
    ds_read_b64_tr_b16 v[46:47], v4 offset:3904
    ds_read_b64_tr_b16 v[48:49], v4 offset:96
    ds_read_b64_tr_b16 v[50:51], v4 offset:3936
    ds_read_b64_tr_b16 v[52:53], v4 offset:128
    ds_read_b64_tr_b16 v[54:55], v4 offset:3968
    ds_read_b64_tr_b16 v[56:57], v4 offset:160
    ds_read_b64_tr_b16 v[58:59], v4 offset:4000
    ds_read_b64_tr_b16 v[60:61], v4 offset:192
    ds_read_b64_tr_b16 v[62:63], v4 offset:4032
    ds_read_b64_tr_b16 v[64:65], v4 offset:224
    ds_read_b64_tr_b16 v[66:67], v4 offset:4064
    s_waitcnt lgkmcnt(0)
    s_barrier
    s_mov_b32 s26, 0
K1q10_cloop:
    v_mfma_f32_16x16x32_bf16 v[120:123], v[36:39], v[16:19], v[120:123]
    ds_read_b128 v[68:71], v3 offset:10240
    v_mfma_f32_16x16x32_bf16 v[124:127], v[40:43], v[16:19], v[124:127]
    ds_read_b128 v[72:75], v3 offset:12288
    v_mfma_f32_16x16x32_bf16 v[128:131], v[44:47], v[16:19], v[128:131]
    ds_read_b128 v[76:79], v3 offset:14336
    v_mfma_f32_16x16x32_bf16 v[132:135], v[48:51], v[16:19], v[132:135]
    ds_read_b128 v[80:83], v3 offset:16384
    v_mfma_f32_16x16x32_bf16 v[136:139], v[52:55], v[16:19], v[136:139]
    ds_read_b128 v[84:87], v3 offset:0
    v_mfma_f32_16x16x32_bf16 v[140:143], v[56:59], v[16:19], v[140:143]
    ds_read_b64_tr_b16 v[88:89], v4 offset:15360
    v_mfma_f32_16x16x32_bf16 v[144:147], v[60:63], v[16:19], v[144:147]
    ds_read_b64_tr_b16 v[90:91], v4 offset:19200
    v_mfma_f32_16x16x32_bf16 v[148:151], v[64:67], v[16:19], v[148:151]
    ds_read_b64_tr_b16 v[92:93], v4 offset:15392
    v_mfma_f32_16x16x32_bf16 v[152:155], v[36:39], v[20:23], v[152:155]
    ds_read_b64_tr_b16 v[94:95], v4 offset:19232
    v_mfma_f32_16x16x32_bf16 v[156:159], v[40:43], v[20:23], v[156:159]
    ds_read_b64_tr_b16 v[96:97], v4 offset:15424
    v_mfma_f32_16x16x32_bf16 v[160:163], v[44:47], v[20:23], v[160:163]
    ds_read_b64_tr_b16 v[98:99], v4 offset:19264
    v_mfma_f32_16x16x32_bf16 v[164:167], v[48:51], v[20:23], v[164:167]
    ds_read_b64_tr_b16 v[100:101], v4 offset:15456
    v_mfma_f32_16x16x32_bf16 v[168:171], v[52:55], v[20:23], v[168:171]
    ds_read_b64_tr_b16 v[102:103], v4 offset:19296
    v_mfma_f32_16x16x32_bf16 v[172:175], v[56:59], v[20:23], v[172:175]
    ds_read_b64_tr_b16 v[104:105], v4 offset:15488
    v_mfma_f32_16x16x32_bf16 v[176:179], v[60:63], v[20:23], v[176:179]
    ds_read_b64_tr_b16 v[106:107], v4 offset:19328
    v_mfma_f32_16x16x32_bf16 v[180:183], v[64:67], v[20:23], v[180:183]
    ds_read_b64_tr_b16 v[108:109], v4 offset:15520
    v_mfma_f32_16x16x32_bf16 v[184:187], v[36:39], v[24:27], v[184:187]
    ds_read_b64_tr_b16 v[110:111], v4 offset:19360
    v_mfma_f32_16x16x32_bf16 v[188:191], v[40:43], v[24:27], v[188:191]
    ds_read_b64_tr_b16 v[112:113], v4 offset:15552
    v_mfma_f32_16x16x32_bf16 v[192:195], v[44:47], v[24:27], v[192:195]
    ds_read_b64_tr_b16 v[114:115], v4 offset:19392
    v_mfma_f32_16x16x32_bf16 v[196:199], v[48:51], v[24:27], v[196:199]
    ds_read_b64_tr_b16 v[116:117], v4 offset:15584
    v_mfma_f32_16x16x32_bf16 v[200:203], v[52:55], v[24:27], v[200:203]
    ds_read_b64_tr_b16 v[118:119], v4 offset:19424
    v_mfma_f32_16x16x32_bf16 v[204:207], v[56:59], v[24:27], v[204:207]
    v_mfma_f32_16x16x32_bf16 v[208:211], v[60:63], v[24:27], v[208:211]
    v_mfma_f32_16x16x32_bf16 v[212:215], v[64:67], v[24:27], v[212:215]
    v_mfma_f32_16x16x32_bf16 v[216:219], v[36:39], v[28:31], v[216:219]
    s_waitcnt lgkmcnt(0)
    s_barrier
    v_mfma_f32_16x16x32_bf16 v[220:223], v[40:43], v[28:31], v[220:223]
    v_mfma_f32_16x16x32_bf16 v[224:227], v[44:47], v[28:31], v[224:227]
    v_mfma_f32_16x16x32_bf16 v[228:231], v[48:51], v[28:31], v[228:231]
    v_mfma_f32_16x16x32_bf16 v[232:235], v[52:55], v[28:31], v[232:235]
    v_mfma_f32_16x16x32_bf16 v[236:239], v[56:59], v[28:31], v[236:239]
    v_mfma_f32_16x16x32_bf16 v[240:243], v[60:63], v[28:31], v[240:243]
    v_mfma_f32_16x16x32_bf16 v[244:247], v[64:67], v[28:31], v[244:247]
    v_mfma_f32_16x16x32_bf16 v[248:251], v[64:67], v[32:35], v[248:251]
    v_mfma_f32_16x16x32_bf16 v[120:123], v[88:91], v[68:71], v[120:123]
    ds_read_b128 v[16:19], v2 offset:28672
    v_mfma_f32_16x16x32_bf16 v[124:127], v[92:95], v[68:71], v[124:127]
    ds_read_b128 v[20:23], v2 offset:30720
    v_mfma_f32_16x16x32_bf16 v[128:131], v[96:99], v[68:71], v[128:131]
    ds_read_b128 v[24:27], v2 offset:32768
    v_mfma_f32_16x16x32_bf16 v[132:135], v[100:103], v[68:71], v[132:135]
    ds_read_b128 v[28:31], v2 offset:34816
    v_mfma_f32_16x16x32_bf16 v[136:139], v[104:107], v[68:71], v[136:139]
    ds_read_b128 v[32:35], v2 offset:18432
    v_mfma_f32_16x16x32_bf16 v[140:143], v[108:111], v[68:71], v[140:143]
    ds_read_b64_tr_b16 v[36:37], v4 offset:30720
    v_mfma_f32_16x16x32_bf16 v[144:147], v[112:115], v[68:71], v[144:147]
    ds_read_b64_tr_b16 v[38:39], v4 offset:34560
    v_mfma_f32_16x16x32_bf16 v[148:151], v[116:119], v[68:71], v[148:151]
    ds_read_b64_tr_b16 v[40:41], v4 offset:30752
    v_mfma_f32_16x16x32_bf16 v[152:155], v[88:91], v[72:75], v[152:155]
    ds_read_b64_tr_b16 v[42:43], v4 offset:34592
    v_mfma_f32_16x16x32_bf16 v[156:159], v[92:95], v[72:75], v[156:159]
    ds_read_b64_tr_b16 v[44:45], v4 offset:30784
    v_mfma_f32_16x16x32_bf16 v[160:163], v[96:99], v[72:75], v[160:163]
    ds_read_b64_tr_b16 v[46:47], v4 offset:34624
    v_mfma_f32_16x16x32_bf16 v[164:167], v[100:103], v[72:75], v[164:167]
    ds_read_b64_tr_b16 v[48:49], v4 offset:30816
    v_mfma_f32_16x16x32_bf16 v[168:171], v[104:107], v[72:75], v[168:171]
    ds_read_b64_tr_b16 v[50:51], v4 offset:34656
    v_mfma_f32_16x16x32_bf16 v[172:175], v[108:111], v[72:75], v[172:175]
    ds_read_b64_tr_b16 v[52:53], v4 offset:30848
    v_mfma_f32_16x16x32_bf16 v[176:179], v[112:115], v[72:75], v[176:179]
    ds_read_b64_tr_b16 v[54:55], v4 offset:34688
    v_mfma_f32_16x16x32_bf16 v[180:183], v[116:119], v[72:75], v[180:183]
    ds_read_b64_tr_b16 v[56:57], v4 offset:30880
    v_mfma_f32_16x16x32_bf16 v[184:187], v[88:91], v[76:79], v[184:187]
    ds_read_b64_tr_b16 v[58:59], v4 offset:34720
    v_mfma_f32_16x16x32_bf16 v[188:191], v[92:95], v[76:79], v[188:191]
    ds_read_b64_tr_b16 v[60:61], v4 offset:30912
    v_mfma_f32_16x16x32_bf16 v[192:195], v[96:99], v[76:79], v[192:195]
    ds_read_b64_tr_b16 v[62:63], v4 offset:34752
    v_mfma_f32_16x16x32_bf16 v[196:199], v[100:103], v[76:79], v[196:199]
    ds_read_b64_tr_b16 v[64:65], v4 offset:30944
    v_mfma_f32_16x16x32_bf16 v[200:203], v[104:107], v[76:79], v[200:203]
    ds_read_b64_tr_b16 v[66:67], v4 offset:34784
    v_mfma_f32_16x16x32_bf16 v[204:207], v[108:111], v[76:79], v[204:207]
    v_mfma_f32_16x16x32_bf16 v[208:211], v[112:115], v[76:79], v[208:211]
    v_mfma_f32_16x16x32_bf16 v[212:215], v[116:119], v[76:79], v[212:215]
    v_mfma_f32_16x16x32_bf16 v[216:219], v[88:91], v[80:83], v[216:219]
    s_waitcnt lgkmcnt(0)
    s_barrier
    v_mfma_f32_16x16x32_bf16 v[220:223], v[92:95], v[80:83], v[220:223]
    v_mfma_f32_16x16x32_bf16 v[224:227], v[96:99], v[80:83], v[224:227]
    v_mfma_f32_16x16x32_bf16 v[228:231], v[100:103], v[80:83], v[228:231]
    v_mfma_f32_16x16x32_bf16 v[232:235], v[104:107], v[80:83], v[232:235]
    v_mfma_f32_16x16x32_bf16 v[236:239], v[108:111], v[80:83], v[236:239]
    v_mfma_f32_16x16x32_bf16 v[240:243], v[112:115], v[80:83], v[240:243]
    v_mfma_f32_16x16x32_bf16 v[244:247], v[116:119], v[80:83], v[244:247]
    v_mfma_f32_16x16x32_bf16 v[248:251], v[116:119], v[84:87], v[248:251]
    v_mfma_f32_16x16x32_bf16 v[120:123], v[36:39], v[16:19], v[120:123]
    ds_read_b128 v[68:71], v3 offset:28672
    v_mfma_f32_16x16x32_bf16 v[124:127], v[40:43], v[16:19], v[124:127]
    ds_read_b128 v[72:75], v3 offset:30720
    v_mfma_f32_16x16x32_bf16 v[128:131], v[44:47], v[16:19], v[128:131]
    ds_read_b128 v[76:79], v3 offset:32768
    v_mfma_f32_16x16x32_bf16 v[132:135], v[48:51], v[16:19], v[132:135]
    ds_read_b128 v[80:83], v3 offset:34816
    v_mfma_f32_16x16x32_bf16 v[136:139], v[52:55], v[16:19], v[136:139]
    ds_read_b128 v[84:87], v3 offset:18432
    v_mfma_f32_16x16x32_bf16 v[140:143], v[56:59], v[16:19], v[140:143]
    ds_read_b64_tr_b16 v[88:89], v5 offset:0
    v_mfma_f32_16x16x32_bf16 v[144:147], v[60:63], v[16:19], v[144:147]
    ds_read_b64_tr_b16 v[90:91], v5 offset:3840
    v_mfma_f32_16x16x32_bf16 v[148:151], v[64:67], v[16:19], v[148:151]
    ds_read_b64_tr_b16 v[92:93], v5 offset:32
    v_mfma_f32_16x16x32_bf16 v[152:155], v[36:39], v[20:23], v[152:155]
    ds_read_b64_tr_b16 v[94:95], v5 offset:3872
    v_mfma_f32_16x16x32_bf16 v[156:159], v[40:43], v[20:23], v[156:159]
    ds_read_b64_tr_b16 v[96:97], v5 offset:64
    v_mfma_f32_16x16x32_bf16 v[160:163], v[44:47], v[20:23], v[160:163]
    ds_read_b64_tr_b16 v[98:99], v5 offset:3904
    v_mfma_f32_16x16x32_bf16 v[164:167], v[48:51], v[20:23], v[164:167]
    ds_read_b64_tr_b16 v[100:101], v5 offset:96
    v_mfma_f32_16x16x32_bf16 v[168:171], v[52:55], v[20:23], v[168:171]
    ds_read_b64_tr_b16 v[102:103], v5 offset:3936
    v_mfma_f32_16x16x32_bf16 v[172:175], v[56:59], v[20:23], v[172:175]
    ds_read_b64_tr_b16 v[104:105], v5 offset:128
    v_mfma_f32_16x16x32_bf16 v[176:179], v[60:63], v[20:23], v[176:179]
    ds_read_b64_tr_b16 v[106:107], v5 offset:3968
    v_mfma_f32_16x16x32_bf16 v[180:183], v[64:67], v[20:23], v[180:183]
    ds_read_b64_tr_b16 v[108:109], v5 offset:160
    v_mfma_f32_16x16x32_bf16 v[184:187], v[36:39], v[24:27], v[184:187]
    ds_read_b64_tr_b16 v[110:111], v5 offset:4000
    v_mfma_f32_16x16x32_bf16 v[188:191], v[40:43], v[24:27], v[188:191]
    ds_read_b64_tr_b16 v[112:113], v5 offset:192
    v_mfma_f32_16x16x32_bf16 v[192:195], v[44:47], v[24:27], v[192:195]
    ds_read_b64_tr_b16 v[114:115], v5 offset:4032
    v_mfma_f32_16x16x32_bf16 v[196:199], v[48:51], v[24:27], v[196:199]
    ds_read_b64_tr_b16 v[116:117], v5 offset:224
    v_mfma_f32_16x16x32_bf16 v[200:203], v[52:55], v[24:27], v[200:203]
    ds_read_b64_tr_b16 v[118:119], v5 offset:4064
    v_mfma_f32_16x16x32_bf16 v[204:207], v[56:59], v[24:27], v[204:207]
    v_mfma_f32_16x16x32_bf16 v[208:211], v[60:63], v[24:27], v[208:211]
    v_mfma_f32_16x16x32_bf16 v[212:215], v[64:67], v[24:27], v[212:215]
    v_mfma_f32_16x16x32_bf16 v[216:219], v[36:39], v[28:31], v[216:219]
    s_waitcnt lgkmcnt(0)
    s_barrier
    v_mfma_f32_16x16x32_bf16 v[220:223], v[40:43], v[28:31], v[220:223]
    v_mfma_f32_16x16x32_bf16 v[224:227], v[44:47], v[28:31], v[224:227]
    v_mfma_f32_16x16x32_bf16 v[228:231], v[48:51], v[28:31], v[228:231]
    v_mfma_f32_16x16x32_bf16 v[232:235], v[52:55], v[28:31], v[232:235]
    v_mfma_f32_16x16x32_bf16 v[236:239], v[56:59], v[28:31], v[236:239]
    v_mfma_f32_16x16x32_bf16 v[240:243], v[60:63], v[28:31], v[240:243]
    v_mfma_f32_16x16x32_bf16 v[244:247], v[64:67], v[28:31], v[244:247]
    v_mfma_f32_16x16x32_bf16 v[248:251], v[64:67], v[32:35], v[248:251]
    v_mfma_f32_16x16x32_bf16 v[120:123], v[88:91], v[68:71], v[120:123]
    ds_read_b128 v[16:19], v2 offset:47104
    v_mfma_f32_16x16x32_bf16 v[124:127], v[92:95], v[68:71], v[124:127]
    ds_read_b128 v[20:23], v2 offset:49152
    v_mfma_f32_16x16x32_bf16 v[128:131], v[96:99], v[68:71], v[128:131]
    ds_read_b128 v[24:27], v2 offset:51200
    v_mfma_f32_16x16x32_bf16 v[132:135], v[100:103], v[68:71], v[132:135]
    ds_read_b128 v[28:31], v2 offset:53248
    v_mfma_f32_16x16x32_bf16 v[136:139], v[104:107], v[68:71], v[136:139]
    ds_read_b128 v[32:35], v2 offset:36864
    v_mfma_f32_16x16x32_bf16 v[140:143], v[108:111], v[68:71], v[140:143]
    ds_read_b64_tr_b16 v[36:37], v5 offset:15360
    v_mfma_f32_16x16x32_bf16 v[144:147], v[112:115], v[68:71], v[144:147]
    ds_read_b64_tr_b16 v[38:39], v5 offset:19200
    v_mfma_f32_16x16x32_bf16 v[148:151], v[116:119], v[68:71], v[148:151]
    ds_read_b64_tr_b16 v[40:41], v5 offset:15392
    v_mfma_f32_16x16x32_bf16 v[152:155], v[88:91], v[72:75], v[152:155]
    ds_read_b64_tr_b16 v[42:43], v5 offset:19232
    v_mfma_f32_16x16x32_bf16 v[156:159], v[92:95], v[72:75], v[156:159]
    ds_read_b64_tr_b16 v[44:45], v5 offset:15424
    v_mfma_f32_16x16x32_bf16 v[160:163], v[96:99], v[72:75], v[160:163]
    ds_read_b64_tr_b16 v[46:47], v5 offset:19264
    v_mfma_f32_16x16x32_bf16 v[164:167], v[100:103], v[72:75], v[164:167]
    ds_read_b64_tr_b16 v[48:49], v5 offset:15456
    v_mfma_f32_16x16x32_bf16 v[168:171], v[104:107], v[72:75], v[168:171]
    ds_read_b64_tr_b16 v[50:51], v5 offset:19296
    v_mfma_f32_16x16x32_bf16 v[172:175], v[108:111], v[72:75], v[172:175]
    ds_read_b64_tr_b16 v[52:53], v5 offset:15488
    v_mfma_f32_16x16x32_bf16 v[176:179], v[112:115], v[72:75], v[176:179]
    ds_read_b64_tr_b16 v[54:55], v5 offset:19328
    v_mfma_f32_16x16x32_bf16 v[180:183], v[116:119], v[72:75], v[180:183]
    ds_read_b64_tr_b16 v[56:57], v5 offset:15520
    v_mfma_f32_16x16x32_bf16 v[184:187], v[88:91], v[76:79], v[184:187]
    ds_read_b64_tr_b16 v[58:59], v5 offset:19360
    v_mfma_f32_16x16x32_bf16 v[188:191], v[92:95], v[76:79], v[188:191]
    ds_read_b64_tr_b16 v[60:61], v5 offset:15552
    v_mfma_f32_16x16x32_bf16 v[192:195], v[96:99], v[76:79], v[192:195]
    ds_read_b64_tr_b16 v[62:63], v5 offset:19392
    v_mfma_f32_16x16x32_bf16 v[196:199], v[100:103], v[76:79], v[196:199]
    ds_read_b64_tr_b16 v[64:65], v5 offset:15584
    v_mfma_f32_16x16x32_bf16 v[200:203], v[104:107], v[76:79], v[200:203]
    ds_read_b64_tr_b16 v[66:67], v5 offset:19424
    v_mfma_f32_16x16x32_bf16 v[204:207], v[108:111], v[76:79], v[204:207]
    v_mfma_f32_16x16x32_bf16 v[208:211], v[112:115], v[76:79], v[208:211]
    v_mfma_f32_16x16x32_bf16 v[212:215], v[116:119], v[76:79], v[212:215]
    v_mfma_f32_16x16x32_bf16 v[216:219], v[88:91], v[80:83], v[216:219]
    s_waitcnt lgkmcnt(0)
    s_barrier
    v_mfma_f32_16x16x32_bf16 v[220:223], v[92:95], v[80:83], v[220:223]
    v_mfma_f32_16x16x32_bf16 v[224:227], v[96:99], v[80:83], v[224:227]
    v_mfma_f32_16x16x32_bf16 v[228:231], v[100:103], v[80:83], v[228:231]
    v_mfma_f32_16x16x32_bf16 v[232:235], v[104:107], v[80:83], v[232:235]
    v_mfma_f32_16x16x32_bf16 v[236:239], v[108:111], v[80:83], v[236:239]
    v_mfma_f32_16x16x32_bf16 v[240:243], v[112:115], v[80:83], v[240:243]
    v_mfma_f32_16x16x32_bf16 v[244:247], v[116:119], v[80:83], v[244:247]
    v_mfma_f32_16x16x32_bf16 v[248:251], v[116:119], v[84:87], v[248:251]
    v_mfma_f32_16x16x32_bf16 v[120:123], v[36:39], v[16:19], v[120:123]
    ds_read_b128 v[68:71], v3 offset:47104
    v_mfma_f32_16x16x32_bf16 v[124:127], v[40:43], v[16:19], v[124:127]
    ds_read_b128 v[72:75], v3 offset:49152
    v_mfma_f32_16x16x32_bf16 v[128:131], v[44:47], v[16:19], v[128:131]
    ds_read_b128 v[76:79], v3 offset:51200
    v_mfma_f32_16x16x32_bf16 v[132:135], v[48:51], v[16:19], v[132:135]
    ds_read_b128 v[80:83], v3 offset:53248
    v_mfma_f32_16x16x32_bf16 v[136:139], v[52:55], v[16:19], v[136:139]
    ds_read_b128 v[84:87], v3 offset:36864
    v_mfma_f32_16x16x32_bf16 v[140:143], v[56:59], v[16:19], v[140:143]
    ds_read_b64_tr_b16 v[88:89], v5 offset:30720
    v_mfma_f32_16x16x32_bf16 v[144:147], v[60:63], v[16:19], v[144:147]
    ds_read_b64_tr_b16 v[90:91], v5 offset:34560
    v_mfma_f32_16x16x32_bf16 v[148:151], v[64:67], v[16:19], v[148:151]
    ds_read_b64_tr_b16 v[92:93], v5 offset:30752
    v_mfma_f32_16x16x32_bf16 v[152:155], v[36:39], v[20:23], v[152:155]
    ds_read_b64_tr_b16 v[94:95], v5 offset:34592
    v_mfma_f32_16x16x32_bf16 v[156:159], v[40:43], v[20:23], v[156:159]
    ds_read_b64_tr_b16 v[96:97], v5 offset:30784
    v_mfma_f32_16x16x32_bf16 v[160:163], v[44:47], v[20:23], v[160:163]
    ds_read_b64_tr_b16 v[98:99], v5 offset:34624
    v_mfma_f32_16x16x32_bf16 v[164:167], v[48:51], v[20:23], v[164:167]
    ds_read_b64_tr_b16 v[100:101], v5 offset:30816
    v_mfma_f32_16x16x32_bf16 v[168:171], v[52:55], v[20:23], v[168:171]
    ds_read_b64_tr_b16 v[102:103], v5 offset:34656
    v_mfma_f32_16x16x32_bf16 v[172:175], v[56:59], v[20:23], v[172:175]
    ds_read_b64_tr_b16 v[104:105], v5 offset:30848
    v_mfma_f32_16x16x32_bf16 v[176:179], v[60:63], v[20:23], v[176:179]
    ds_read_b64_tr_b16 v[106:107], v5 offset:34688
    v_mfma_f32_16x16x32_bf16 v[180:183], v[64:67], v[20:23], v[180:183]
    ds_read_b64_tr_b16 v[108:109], v5 offset:30880
    v_mfma_f32_16x16x32_bf16 v[184:187], v[36:39], v[24:27], v[184:187]
    ds_read_b64_tr_b16 v[110:111], v5 offset:34720
    v_mfma_f32_16x16x32_bf16 v[188:191], v[40:43], v[24:27], v[188:191]
    ds_read_b64_tr_b16 v[112:113], v5 offset:30912
    v_mfma_f32_16x16x32_bf16 v[192:195], v[44:47], v[24:27], v[192:195]
    ds_read_b64_tr_b16 v[114:115], v5 offset:34752
    v_mfma_f32_16x16x32_bf16 v[196:199], v[48:51], v[24:27], v[196:199]
    ds_read_b64_tr_b16 v[116:117], v5 offset:30944
    v_mfma_f32_16x16x32_bf16 v[200:203], v[52:55], v[24:27], v[200:203]
    ds_read_b64_tr_b16 v[118:119], v5 offset:34784
    v_mfma_f32_16x16x32_bf16 v[204:207], v[56:59], v[24:27], v[204:207]
    v_mfma_f32_16x16x32_bf16 v[208:211], v[60:63], v[24:27], v[208:211]
    v_mfma_f32_16x16x32_bf16 v[212:215], v[64:67], v[24:27], v[212:215]
    v_mfma_f32_16x16x32_bf16 v[216:219], v[36:39], v[28:31], v[216:219]
    s_waitcnt lgkmcnt(0)
    s_barrier
    v_mfma_f32_16x16x32_bf16 v[220:223], v[40:43], v[28:31], v[220:223]
    v_mfma_f32_16x16x32_bf16 v[224:227], v[44:47], v[28:31], v[224:227]
    v_mfma_f32_16x16x32_bf16 v[228:231], v[48:51], v[28:31], v[228:231]
    v_mfma_f32_16x16x32_bf16 v[232:235], v[52:55], v[28:31], v[232:235]
    v_mfma_f32_16x16x32_bf16 v[236:239], v[56:59], v[28:31], v[236:239]
    v_mfma_f32_16x16x32_bf16 v[240:243], v[60:63], v[28:31], v[240:243]
    v_mfma_f32_16x16x32_bf16 v[244:247], v[64:67], v[28:31], v[244:247]
    v_mfma_f32_16x16x32_bf16 v[248:251], v[64:67], v[32:35], v[248:251]
    v_mfma_f32_16x16x32_bf16 v[120:123], v[88:91], v[68:71], v[120:123]
    ds_read_b128 v[16:19], v2 offset:10240
    v_mfma_f32_16x16x32_bf16 v[124:127], v[92:95], v[68:71], v[124:127]
    ds_read_b128 v[20:23], v2 offset:12288
    v_mfma_f32_16x16x32_bf16 v[128:131], v[96:99], v[68:71], v[128:131]
    ds_read_b128 v[24:27], v2 offset:14336
    v_mfma_f32_16x16x32_bf16 v[132:135], v[100:103], v[68:71], v[132:135]
    ds_read_b128 v[28:31], v2 offset:16384
    v_mfma_f32_16x16x32_bf16 v[136:139], v[104:107], v[68:71], v[136:139]
    ds_read_b128 v[32:35], v2 offset:0
    v_mfma_f32_16x16x32_bf16 v[140:143], v[108:111], v[68:71], v[140:143]
    ds_read_b64_tr_b16 v[36:37], v4 offset:0
    v_mfma_f32_16x16x32_bf16 v[144:147], v[112:115], v[68:71], v[144:147]
    ds_read_b64_tr_b16 v[38:39], v4 offset:3840
    v_mfma_f32_16x16x32_bf16 v[148:151], v[116:119], v[68:71], v[148:151]
    ds_read_b64_tr_b16 v[40:41], v4 offset:32
    v_mfma_f32_16x16x32_bf16 v[152:155], v[88:91], v[72:75], v[152:155]
    ds_read_b64_tr_b16 v[42:43], v4 offset:3872
    v_mfma_f32_16x16x32_bf16 v[156:159], v[92:95], v[72:75], v[156:159]
    ds_read_b64_tr_b16 v[44:45], v4 offset:64
    v_mfma_f32_16x16x32_bf16 v[160:163], v[96:99], v[72:75], v[160:163]
    ds_read_b64_tr_b16 v[46:47], v4 offset:3904
    v_mfma_f32_16x16x32_bf16 v[164:167], v[100:103], v[72:75], v[164:167]
    ds_read_b64_tr_b16 v[48:49], v4 offset:96
    v_mfma_f32_16x16x32_bf16 v[168:171], v[104:107], v[72:75], v[168:171]
    ds_read_b64_tr_b16 v[50:51], v4 offset:3936
    v_mfma_f32_16x16x32_bf16 v[172:175], v[108:111], v[72:75], v[172:175]
    ds_read_b64_tr_b16 v[52:53], v4 offset:128
    v_mfma_f32_16x16x32_bf16 v[176:179], v[112:115], v[72:75], v[176:179]
    ds_read_b64_tr_b16 v[54:55], v4 offset:3968
    v_mfma_f32_16x16x32_bf16 v[180:183], v[116:119], v[72:75], v[180:183]
    ds_read_b64_tr_b16 v[56:57], v4 offset:160
    v_mfma_f32_16x16x32_bf16 v[184:187], v[88:91], v[76:79], v[184:187]
    ds_read_b64_tr_b16 v[58:59], v4 offset:4000
    v_mfma_f32_16x16x32_bf16 v[188:191], v[92:95], v[76:79], v[188:191]
    ds_read_b64_tr_b16 v[60:61], v4 offset:192
    v_mfma_f32_16x16x32_bf16 v[192:195], v[96:99], v[76:79], v[192:195]
    ds_read_b64_tr_b16 v[62:63], v4 offset:4032
    v_mfma_f32_16x16x32_bf16 v[196:199], v[100:103], v[76:79], v[196:199]
    ds_read_b64_tr_b16 v[64:65], v4 offset:224
    v_mfma_f32_16x16x32_bf16 v[200:203], v[104:107], v[76:79], v[200:203]
    ds_read_b64_tr_b16 v[66:67], v4 offset:4064
    v_mfma_f32_16x16x32_bf16 v[204:207], v[108:111], v[76:79], v[204:207]
    v_mfma_f32_16x16x32_bf16 v[208:211], v[112:115], v[76:79], v[208:211]
    v_mfma_f32_16x16x32_bf16 v[212:215], v[116:119], v[76:79], v[212:215]
    v_mfma_f32_16x16x32_bf16 v[216:219], v[88:91], v[80:83], v[216:219]
    s_waitcnt lgkmcnt(0)
    s_barrier
    v_mfma_f32_16x16x32_bf16 v[220:223], v[92:95], v[80:83], v[220:223]
    v_mfma_f32_16x16x32_bf16 v[224:227], v[96:99], v[80:83], v[224:227]
    v_mfma_f32_16x16x32_bf16 v[228:231], v[100:103], v[80:83], v[228:231]
    v_mfma_f32_16x16x32_bf16 v[232:235], v[104:107], v[80:83], v[232:235]
    v_mfma_f32_16x16x32_bf16 v[236:239], v[108:111], v[80:83], v[236:239]
    v_mfma_f32_16x16x32_bf16 v[240:243], v[112:115], v[80:83], v[240:243]
    v_mfma_f32_16x16x32_bf16 v[244:247], v[116:119], v[80:83], v[244:247]
    v_mfma_f32_16x16x32_bf16 v[248:251], v[116:119], v[84:87], v[248:251]
    s_add_u32 s26, s26, 1
    s_cmp_lt_u32 s26, 3
    s_cbranch_scc1 K1q10_cloop
    v_mfma_f32_16x16x32_bf16 v[120:123], v[36:39], v[16:19], v[120:123]
    ds_read_b128 v[68:71], v3 offset:10240
    v_mfma_f32_16x16x32_bf16 v[124:127], v[40:43], v[16:19], v[124:127]
    ds_read_b128 v[72:75], v3 offset:12288
    v_mfma_f32_16x16x32_bf16 v[128:131], v[44:47], v[16:19], v[128:131]
    ds_read_b128 v[76:79], v3 offset:14336
    v_mfma_f32_16x16x32_bf16 v[132:135], v[48:51], v[16:19], v[132:135]
    ds_read_b128 v[80:83], v3 offset:16384
    v_mfma_f32_16x16x32_bf16 v[136:139], v[52:55], v[16:19], v[136:139]
    ds_read_b128 v[84:87], v3 offset:0
    v_mfma_f32_16x16x32_bf16 v[140:143], v[56:59], v[16:19], v[140:143]
    ds_read_b64_tr_b16 v[88:89], v4 offset:15360
    v_mfma_f32_16x16x32_bf16 v[144:147], v[60:63], v[16:19], v[144:147]
    ds_read_b64_tr_b16 v[90:91], v4 offset:19200
    v_mfma_f32_16x16x32_bf16 v[148:151], v[64:67], v[16:19], v[148:151]
    ds_read_b64_tr_b16 v[92:93], v4 offset:15392
    v_mfma_f32_16x16x32_bf16 v[152:155], v[36:39], v[20:23], v[152:155]
    ds_read_b64_tr_b16 v[94:95], v4 offset:19232
    v_mfma_f32_16x16x32_bf16 v[156:159], v[40:43], v[20:23], v[156:159]
    ds_read_b64_tr_b16 v[96:97], v4 offset:15424
    v_mfma_f32_16x16x32_bf16 v[160:163], v[44:47], v[20:23], v[160:163]
    ds_read_b64_tr_b16 v[98:99], v4 offset:19264
    v_mfma_f32_16x16x32_bf16 v[164:167], v[48:51], v[20:23], v[164:167]
    ds_read_b64_tr_b16 v[100:101], v4 offset:15456
    v_mfma_f32_16x16x32_bf16 v[168:171], v[52:55], v[20:23], v[168:171]
    ds_read_b64_tr_b16 v[102:103], v4 offset:19296
    v_mfma_f32_16x16x32_bf16 v[172:175], v[56:59], v[20:23], v[172:175]
    ds_read_b64_tr_b16 v[104:105], v4 offset:15488
    v_mfma_f32_16x16x32_bf16 v[176:179], v[60:63], v[20:23], v[176:179]
    ds_read_b64_tr_b16 v[106:107], v4 offset:19328
    v_mfma_f32_16x16x32_bf16 v[180:183], v[64:67], v[20:23], v[180:183]
    ds_read_b64_tr_b16 v[108:109], v4 offset:15520
    v_mfma_f32_16x16x32_bf16 v[184:187], v[36:39], v[24:27], v[184:187]
    ds_read_b64_tr_b16 v[110:111], v4 offset:19360
    v_mfma_f32_16x16x32_bf16 v[188:191], v[40:43], v[24:27], v[188:191]
    ds_read_b64_tr_b16 v[112:113], v4 offset:15552
    v_mfma_f32_16x16x32_bf16 v[192:195], v[44:47], v[24:27], v[192:195]
    ds_read_b64_tr_b16 v[114:115], v4 offset:19392
    v_mfma_f32_16x16x32_bf16 v[196:199], v[48:51], v[24:27], v[196:199]
    ds_read_b64_tr_b16 v[116:117], v4 offset:15584
    v_mfma_f32_16x16x32_bf16 v[200:203], v[52:55], v[24:27], v[200:203]
    ds_read_b64_tr_b16 v[118:119], v4 offset:19424
    v_mfma_f32_16x16x32_bf16 v[204:207], v[56:59], v[24:27], v[204:207]
    v_mfma_f32_16x16x32_bf16 v[208:211], v[60:63], v[24:27], v[208:211]
    v_mfma_f32_16x16x32_bf16 v[212:215], v[64:67], v[24:27], v[212:215]
    v_mfma_f32_16x16x32_bf16 v[216:219], v[36:39], v[28:31], v[216:219]
    s_waitcnt lgkmcnt(0)
    s_barrier
    v_mfma_f32_16x16x32_bf16 v[220:223], v[40:43], v[28:31], v[220:223]
    v_mfma_f32_16x16x32_bf16 v[224:227], v[44:47], v[28:31], v[224:227]
    v_mfma_f32_16x16x32_bf16 v[228:231], v[48:51], v[28:31], v[228:231]
    v_mfma_f32_16x16x32_bf16 v[232:235], v[52:55], v[28:31], v[232:235]
    v_mfma_f32_16x16x32_bf16 v[236:239], v[56:59], v[28:31], v[236:239]
    v_mfma_f32_16x16x32_bf16 v[240:243], v[60:63], v[28:31], v[240:243]
    v_mfma_f32_16x16x32_bf16 v[244:247], v[64:67], v[28:31], v[244:247]
    v_mfma_f32_16x16x32_bf16 v[248:251], v[64:67], v[32:35], v[248:251]
    v_mfma_f32_16x16x32_bf16 v[120:123], v[88:91], v[68:71], v[120:123]
    v_mfma_f32_16x16x32_bf16 v[124:127], v[92:95], v[68:71], v[124:127]
    v_mfma_f32_16x16x32_bf16 v[128:131], v[96:99], v[68:71], v[128:131]
    v_mfma_f32_16x16x32_bf16 v[132:135], v[100:103], v[68:71], v[132:135]
    v_mfma_f32_16x16x32_bf16 v[136:139], v[104:107], v[68:71], v[136:139]
    v_mfma_f32_16x16x32_bf16 v[140:143], v[108:111], v[68:71], v[140:143]
    v_mfma_f32_16x16x32_bf16 v[144:147], v[112:115], v[68:71], v[144:147]
    v_mfma_f32_16x16x32_bf16 v[148:151], v[116:119], v[68:71], v[148:151]
    v_mfma_f32_16x16x32_bf16 v[152:155], v[88:91], v[72:75], v[152:155]
    v_mfma_f32_16x16x32_bf16 v[156:159], v[92:95], v[72:75], v[156:159]
    v_mfma_f32_16x16x32_bf16 v[160:163], v[96:99], v[72:75], v[160:163]
    v_mfma_f32_16x16x32_bf16 v[164:167], v[100:103], v[72:75], v[164:167]
    v_mfma_f32_16x16x32_bf16 v[168:171], v[104:107], v[72:75], v[168:171]
    v_mfma_f32_16x16x32_bf16 v[172:175], v[108:111], v[72:75], v[172:175]
    v_mfma_f32_16x16x32_bf16 v[176:179], v[112:115], v[72:75], v[176:179]
    v_mfma_f32_16x16x32_bf16 v[180:183], v[116:119], v[72:75], v[180:183]
    v_mfma_f32_16x16x32_bf16 v[184:187], v[88:91], v[76:79], v[184:187]
    v_mfma_f32_16x16x32_bf16 v[188:191], v[92:95], v[76:79], v[188:191]
    v_mfma_f32_16x16x32_bf16 v[192:195], v[96:99], v[76:79], v[192:195]
    v_mfma_f32_16x16x32_bf16 v[196:199], v[100:103], v[76:79], v[196:199]
    v_mfma_f32_16x16x32_bf16 v[200:203], v[104:107], v[76:79], v[200:203]
    v_mfma_f32_16x16x32_bf16 v[204:207], v[108:111], v[76:79], v[204:207]
    v_mfma_f32_16x16x32_bf16 v[208:211], v[112:115], v[76:79], v[208:211]
    v_mfma_f32_16x16x32_bf16 v[212:215], v[116:119], v[76:79], v[212:215]
    v_mfma_f32_16x16x32_bf16 v[216:219], v[88:91], v[80:83], v[216:219]
    s_waitcnt lgkmcnt(0)
    s_barrier
    v_mfma_f32_16x16x32_bf16 v[220:223], v[92:95], v[80:83], v[220:223]
    v_mfma_f32_16x16x32_bf16 v[224:227], v[96:99], v[80:83], v[224:227]
    v_mfma_f32_16x16x32_bf16 v[228:231], v[100:103], v[80:83], v[228:231]
    v_mfma_f32_16x16x32_bf16 v[232:235], v[104:107], v[80:83], v[232:235]
    v_mfma_f32_16x16x32_bf16 v[236:239], v[108:111], v[80:83], v[236:239]
    v_mfma_f32_16x16x32_bf16 v[240:243], v[112:115], v[80:83], v[240:243]
    v_mfma_f32_16x16x32_bf16 v[244:247], v[116:119], v[80:83], v[244:247]
    v_mfma_f32_16x16x32_bf16 v[248:251], v[116:119], v[84:87], v[248:251]
    v_and_b32 v6, 15, v0
    v_mul_u32_u24 v6, 504, v6
    v_lshrrev_b32 v7, 4, v0
    v_lshl_add_u32 v6, v7, 3, v6
    v_cvt_pk_bf16_f32 v16, v120, v121
    v_cvt_pk_bf16_f32 v17, v122, v123
    v_cvt_pk_bf16_f32 v18, v124, v125
    v_cvt_pk_bf16_f32 v19, v126, v127
    v_cvt_pk_bf16_f32 v20, v128, v129
    v_cvt_pk_bf16_f32 v21, v130, v131
    v_cvt_pk_bf16_f32 v22, v132, v133
    v_cvt_pk_bf16_f32 v23, v134, v135
    v_cvt_pk_bf16_f32 v24, v136, v137
    v_cvt_pk_bf16_f32 v25, v138, v139
    v_cvt_pk_bf16_f32 v26, v140, v141
    v_cvt_pk_bf16_f32 v27, v142, v143
    v_cvt_pk_bf16_f32 v28, v144, v145
    v_cvt_pk_bf16_f32 v29, v146, v147
    v_cvt_pk_bf16_f32 v30, v148, v149
    v_cvt_pk_bf16_f32 v31, v150, v151
    v_cvt_pk_bf16_f32 v32, v152, v153
    v_cvt_pk_bf16_f32 v33, v154, v155
    v_cvt_pk_bf16_f32 v34, v156, v157
    v_cvt_pk_bf16_f32 v35, v158, v159
    v_cvt_pk_bf16_f32 v36, v160, v161
    v_cvt_pk_bf16_f32 v37, v162, v163
    v_cvt_pk_bf16_f32 v38, v164, v165
    v_cvt_pk_bf16_f32 v39, v166, v167
    v_cvt_pk_bf16_f32 v40, v168, v169
    v_cvt_pk_bf16_f32 v41, v170, v171
    v_cvt_pk_bf16_f32 v42, v172, v173
    v_cvt_pk_bf16_f32 v43, v174, v175
    v_cvt_pk_bf16_f32 v44, v176, v177
    v_cvt_pk_bf16_f32 v45, v178, v179
    v_cvt_pk_bf16_f32 v46, v180, v181
    v_cvt_pk_bf16_f32 v47, v182, v183
    v_cvt_pk_bf16_f32 v48, v184, v185
    v_cvt_pk_bf16_f32 v49, v186, v187
    v_cvt_pk_bf16_f32 v50, v188, v189
    v_cvt_pk_bf16_f32 v51, v190, v191
    v_cvt_pk_bf16_f32 v52, v192, v193
    v_cvt_pk_bf16_f32 v53, v194, v195
    v_cvt_pk_bf16_f32 v54, v196, v197
    v_cvt_pk_bf16_f32 v55, v198, v199
    v_cvt_pk_bf16_f32 v56, v200, v201
    v_cvt_pk_bf16_f32 v57, v202, v203
    v_cvt_pk_bf16_f32 v58, v204, v205
    v_cvt_pk_bf16_f32 v59, v206, v207
    v_cvt_pk_bf16_f32 v60, v208, v209
    v_cvt_pk_bf16_f32 v61, v210, v211
    v_cvt_pk_bf16_f32 v62, v212, v213
    v_cvt_pk_bf16_f32 v63, v214, v215
    v_cvt_pk_bf16_f32 v64, v216, v217
    v_cvt_pk_bf16_f32 v65, v218, v219
    v_cvt_pk_bf16_f32 v66, v220, v221
    v_cvt_pk_bf16_f32 v67, v222, v223
    v_cvt_pk_bf16_f32 v68, v224, v225
    v_cvt_pk_bf16_f32 v69, v226, v227
    v_cvt_pk_bf16_f32 v70, v228, v229
    v_cvt_pk_bf16_f32 v71, v230, v231
    v_cvt_pk_bf16_f32 v72, v232, v233
    v_cvt_pk_bf16_f32 v73, v234, v235
    v_cvt_pk_bf16_f32 v74, v236, v237
    v_cvt_pk_bf16_f32 v75, v238, v239
    v_cvt_pk_bf16_f32 v76, v240, v241
    v_cvt_pk_bf16_f32 v77, v242, v243
    v_cvt_pk_bf16_f32 v78, v244, v245
    v_cvt_pk_bf16_f32 v79, v246, v247
    v_cvt_pk_bf16_f32 v80, v248, v249
    v_cvt_pk_bf16_f32 v81, v250, v251
    v_add_u32 v7, 0x8000, v6
    ds_write_b64 v6, v[16:17] offset:40320
    ds_write_b64 v6, v[18:19] offset:40352
    ds_write_b64 v6, v[20:21] offset:40384
    ds_write_b64 v6, v[22:23] offset:40416
    ds_write_b64 v6, v[24:25] offset:40448
    ds_write_b64 v6, v[26:27] offset:40480
    ds_write_b64 v6, v[28:29] offset:40512
    ds_write_b64 v6, v[30:31] offset:40544
    ds_write_b64 v6, v[32:33] offset:48384
    ds_write_b64 v6, v[34:35] offset:48416
    ds_write_b64 v6, v[36:37] offset:48448
    ds_write_b64 v6, v[38:39] offset:48480
    ds_write_b64 v6, v[40:41] offset:48512
    ds_write_b64 v6, v[42:43] offset:48544
    ds_write_b64 v6, v[44:45] offset:48576
    ds_write_b64 v6, v[46:47] offset:48608
    ds_write_b64 v6, v[48:49] offset:56448
    ds_write_b64 v6, v[50:51] offset:56480
    ds_write_b64 v6, v[52:53] offset:56512
    ds_write_b64 v6, v[54:55] offset:56544
    ds_write_b64 v6, v[56:57] offset:56576
    ds_write_b64 v6, v[58:59] offset:56608
    ds_write_b64 v6, v[60:61] offset:56640
    ds_write_b64 v6, v[62:63] offset:56672
    ds_write_b64 v6, v[64:65] offset:64512
    ds_write_b64 v6, v[66:67] offset:64544
    ds_write_b64 v6, v[68:69] offset:64576
    ds_write_b64 v6, v[70:71] offset:64608
    ds_write_b64 v6, v[72:73] offset:64640
    ds_write_b64 v6, v[74:75] offset:64672
    ds_write_b64 v6, v[76:77] offset:64704
    ds_write_b64 v6, v[78:79] offset:64736
    ds_write_b64 v6, v[80:81] offset:224
    s_branch K1_att
K1_q01:
    v_and_b32 v14, 15, v0
    v_lshrrev_b32 v15, 4, v0
    v_and_b32 v6, 7, v14
    v_xor_b32 v6, v15, v6
    v_lshlrev_b32 v14, 7, v14
    v_lshl_add_u32 v2, v6, 4, v14
    v_xor_b32 v3, 64, v2
    v_lshrrev_b32 v6, 1, v15
    v_lshlrev_b32 v6, 4, v6
    v_and_b32 v7, 1, v15
    v_lshl_add_u32 v6, v7, 2, v6
    v_lshrrev_b32 v7, 2, v0
    v_and_b32 v7, 3, v7
    v_add_u32 v6, v6, v7
    v_mul_u32_u24 v6, 480, v6
    v_and_b32 v7, 3, v0
    v_lshl_add_u32 v6, v7, 3, v6
    v_add_u32 v4, 55296, v6
    v_add_u32 v5, 101376, v6
    v_mov_b32 v120, 0
    v_mov_b32 v121, 0
    v_mov_b32 v122, 0
    v_mov_b32 v123, 0
    v_mov_b32 v124, 0
    v_mov_b32 v125, 0
    v_mov_b32 v126, 0
    v_mov_b32 v127, 0
    v_mov_b32 v128, 0
    v_mov_b32 v129, 0
    v_mov_b32 v130, 0
    v_mov_b32 v131, 0
    v_mov_b32 v132, 0
    v_mov_b32 v133, 0
    v_mov_b32 v134, 0
    v_mov_b32 v135, 0
    v_mov_b32 v136, 0
    v_mov_b32 v137, 0
    v_mov_b32 v138, 0
    v_mov_b32 v139, 0
    v_mov_b32 v140, 0
    v_mov_b32 v141, 0
    v_mov_b32 v142, 0
    v_mov_b32 v143, 0
    v_mov_b32 v144, 0
    v_mov_b32 v145, 0
    v_mov_b32 v146, 0
    v_mov_b32 v147, 0
    v_mov_b32 v148, 0
    v_mov_b32 v149, 0
    v_mov_b32 v150, 0
    v_mov_b32 v151, 0
    v_mov_b32 v152, 0
    v_mov_b32 v153, 0
    v_mov_b32 v154, 0
    v_mov_b32 v155, 0
    v_mov_b32 v156, 0
    v_mov_b32 v157, 0
    v_mov_b32 v158, 0
    v_mov_b32 v159, 0
    v_mov_b32 v160, 0
    v_mov_b32 v161, 0
    v_mov_b32 v162, 0
    v_mov_b32 v163, 0
    v_mov_b32 v164, 0
    v_mov_b32 v165, 0
    v_mov_b32 v166, 0
    v_mov_b32 v167, 0
    v_mov_b32 v168, 0
    v_mov_b32 v169, 0
    v_mov_b32 v170, 0
    v_mov_b32 v171, 0
    v_mov_b32 v172, 0
    v_mov_b32 v173, 0
    v_mov_b32 v174, 0
    v_mov_b32 v175, 0
    v_mov_b32 v176, 0
    v_mov_b32 v177, 0
    v_mov_b32 v178, 0
    v_mov_b32 v179, 0
    v_mov_b32 v180, 0
    v_mov_b32 v181, 0
    v_mov_b32 v182, 0
    v_mov_b32 v183, 0
    v_mov_b32 v184, 0
    v_mov_b32 v185, 0
    v_mov_b32 v186, 0
    v_mov_b32 v187, 0
    v_mov_b32 v188, 0
    v_mov_b32 v189, 0
    v_mov_b32 v190, 0
    v_mov_b32 v191, 0
    v_mov_b32 v192, 0
    v_mov_b32 v193, 0
    v_mov_b32 v194, 0
    v_mov_b32 v195, 0
    v_mov_b32 v196, 0
    v_mov_b32 v197, 0
    v_mov_b32 v198, 0
    v_mov_b32 v199, 0
    v_mov_b32 v200, 0
    v_mov_b32 v201, 0
    v_mov_b32 v202, 0
    v_mov_b32 v203, 0
    v_mov_b32 v204, 0
    v_mov_b32 v205, 0
    v_mov_b32 v206, 0
    v_mov_b32 v207, 0
    v_mov_b32 v208, 0
    v_mov_b32 v209, 0
    v_mov_b32 v210, 0
    v_mov_b32 v211, 0
    v_mov_b32 v212, 0
    v_mov_b32 v213, 0
    v_mov_b32 v214, 0
    v_mov_b32 v215, 0
    v_mov_b32 v216, 0
    v_mov_b32 v217, 0
    v_mov_b32 v218, 0
    v_mov_b32 v219, 0
    v_mov_b32 v220, 0
    v_mov_b32 v221, 0
    v_mov_b32 v222, 0
    v_mov_b32 v223, 0
    v_mov_b32 v224, 0
    v_mov_b32 v225, 0
    v_mov_b32 v226, 0
    v_mov_b32 v227, 0
    v_mov_b32 v228, 0
    v_mov_b32 v229, 0
    v_mov_b32 v230, 0
    v_mov_b32 v231, 0
    v_mov_b32 v232, 0
    v_mov_b32 v233, 0
    v_mov_b32 v234, 0
    v_mov_b32 v235, 0
    v_mov_b32 v236, 0
    v_mov_b32 v237, 0
    v_mov_b32 v238, 0
    v_mov_b32 v239, 0
    v_mov_b32 v240, 0
    v_mov_b32 v241, 0
    v_mov_b32 v242, 0
    v_mov_b32 v243, 0
    v_mov_b32 v244, 0
    v_mov_b32 v245, 0
    v_mov_b32 v246, 0
    v_mov_b32 v247, 0
    s_barrier
    ds_read_b128 v[16:19], v2 offset:2048
    ds_read_b128 v[20:23], v2 offset:4096
    ds_read_b128 v[24:27], v2 offset:6144
    ds_read_b128 v[28:31], v2 offset:8192
    ds_read_b128 v[32:35], v2 offset:0
    ds_read_b64_tr_b16 v[36:37], v4 offset:256
    ds_read_b64_tr_b16 v[38:39], v4 offset:4096
    ds_read_b64_tr_b16 v[40:41], v4 offset:288
    ds_read_b64_tr_b16 v[42:43], v4 offset:4128
    ds_read_b64_tr_b16 v[44:45], v4 offset:320
    ds_read_b64_tr_b16 v[46:47], v4 offset:4160
    ds_read_b64_tr_b16 v[48:49], v4 offset:352
    ds_read_b64_tr_b16 v[50:51], v4 offset:4192
    ds_read_b64_tr_b16 v[52:53], v4 offset:384
    ds_read_b64_tr_b16 v[54:55], v4 offset:4224
    ds_read_b64_tr_b16 v[56:57], v4 offset:416
    ds_read_b64_tr_b16 v[58:59], v4 offset:4256
    ds_read_b64_tr_b16 v[60:61], v4 offset:448
    ds_read_b64_tr_b16 v[62:63], v4 offset:4288
    s_waitcnt lgkmcnt(0)
    s_barrier
    s_mov_b32 s26, 0
K1q01_cloop:
    v_mfma_f32_16x16x32_bf16 v[120:123], v[36:39], v[16:19], v[120:123]
    ds_read_b128 v[68:71], v3 offset:2048
    v_mfma_f32_16x16x32_bf16 v[124:127], v[40:43], v[16:19], v[124:127]
    ds_read_b128 v[72:75], v3 offset:4096
    v_mfma_f32_16x16x32_bf16 v[128:131], v[44:47], v[16:19], v[128:131]
    ds_read_b128 v[76:79], v3 offset:6144
    v_mfma_f32_16x16x32_bf16 v[132:135], v[48:51], v[16:19], v[132:135]
    ds_read_b128 v[80:83], v3 offset:8192
    v_mfma_f32_16x16x32_bf16 v[136:139], v[52:55], v[16:19], v[136:139]
    ds_read_b128 v[84:87], v3 offset:0
    v_mfma_f32_16x16x32_bf16 v[140:143], v[56:59], v[16:19], v[140:143]
    ds_read_b64_tr_b16 v[88:89], v4 offset:15616
    v_mfma_f32_16x16x32_bf16 v[144:147], v[60:63], v[16:19], v[144:147]
    ds_read_b64_tr_b16 v[90:91], v4 offset:19456
    v_mfma_f32_16x16x32_bf16 v[148:151], v[36:39], v[20:23], v[148:151]
    ds_read_b64_tr_b16 v[92:93], v4 offset:15648
    v_mfma_f32_16x16x32_bf16 v[152:155], v[40:43], v[20:23], v[152:155]
    ds_read_b64_tr_b16 v[94:95], v4 offset:19488
    v_mfma_f32_16x16x32_bf16 v[156:159], v[44:47], v[20:23], v[156:159]
    ds_read_b64_tr_b16 v[96:97], v4 offset:15680
    v_mfma_f32_16x16x32_bf16 v[160:163], v[48:51], v[20:23], v[160:163]
    ds_read_b64_tr_b16 v[98:99], v4 offset:19520
    v_mfma_f32_16x16x32_bf16 v[164:167], v[52:55], v[20:23], v[164:167]
    ds_read_b64_tr_b16 v[100:101], v4 offset:15712
    v_mfma_f32_16x16x32_bf16 v[168:171], v[56:59], v[20:23], v[168:171]
    ds_read_b64_tr_b16 v[102:103], v4 offset:19552
    v_mfma_f32_16x16x32_bf16 v[172:175], v[60:63], v[20:23], v[172:175]
    ds_read_b64_tr_b16 v[104:105], v4 offset:15744
    v_mfma_f32_16x16x32_bf16 v[176:179], v[36:39], v[24:27], v[176:179]
    ds_read_b64_tr_b16 v[106:107], v4 offset:19584
    v_mfma_f32_16x16x32_bf16 v[180:183], v[40:43], v[24:27], v[180:183]
    ds_read_b64_tr_b16 v[108:109], v4 offset:15776
    v_mfma_f32_16x16x32_bf16 v[184:187], v[44:47], v[24:27], v[184:187]
    ds_read_b64_tr_b16 v[110:111], v4 offset:19616
    v_mfma_f32_16x16x32_bf16 v[188:191], v[48:51], v[24:27], v[188:191]
    ds_read_b64_tr_b16 v[112:113], v4 offset:15808
    v_mfma_f32_16x16x32_bf16 v[192:195], v[52:55], v[24:27], v[192:195]
    ds_read_b64_tr_b16 v[114:115], v4 offset:19648
    v_mfma_f32_16x16x32_bf16 v[196:199], v[56:59], v[24:27], v[196:199]
    v_mfma_f32_16x16x32_bf16 v[200:203], v[60:63], v[24:27], v[200:203]
    v_mfma_f32_16x16x32_bf16 v[204:207], v[36:39], v[28:31], v[204:207]
    v_mfma_f32_16x16x32_bf16 v[208:211], v[40:43], v[28:31], v[208:211]
    v_mfma_f32_16x16x32_bf16 v[212:215], v[44:47], v[28:31], v[212:215]
    s_waitcnt lgkmcnt(0)
    s_barrier
    v_mfma_f32_16x16x32_bf16 v[216:219], v[48:51], v[28:31], v[216:219]
    v_mfma_f32_16x16x32_bf16 v[220:223], v[52:55], v[28:31], v[220:223]
    v_mfma_f32_16x16x32_bf16 v[224:227], v[56:59], v[28:31], v[224:227]
    v_mfma_f32_16x16x32_bf16 v[228:231], v[60:63], v[28:31], v[228:231]
    v_mfma_f32_16x16x32_bf16 v[232:235], v[36:39], v[32:35], v[232:235]
    v_mfma_f32_16x16x32_bf16 v[236:239], v[40:43], v[32:35], v[236:239]
    v_mfma_f32_16x16x32_bf16 v[240:243], v[44:47], v[32:35], v[240:243]
    v_mfma_f32_16x16x32_bf16 v[244:247], v[48:51], v[32:35], v[244:247]
    v_mfma_f32_16x16x32_bf16 v[120:123], v[88:91], v[68:71], v[120:123]
    ds_read_b128 v[16:19], v2 offset:20480
    v_mfma_f32_16x16x32_bf16 v[124:127], v[92:95], v[68:71], v[124:127]
    ds_read_b128 v[20:23], v2 offset:22528
    v_mfma_f32_16x16x32_bf16 v[128:131], v[96:99], v[68:71], v[128:131]
    ds_read_b128 v[24:27], v2 offset:24576
    v_mfma_f32_16x16x32_bf16 v[132:135], v[100:103], v[68:71], v[132:135]
    ds_read_b128 v[28:31], v2 offset:26624
    v_mfma_f32_16x16x32_bf16 v[136:139], v[104:107], v[68:71], v[136:139]
    ds_read_b128 v[32:35], v2 offset:18432
    v_mfma_f32_16x16x32_bf16 v[140:143], v[108:111], v[68:71], v[140:143]
    ds_read_b64_tr_b16 v[36:37], v4 offset:30976
    v_mfma_f32_16x16x32_bf16 v[144:147], v[112:115], v[68:71], v[144:147]
    ds_read_b64_tr_b16 v[38:39], v4 offset:34816
    v_mfma_f32_16x16x32_bf16 v[148:151], v[88:91], v[72:75], v[148:151]
    ds_read_b64_tr_b16 v[40:41], v4 offset:31008
    v_mfma_f32_16x16x32_bf16 v[152:155], v[92:95], v[72:75], v[152:155]
    ds_read_b64_tr_b16 v[42:43], v4 offset:34848
    v_mfma_f32_16x16x32_bf16 v[156:159], v[96:99], v[72:75], v[156:159]
    ds_read_b64_tr_b16 v[44:45], v4 offset:31040
    v_mfma_f32_16x16x32_bf16 v[160:163], v[100:103], v[72:75], v[160:163]
    ds_read_b64_tr_b16 v[46:47], v4 offset:34880
    v_mfma_f32_16x16x32_bf16 v[164:167], v[104:107], v[72:75], v[164:167]
    ds_read_b64_tr_b16 v[48:49], v4 offset:31072
    v_mfma_f32_16x16x32_bf16 v[168:171], v[108:111], v[72:75], v[168:171]
    ds_read_b64_tr_b16 v[50:51], v4 offset:34912
    v_mfma_f32_16x16x32_bf16 v[172:175], v[112:115], v[72:75], v[172:175]
    ds_read_b64_tr_b16 v[52:53], v4 offset:31104
    v_mfma_f32_16x16x32_bf16 v[176:179], v[88:91], v[76:79], v[176:179]
    ds_read_b64_tr_b16 v[54:55], v4 offset:34944
    v_mfma_f32_16x16x32_bf16 v[180:183], v[92:95], v[76:79], v[180:183]
    ds_read_b64_tr_b16 v[56:57], v4 offset:31136
    v_mfma_f32_16x16x32_bf16 v[184:187], v[96:99], v[76:79], v[184:187]
    ds_read_b64_tr_b16 v[58:59], v4 offset:34976
    v_mfma_f32_16x16x32_bf16 v[188:191], v[100:103], v[76:79], v[188:191]
    ds_read_b64_tr_b16 v[60:61], v4 offset:31168
    v_mfma_f32_16x16x32_bf16 v[192:195], v[104:107], v[76:79], v[192:195]
    ds_read_b64_tr_b16 v[62:63], v4 offset:35008
    v_mfma_f32_16x16x32_bf16 v[196:199], v[108:111], v[76:79], v[196:199]
    v_mfma_f32_16x16x32_bf16 v[200:203], v[112:115], v[76:79], v[200:203]
    v_mfma_f32_16x16x32_bf16 v[204:207], v[88:91], v[80:83], v[204:207]
    v_mfma_f32_16x16x32_bf16 v[208:211], v[92:95], v[80:83], v[208:211]
    v_mfma_f32_16x16x32_bf16 v[212:215], v[96:99], v[80:83], v[212:215]
    s_waitcnt lgkmcnt(0)
    s_barrier
    v_mfma_f32_16x16x32_bf16 v[216:219], v[100:103], v[80:83], v[216:219]
    v_mfma_f32_16x16x32_bf16 v[220:223], v[104:107], v[80:83], v[220:223]
    v_mfma_f32_16x16x32_bf16 v[224:227], v[108:111], v[80:83], v[224:227]
    v_mfma_f32_16x16x32_bf16 v[228:231], v[112:115], v[80:83], v[228:231]
    v_mfma_f32_16x16x32_bf16 v[232:235], v[88:91], v[84:87], v[232:235]
    v_mfma_f32_16x16x32_bf16 v[236:239], v[92:95], v[84:87], v[236:239]
    v_mfma_f32_16x16x32_bf16 v[240:243], v[96:99], v[84:87], v[240:243]
    v_mfma_f32_16x16x32_bf16 v[244:247], v[100:103], v[84:87], v[244:247]
    v_mfma_f32_16x16x32_bf16 v[120:123], v[36:39], v[16:19], v[120:123]
    ds_read_b128 v[68:71], v3 offset:20480
    v_mfma_f32_16x16x32_bf16 v[124:127], v[40:43], v[16:19], v[124:127]
    ds_read_b128 v[72:75], v3 offset:22528
    v_mfma_f32_16x16x32_bf16 v[128:131], v[44:47], v[16:19], v[128:131]
    ds_read_b128 v[76:79], v3 offset:24576
    v_mfma_f32_16x16x32_bf16 v[132:135], v[48:51], v[16:19], v[132:135]
    ds_read_b128 v[80:83], v3 offset:26624
    v_mfma_f32_16x16x32_bf16 v[136:139], v[52:55], v[16:19], v[136:139]
    ds_read_b128 v[84:87], v3 offset:18432
    v_mfma_f32_16x16x32_bf16 v[140:143], v[56:59], v[16:19], v[140:143]
    ds_read_b64_tr_b16 v[88:89], v5 offset:256
    v_mfma_f32_16x16x32_bf16 v[144:147], v[60:63], v[16:19], v[144:147]
    ds_read_b64_tr_b16 v[90:91], v5 offset:4096
    v_mfma_f32_16x16x32_bf16 v[148:151], v[36:39], v[20:23], v[148:151]
    ds_read_b64_tr_b16 v[92:93], v5 offset:288
    v_mfma_f32_16x16x32_bf16 v[152:155], v[40:43], v[20:23], v[152:155]
    ds_read_b64_tr_b16 v[94:95], v5 offset:4128
    v_mfma_f32_16x16x32_bf16 v[156:159], v[44:47], v[20:23], v[156:159]
    ds_read_b64_tr_b16 v[96:97], v5 offset:320
    v_mfma_f32_16x16x32_bf16 v[160:163], v[48:51], v[20:23], v[160:163]
    ds_read_b64_tr_b16 v[98:99], v5 offset:4160
    v_mfma_f32_16x16x32_bf16 v[164:167], v[52:55], v[20:23], v[164:167]
    ds_read_b64_tr_b16 v[100:101], v5 offset:352
    v_mfma_f32_16x16x32_bf16 v[168:171], v[56:59], v[20:23], v[168:171]
    ds_read_b64_tr_b16 v[102:103], v5 offset:4192
    v_mfma_f32_16x16x32_bf16 v[172:175], v[60:63], v[20:23], v[172:175]
    ds_read_b64_tr_b16 v[104:105], v5 offset:384
    v_mfma_f32_16x16x32_bf16 v[176:179], v[36:39], v[24:27], v[176:179]
    ds_read_b64_tr_b16 v[106:107], v5 offset:4224
    v_mfma_f32_16x16x32_bf16 v[180:183], v[40:43], v[24:27], v[180:183]
    ds_read_b64_tr_b16 v[108:109], v5 offset:416
    v_mfma_f32_16x16x32_bf16 v[184:187], v[44:47], v[24:27], v[184:187]
    ds_read_b64_tr_b16 v[110:111], v5 offset:4256
    v_mfma_f32_16x16x32_bf16 v[188:191], v[48:51], v[24:27], v[188:191]
    ds_read_b64_tr_b16 v[112:113], v5 offset:448
    v_mfma_f32_16x16x32_bf16 v[192:195], v[52:55], v[24:27], v[192:195]
    ds_read_b64_tr_b16 v[114:115], v5 offset:4288
    v_mfma_f32_16x16x32_bf16 v[196:199], v[56:59], v[24:27], v[196:199]
    v_mfma_f32_16x16x32_bf16 v[200:203], v[60:63], v[24:27], v[200:203]
    v_mfma_f32_16x16x32_bf16 v[204:207], v[36:39], v[28:31], v[204:207]
    v_mfma_f32_16x16x32_bf16 v[208:211], v[40:43], v[28:31], v[208:211]
    v_mfma_f32_16x16x32_bf16 v[212:215], v[44:47], v[28:31], v[212:215]
    s_waitcnt lgkmcnt(0)
    s_barrier
    v_mfma_f32_16x16x32_bf16 v[216:219], v[48:51], v[28:31], v[216:219]
    v_mfma_f32_16x16x32_bf16 v[220:223], v[52:55], v[28:31], v[220:223]
    v_mfma_f32_16x16x32_bf16 v[224:227], v[56:59], v[28:31], v[224:227]
    v_mfma_f32_16x16x32_bf16 v[228:231], v[60:63], v[28:31], v[228:231]
    v_mfma_f32_16x16x32_bf16 v[232:235], v[36:39], v[32:35], v[232:235]
    v_mfma_f32_16x16x32_bf16 v[236:239], v[40:43], v[32:35], v[236:239]
    v_mfma_f32_16x16x32_bf16 v[240:243], v[44:47], v[32:35], v[240:243]
    v_mfma_f32_16x16x32_bf16 v[244:247], v[48:51], v[32:35], v[244:247]
    v_mfma_f32_16x16x32_bf16 v[120:123], v[88:91], v[68:71], v[120:123]
    ds_read_b128 v[16:19], v2 offset:38912
    v_mfma_f32_16x16x32_bf16 v[124:127], v[92:95], v[68:71], v[124:127]
    ds_read_b128 v[20:23], v2 offset:40960
    v_mfma_f32_16x16x32_bf16 v[128:131], v[96:99], v[68:71], v[128:131]
    ds_read_b128 v[24:27], v2 offset:43008
    v_mfma_f32_16x16x32_bf16 v[132:135], v[100:103], v[68:71], v[132:135]
    ds_read_b128 v[28:31], v2 offset:45056
    v_mfma_f32_16x16x32_bf16 v[136:139], v[104:107], v[68:71], v[136:139]
    ds_read_b128 v[32:35], v2 offset:36864
    v_mfma_f32_16x16x32_bf16 v[140:143], v[108:111], v[68:71], v[140:143]
    ds_read_b64_tr_b16 v[36:37], v5 offset:15616
    v_mfma_f32_16x16x32_bf16 v[144:147], v[112:115], v[68:71], v[144:147]
    ds_read_b64_tr_b16 v[38:39], v5 offset:19456
    v_mfma_f32_16x16x32_bf16 v[148:151], v[88:91], v[72:75], v[148:151]
    ds_read_b64_tr_b16 v[40:41], v5 offset:15648
    v_mfma_f32_16x16x32_bf16 v[152:155], v[92:95], v[72:75], v[152:155]
    ds_read_b64_tr_b16 v[42:43], v5 offset:19488
    v_mfma_f32_16x16x32_bf16 v[156:159], v[96:99], v[72:75], v[156:159]
    ds_read_b64_tr_b16 v[44:45], v5 offset:15680
    v_mfma_f32_16x16x32_bf16 v[160:163], v[100:103], v[72:75], v[160:163]
    ds_read_b64_tr_b16 v[46:47], v5 offset:19520
    v_mfma_f32_16x16x32_bf16 v[164:167], v[104:107], v[72:75], v[164:167]
    ds_read_b64_tr_b16 v[48:49], v5 offset:15712
    v_mfma_f32_16x16x32_bf16 v[168:171], v[108:111], v[72:75], v[168:171]
    ds_read_b64_tr_b16 v[50:51], v5 offset:19552
    v_mfma_f32_16x16x32_bf16 v[172:175], v[112:115], v[72:75], v[172:175]
    ds_read_b64_tr_b16 v[52:53], v5 offset:15744
    v_mfma_f32_16x16x32_bf16 v[176:179], v[88:91], v[76:79], v[176:179]
    ds_read_b64_tr_b16 v[54:55], v5 offset:19584
    v_mfma_f32_16x16x32_bf16 v[180:183], v[92:95], v[76:79], v[180:183]
    ds_read_b64_tr_b16 v[56:57], v5 offset:15776
    v_mfma_f32_16x16x32_bf16 v[184:187], v[96:99], v[76:79], v[184:187]
    ds_read_b64_tr_b16 v[58:59], v5 offset:19616
    v_mfma_f32_16x16x32_bf16 v[188:191], v[100:103], v[76:79], v[188:191]
    ds_read_b64_tr_b16 v[60:61], v5 offset:15808
    v_mfma_f32_16x16x32_bf16 v[192:195], v[104:107], v[76:79], v[192:195]
    ds_read_b64_tr_b16 v[62:63], v5 offset:19648
    v_mfma_f32_16x16x32_bf16 v[196:199], v[108:111], v[76:79], v[196:199]
    v_mfma_f32_16x16x32_bf16 v[200:203], v[112:115], v[76:79], v[200:203]
    v_mfma_f32_16x16x32_bf16 v[204:207], v[88:91], v[80:83], v[204:207]
    v_mfma_f32_16x16x32_bf16 v[208:211], v[92:95], v[80:83], v[208:211]
    v_mfma_f32_16x16x32_bf16 v[212:215], v[96:99], v[80:83], v[212:215]
    s_waitcnt lgkmcnt(0)
    s_barrier
    v_mfma_f32_16x16x32_bf16 v[216:219], v[100:103], v[80:83], v[216:219]
    v_mfma_f32_16x16x32_bf16 v[220:223], v[104:107], v[80:83], v[220:223]
    v_mfma_f32_16x16x32_bf16 v[224:227], v[108:111], v[80:83], v[224:227]
    v_mfma_f32_16x16x32_bf16 v[228:231], v[112:115], v[80:83], v[228:231]
    v_mfma_f32_16x16x32_bf16 v[232:235], v[88:91], v[84:87], v[232:235]
    v_mfma_f32_16x16x32_bf16 v[236:239], v[92:95], v[84:87], v[236:239]
    v_mfma_f32_16x16x32_bf16 v[240:243], v[96:99], v[84:87], v[240:243]
    v_mfma_f32_16x16x32_bf16 v[244:247], v[100:103], v[84:87], v[244:247]
    v_mfma_f32_16x16x32_bf16 v[120:123], v[36:39], v[16:19], v[120:123]
    ds_read_b128 v[68:71], v3 offset:38912
    v_mfma_f32_16x16x32_bf16 v[124:127], v[40:43], v[16:19], v[124:127]
    ds_read_b128 v[72:75], v3 offset:40960
    v_mfma_f32_16x16x32_bf16 v[128:131], v[44:47], v[16:19], v[128:131]
    ds_read_b128 v[76:79], v3 offset:43008
    v_mfma_f32_16x16x32_bf16 v[132:135], v[48:51], v[16:19], v[132:135]
    ds_read_b128 v[80:83], v3 offset:45056
    v_mfma_f32_16x16x32_bf16 v[136:139], v[52:55], v[16:19], v[136:139]
    ds_read_b128 v[84:87], v3 offset:36864
    v_mfma_f32_16x16x32_bf16 v[140:143], v[56:59], v[16:19], v[140:143]
    ds_read_b64_tr_b16 v[88:89], v5 offset:30976
    v_mfma_f32_16x16x32_bf16 v[144:147], v[60:63], v[16:19], v[144:147]
    ds_read_b64_tr_b16 v[90:91], v5 offset:34816
    v_mfma_f32_16x16x32_bf16 v[148:151], v[36:39], v[20:23], v[148:151]
    ds_read_b64_tr_b16 v[92:93], v5 offset:31008
    v_mfma_f32_16x16x32_bf16 v[152:155], v[40:43], v[20:23], v[152:155]
    ds_read_b64_tr_b16 v[94:95], v5 offset:34848
    v_mfma_f32_16x16x32_bf16 v[156:159], v[44:47], v[20:23], v[156:159]
    ds_read_b64_tr_b16 v[96:97], v5 offset:31040
    v_mfma_f32_16x16x32_bf16 v[160:163], v[48:51], v[20:23], v[160:163]
    ds_read_b64_tr_b16 v[98:99], v5 offset:34880
    v_mfma_f32_16x16x32_bf16 v[164:167], v[52:55], v[20:23], v[164:167]
    ds_read_b64_tr_b16 v[100:101], v5 offset:31072
    v_mfma_f32_16x16x32_bf16 v[168:171], v[56:59], v[20:23], v[168:171]
    ds_read_b64_tr_b16 v[102:103], v5 offset:34912
    v_mfma_f32_16x16x32_bf16 v[172:175], v[60:63], v[20:23], v[172:175]
    ds_read_b64_tr_b16 v[104:105], v5 offset:31104
    v_mfma_f32_16x16x32_bf16 v[176:179], v[36:39], v[24:27], v[176:179]
    ds_read_b64_tr_b16 v[106:107], v5 offset:34944
    v_mfma_f32_16x16x32_bf16 v[180:183], v[40:43], v[24:27], v[180:183]
    ds_read_b64_tr_b16 v[108:109], v5 offset:31136
    v_mfma_f32_16x16x32_bf16 v[184:187], v[44:47], v[24:27], v[184:187]
    ds_read_b64_tr_b16 v[110:111], v5 offset:34976
    v_mfma_f32_16x16x32_bf16 v[188:191], v[48:51], v[24:27], v[188:191]
    ds_read_b64_tr_b16 v[112:113], v5 offset:31168
    v_mfma_f32_16x16x32_bf16 v[192:195], v[52:55], v[24:27], v[192:195]
    ds_read_b64_tr_b16 v[114:115], v5 offset:35008
    v_mfma_f32_16x16x32_bf16 v[196:199], v[56:59], v[24:27], v[196:199]
    v_mfma_f32_16x16x32_bf16 v[200:203], v[60:63], v[24:27], v[200:203]
    v_mfma_f32_16x16x32_bf16 v[204:207], v[36:39], v[28:31], v[204:207]
    v_mfma_f32_16x16x32_bf16 v[208:211], v[40:43], v[28:31], v[208:211]
    v_mfma_f32_16x16x32_bf16 v[212:215], v[44:47], v[28:31], v[212:215]
    s_waitcnt lgkmcnt(0)
    s_barrier
    v_mfma_f32_16x16x32_bf16 v[216:219], v[48:51], v[28:31], v[216:219]
    v_mfma_f32_16x16x32_bf16 v[220:223], v[52:55], v[28:31], v[220:223]
    v_mfma_f32_16x16x32_bf16 v[224:227], v[56:59], v[28:31], v[224:227]
    v_mfma_f32_16x16x32_bf16 v[228:231], v[60:63], v[28:31], v[228:231]
    v_mfma_f32_16x16x32_bf16 v[232:235], v[36:39], v[32:35], v[232:235]
    v_mfma_f32_16x16x32_bf16 v[236:239], v[40:43], v[32:35], v[236:239]
    v_mfma_f32_16x16x32_bf16 v[240:243], v[44:47], v[32:35], v[240:243]
    v_mfma_f32_16x16x32_bf16 v[244:247], v[48:51], v[32:35], v[244:247]
    v_mfma_f32_16x16x32_bf16 v[120:123], v[88:91], v[68:71], v[120:123]
    ds_read_b128 v[16:19], v2 offset:2048
    v_mfma_f32_16x16x32_bf16 v[124:127], v[92:95], v[68:71], v[124:127]
    ds_read_b128 v[20:23], v2 offset:4096
    v_mfma_f32_16x16x32_bf16 v[128:131], v[96:99], v[68:71], v[128:131]
    ds_read_b128 v[24:27], v2 offset:6144
    v_mfma_f32_16x16x32_bf16 v[132:135], v[100:103], v[68:71], v[132:135]
    ds_read_b128 v[28:31], v2 offset:8192
    v_mfma_f32_16x16x32_bf16 v[136:139], v[104:107], v[68:71], v[136:139]
    ds_read_b128 v[32:35], v2 offset:0
    v_mfma_f32_16x16x32_bf16 v[140:143], v[108:111], v[68:71], v[140:143]
    ds_read_b64_tr_b16 v[36:37], v4 offset:256
    v_mfma_f32_16x16x32_bf16 v[144:147], v[112:115], v[68:71], v[144:147]
    ds_read_b64_tr_b16 v[38:39], v4 offset:4096
    v_mfma_f32_16x16x32_bf16 v[148:151], v[88:91], v[72:75], v[148:151]
    ds_read_b64_tr_b16 v[40:41], v4 offset:288
    v_mfma_f32_16x16x32_bf16 v[152:155], v[92:95], v[72:75], v[152:155]
    ds_read_b64_tr_b16 v[42:43], v4 offset:4128
    v_mfma_f32_16x16x32_bf16 v[156:159], v[96:99], v[72:75], v[156:159]
    ds_read_b64_tr_b16 v[44:45], v4 offset:320
    v_mfma_f32_16x16x32_bf16 v[160:163], v[100:103], v[72:75], v[160:163]
    ds_read_b64_tr_b16 v[46:47], v4 offset:4160
    v_mfma_f32_16x16x32_bf16 v[164:167], v[104:107], v[72:75], v[164:167]
    ds_read_b64_tr_b16 v[48:49], v4 offset:352
    v_mfma_f32_16x16x32_bf16 v[168:171], v[108:111], v[72:75], v[168:171]
    ds_read_b64_tr_b16 v[50:51], v4 offset:4192
    v_mfma_f32_16x16x32_bf16 v[172:175], v[112:115], v[72:75], v[172:175]
    ds_read_b64_tr_b16 v[52:53], v4 offset:384
    v_mfma_f32_16x16x32_bf16 v[176:179], v[88:91], v[76:79], v[176:179]
    ds_read_b64_tr_b16 v[54:55], v4 offset:4224
    v_mfma_f32_16x16x32_bf16 v[180:183], v[92:95], v[76:79], v[180:183]
    ds_read_b64_tr_b16 v[56:57], v4 offset:416
    v_mfma_f32_16x16x32_bf16 v[184:187], v[96:99], v[76:79], v[184:187]
    ds_read_b64_tr_b16 v[58:59], v4 offset:4256
    v_mfma_f32_16x16x32_bf16 v[188:191], v[100:103], v[76:79], v[188:191]
    ds_read_b64_tr_b16 v[60:61], v4 offset:448
    v_mfma_f32_16x16x32_bf16 v[192:195], v[104:107], v[76:79], v[192:195]
    ds_read_b64_tr_b16 v[62:63], v4 offset:4288
    v_mfma_f32_16x16x32_bf16 v[196:199], v[108:111], v[76:79], v[196:199]
    v_mfma_f32_16x16x32_bf16 v[200:203], v[112:115], v[76:79], v[200:203]
    v_mfma_f32_16x16x32_bf16 v[204:207], v[88:91], v[80:83], v[204:207]
    v_mfma_f32_16x16x32_bf16 v[208:211], v[92:95], v[80:83], v[208:211]
    v_mfma_f32_16x16x32_bf16 v[212:215], v[96:99], v[80:83], v[212:215]
    s_waitcnt lgkmcnt(0)
    s_barrier
    v_mfma_f32_16x16x32_bf16 v[216:219], v[100:103], v[80:83], v[216:219]
    v_mfma_f32_16x16x32_bf16 v[220:223], v[104:107], v[80:83], v[220:223]
    v_mfma_f32_16x16x32_bf16 v[224:227], v[108:111], v[80:83], v[224:227]
    v_mfma_f32_16x16x32_bf16 v[228:231], v[112:115], v[80:83], v[228:231]
    v_mfma_f32_16x16x32_bf16 v[232:235], v[88:91], v[84:87], v[232:235]
    v_mfma_f32_16x16x32_bf16 v[236:239], v[92:95], v[84:87], v[236:239]
    v_mfma_f32_16x16x32_bf16 v[240:243], v[96:99], v[84:87], v[240:243]
    v_mfma_f32_16x16x32_bf16 v[244:247], v[100:103], v[84:87], v[244:247]
    s_add_u32 s26, s26, 1
    s_cmp_lt_u32 s26, 3
    s_cbranch_scc1 K1q01_cloop
    v_mfma_f32_16x16x32_bf16 v[120:123], v[36:39], v[16:19], v[120:123]
    ds_read_b128 v[68:71], v3 offset:2048
    v_mfma_f32_16x16x32_bf16 v[124:127], v[40:43], v[16:19], v[124:127]
    ds_read_b128 v[72:75], v3 offset:4096
    v_mfma_f32_16x16x32_bf16 v[128:131], v[44:47], v[16:19], v[128:131]
    ds_read_b128 v[76:79], v3 offset:6144
    v_mfma_f32_16x16x32_bf16 v[132:135], v[48:51], v[16:19], v[132:135]
    ds_read_b128 v[80:83], v3 offset:8192
    v_mfma_f32_16x16x32_bf16 v[136:139], v[52:55], v[16:19], v[136:139]
    ds_read_b128 v[84:87], v3 offset:0
    v_mfma_f32_16x16x32_bf16 v[140:143], v[56:59], v[16:19], v[140:143]
    ds_read_b64_tr_b16 v[88:89], v4 offset:15616
    v_mfma_f32_16x16x32_bf16 v[144:147], v[60:63], v[16:19], v[144:147]
    ds_read_b64_tr_b16 v[90:91], v4 offset:19456
    v_mfma_f32_16x16x32_bf16 v[148:151], v[36:39], v[20:23], v[148:151]
    ds_read_b64_tr_b16 v[92:93], v4 offset:15648
    v_mfma_f32_16x16x32_bf16 v[152:155], v[40:43], v[20:23], v[152:155]
    ds_read_b64_tr_b16 v[94:95], v4 offset:19488
    v_mfma_f32_16x16x32_bf16 v[156:159], v[44:47], v[20:23], v[156:159]
    ds_read_b64_tr_b16 v[96:97], v4 offset:15680
    v_mfma_f32_16x16x32_bf16 v[160:163], v[48:51], v[20:23], v[160:163]
    ds_read_b64_tr_b16 v[98:99], v4 offset:19520
    v_mfma_f32_16x16x32_bf16 v[164:167], v[52:55], v[20:23], v[164:167]
    ds_read_b64_tr_b16 v[100:101], v4 offset:15712
    v_mfma_f32_16x16x32_bf16 v[168:171], v[56:59], v[20:23], v[168:171]
    ds_read_b64_tr_b16 v[102:103], v4 offset:19552
    v_mfma_f32_16x16x32_bf16 v[172:175], v[60:63], v[20:23], v[172:175]
    ds_read_b64_tr_b16 v[104:105], v4 offset:15744
    v_mfma_f32_16x16x32_bf16 v[176:179], v[36:39], v[24:27], v[176:179]
    ds_read_b64_tr_b16 v[106:107], v4 offset:19584
    v_mfma_f32_16x16x32_bf16 v[180:183], v[40:43], v[24:27], v[180:183]
    ds_read_b64_tr_b16 v[108:109], v4 offset:15776
    v_mfma_f32_16x16x32_bf16 v[184:187], v[44:47], v[24:27], v[184:187]
    ds_read_b64_tr_b16 v[110:111], v4 offset:19616
    v_mfma_f32_16x16x32_bf16 v[188:191], v[48:51], v[24:27], v[188:191]
    ds_read_b64_tr_b16 v[112:113], v4 offset:15808
    v_mfma_f32_16x16x32_bf16 v[192:195], v[52:55], v[24:27], v[192:195]
    ds_read_b64_tr_b16 v[114:115], v4 offset:19648
    v_mfma_f32_16x16x32_bf16 v[196:199], v[56:59], v[24:27], v[196:199]
    v_mfma_f32_16x16x32_bf16 v[200:203], v[60:63], v[24:27], v[200:203]
    v_mfma_f32_16x16x32_bf16 v[204:207], v[36:39], v[28:31], v[204:207]
    v_mfma_f32_16x16x32_bf16 v[208:211], v[40:43], v[28:31], v[208:211]
    v_mfma_f32_16x16x32_bf16 v[212:215], v[44:47], v[28:31], v[212:215]
    s_waitcnt lgkmcnt(0)
    s_barrier
    v_mfma_f32_16x16x32_bf16 v[216:219], v[48:51], v[28:31], v[216:219]
    v_mfma_f32_16x16x32_bf16 v[220:223], v[52:55], v[28:31], v[220:223]
    v_mfma_f32_16x16x32_bf16 v[224:227], v[56:59], v[28:31], v[224:227]
    v_mfma_f32_16x16x32_bf16 v[228:231], v[60:63], v[28:31], v[228:231]
    v_mfma_f32_16x16x32_bf16 v[232:235], v[36:39], v[32:35], v[232:235]
    v_mfma_f32_16x16x32_bf16 v[236:239], v[40:43], v[32:35], v[236:239]
    v_mfma_f32_16x16x32_bf16 v[240:243], v[44:47], v[32:35], v[240:243]
    v_mfma_f32_16x16x32_bf16 v[244:247], v[48:51], v[32:35], v[244:247]
    v_mfma_f32_16x16x32_bf16 v[120:123], v[88:91], v[68:71], v[120:123]
    v_mfma_f32_16x16x32_bf16 v[124:127], v[92:95], v[68:71], v[124:127]
    v_mfma_f32_16x16x32_bf16 v[128:131], v[96:99], v[68:71], v[128:131]
    v_mfma_f32_16x16x32_bf16 v[132:135], v[100:103], v[68:71], v[132:135]
    v_mfma_f32_16x16x32_bf16 v[136:139], v[104:107], v[68:71], v[136:139]
    v_mfma_f32_16x16x32_bf16 v[140:143], v[108:111], v[68:71], v[140:143]
    v_mfma_f32_16x16x32_bf16 v[144:147], v[112:115], v[68:71], v[144:147]
    v_mfma_f32_16x16x32_bf16 v[148:151], v[88:91], v[72:75], v[148:151]
    v_mfma_f32_16x16x32_bf16 v[152:155], v[92:95], v[72:75], v[152:155]
    v_mfma_f32_16x16x32_bf16 v[156:159], v[96:99], v[72:75], v[156:159]
    v_mfma_f32_16x16x32_bf16 v[160:163], v[100:103], v[72:75], v[160:163]
    v_mfma_f32_16x16x32_bf16 v[164:167], v[104:107], v[72:75], v[164:167]
    v_mfma_f32_16x16x32_bf16 v[168:171], v[108:111], v[72:75], v[168:171]
    v_mfma_f32_16x16x32_bf16 v[172:175], v[112:115], v[72:75], v[172:175]
    v_mfma_f32_16x16x32_bf16 v[176:179], v[88:91], v[76:79], v[176:179]
    v_mfma_f32_16x16x32_bf16 v[180:183], v[92:95], v[76:79], v[180:183]
    v_mfma_f32_16x16x32_bf16 v[184:187], v[96:99], v[76:79], v[184:187]
    v_mfma_f32_16x16x32_bf16 v[188:191], v[100:103], v[76:79], v[188:191]
    v_mfma_f32_16x16x32_bf16 v[192:195], v[104:107], v[76:79], v[192:195]
    v_mfma_f32_16x16x32_bf16 v[196:199], v[108:111], v[76:79], v[196:199]
    v_mfma_f32_16x16x32_bf16 v[200:203], v[112:115], v[76:79], v[200:203]
    v_mfma_f32_16x16x32_bf16 v[204:207], v[88:91], v[80:83], v[204:207]
    v_mfma_f32_16x16x32_bf16 v[208:211], v[92:95], v[80:83], v[208:211]
    v_mfma_f32_16x16x32_bf16 v[212:215], v[96:99], v[80:83], v[212:215]
    s_waitcnt lgkmcnt(0)
    s_barrier
    v_mfma_f32_16x16x32_bf16 v[216:219], v[100:103], v[80:83], v[216:219]
    v_mfma_f32_16x16x32_bf16 v[220:223], v[104:107], v[80:83], v[220:223]
    v_mfma_f32_16x16x32_bf16 v[224:227], v[108:111], v[80:83], v[224:227]
    v_mfma_f32_16x16x32_bf16 v[228:231], v[112:115], v[80:83], v[228:231]
    v_mfma_f32_16x16x32_bf16 v[232:235], v[88:91], v[84:87], v[232:235]
    v_mfma_f32_16x16x32_bf16 v[236:239], v[92:95], v[84:87], v[236:239]
    v_mfma_f32_16x16x32_bf16 v[240:243], v[96:99], v[84:87], v[240:243]
    v_mfma_f32_16x16x32_bf16 v[244:247], v[100:103], v[84:87], v[244:247]
    v_and_b32 v6, 15, v0
    v_mul_u32_u24 v6, 504, v6
    v_lshrrev_b32 v7, 4, v0
    v_lshl_add_u32 v6, v7, 3, v6
    v_cvt_pk_bf16_f32 v16, v120, v121
    v_cvt_pk_bf16_f32 v17, v122, v123
    v_cvt_pk_bf16_f32 v18, v124, v125
    v_cvt_pk_bf16_f32 v19, v126, v127
    v_cvt_pk_bf16_f32 v20, v128, v129
    v_cvt_pk_bf16_f32 v21, v130, v131
    v_cvt_pk_bf16_f32 v22, v132, v133
    v_cvt_pk_bf16_f32 v23, v134, v135
    v_cvt_pk_bf16_f32 v24, v136, v137
    v_cvt_pk_bf16_f32 v25, v138, v139
    v_cvt_pk_bf16_f32 v26, v140, v141
    v_cvt_pk_bf16_f32 v27, v142, v143
    v_cvt_pk_bf16_f32 v28, v144, v145
    v_cvt_pk_bf16_f32 v29, v146, v147
    v_cvt_pk_bf16_f32 v30, v148, v149
    v_cvt_pk_bf16_f32 v31, v150, v151
    v_cvt_pk_bf16_f32 v32, v152, v153
    v_cvt_pk_bf16_f32 v33, v154, v155
    v_cvt_pk_bf16_f32 v34, v156, v157
    v_cvt_pk_bf16_f32 v35, v158, v159
    v_cvt_pk_bf16_f32 v36, v160, v161
    v_cvt_pk_bf16_f32 v37, v162, v163
    v_cvt_pk_bf16_f32 v38, v164, v165
    v_cvt_pk_bf16_f32 v39, v166, v167
    v_cvt_pk_bf16_f32 v40, v168, v169
    v_cvt_pk_bf16_f32 v41, v170, v171
    v_cvt_pk_bf16_f32 v42, v172, v173
    v_cvt_pk_bf16_f32 v43, v174, v175
    v_cvt_pk_bf16_f32 v44, v176, v177
    v_cvt_pk_bf16_f32 v45, v178, v179
    v_cvt_pk_bf16_f32 v46, v180, v181
    v_cvt_pk_bf16_f32 v47, v182, v183
    v_cvt_pk_bf16_f32 v48, v184, v185
    v_cvt_pk_bf16_f32 v49, v186, v187
    v_cvt_pk_bf16_f32 v50, v188, v189
    v_cvt_pk_bf16_f32 v51, v190, v191
    v_cvt_pk_bf16_f32 v52, v192, v193
    v_cvt_pk_bf16_f32 v53, v194, v195
    v_cvt_pk_bf16_f32 v54, v196, v197
    v_cvt_pk_bf16_f32 v55, v198, v199
    v_cvt_pk_bf16_f32 v56, v200, v201
    v_cvt_pk_bf16_f32 v57, v202, v203
    v_cvt_pk_bf16_f32 v58, v204, v205
    v_cvt_pk_bf16_f32 v59, v206, v207
    v_cvt_pk_bf16_f32 v60, v208, v209
    v_cvt_pk_bf16_f32 v61, v210, v211
    v_cvt_pk_bf16_f32 v62, v212, v213
    v_cvt_pk_bf16_f32 v63, v214, v215
    v_cvt_pk_bf16_f32 v64, v216, v217
    v_cvt_pk_bf16_f32 v65, v218, v219
    v_cvt_pk_bf16_f32 v66, v220, v221
    v_cvt_pk_bf16_f32 v67, v222, v223
    v_cvt_pk_bf16_f32 v68, v224, v225
    v_cvt_pk_bf16_f32 v69, v226, v227
    v_cvt_pk_bf16_f32 v70, v228, v229
    v_cvt_pk_bf16_f32 v71, v230, v231
    v_cvt_pk_bf16_f32 v72, v232, v233
    v_cvt_pk_bf16_f32 v73, v234, v235
    v_cvt_pk_bf16_f32 v74, v236, v237
    v_cvt_pk_bf16_f32 v75, v238, v239
    v_cvt_pk_bf16_f32 v76, v240, v241
    v_cvt_pk_bf16_f32 v77, v242, v243
    v_cvt_pk_bf16_f32 v78, v244, v245
    v_cvt_pk_bf16_f32 v79, v246, v247
    v_add_u32 v7, 0x8000, v6
    ds_write_b64 v6, v[16:17] offset:8320
    ds_write_b64 v6, v[18:19] offset:8352
    ds_write_b64 v6, v[20:21] offset:8384
    ds_write_b64 v6, v[22:23] offset:8416
    ds_write_b64 v6, v[24:25] offset:8448
    ds_write_b64 v6, v[26:27] offset:8480
    ds_write_b64 v6, v[28:29] offset:8512
    ds_write_b64 v6, v[30:31] offset:16384
    ds_write_b64 v6, v[32:33] offset:16416
    ds_write_b64 v6, v[34:35] offset:16448
    ds_write_b64 v6, v[36:37] offset:16480
    ds_write_b64 v6, v[38:39] offset:16512
    ds_write_b64 v6, v[40:41] offset:16544
    ds_write_b64 v6, v[42:43] offset:16576
    ds_write_b64 v6, v[44:45] offset:24448
    ds_write_b64 v6, v[46:47] offset:24480
    ds_write_b64 v6, v[48:49] offset:24512
    ds_write_b64 v6, v[50:51] offset:24544
    ds_write_b64 v6, v[52:53] offset:24576
    ds_write_b64 v6, v[54:55] offset:24608
    ds_write_b64 v6, v[56:57] offset:24640
    ds_write_b64 v6, v[58:59] offset:32512
    ds_write_b64 v6, v[60:61] offset:32544
    ds_write_b64 v6, v[62:63] offset:32576
    ds_write_b64 v6, v[64:65] offset:32608
    ds_write_b64 v6, v[66:67] offset:32640
    ds_write_b64 v6, v[68:69] offset:32672
    ds_write_b64 v6, v[70:71] offset:32704
    ds_write_b64 v6, v[72:73] offset:256
    ds_write_b64 v6, v[74:75] offset:288
    ds_write_b64 v6, v[76:77] offset:320
    ds_write_b64 v6, v[78:79] offset:352
    s_branch K1_att
K1_q11:
    v_and_b32 v14, 15, v0
    v_lshrrev_b32 v15, 4, v0
    v_and_b32 v6, 7, v14
    v_xor_b32 v6, v15, v6
    v_lshlrev_b32 v14, 7, v14
    v_lshl_add_u32 v2, v6, 4, v14
    v_xor_b32 v3, 64, v2
    v_lshrrev_b32 v6, 1, v15
    v_lshlrev_b32 v6, 4, v6
    v_and_b32 v7, 1, v15
    v_lshl_add_u32 v6, v7, 2, v6
    v_lshrrev_b32 v7, 2, v0
    v_and_b32 v7, 3, v7
    v_add_u32 v6, v6, v7
    v_mul_u32_u24 v6, 480, v6
    v_and_b32 v7, 3, v0
    v_lshl_add_u32 v6, v7, 3, v6
    v_add_u32 v4, 55296, v6
    v_add_u32 v5, 101376, v6
    v_mov_b32 v120, 0
    v_mov_b32 v121, 0
    v_mov_b32 v122, 0
    v_mov_b32 v123, 0
    v_mov_b32 v124, 0
    v_mov_b32 v125, 0
    v_mov_b32 v126, 0
    v_mov_b32 v127, 0
    v_mov_b32 v128, 0
    v_mov_b32 v129, 0
    v_mov_b32 v130, 0
    v_mov_b32 v131, 0
    v_mov_b32 v132, 0
    v_mov_b32 v133, 0
    v_mov_b32 v134, 0
    v_mov_b32 v135, 0
    v_mov_b32 v136, 0
    v_mov_b32 v137, 0
    v_mov_b32 v138, 0
    v_mov_b32 v139, 0
    v_mov_b32 v140, 0
    v_mov_b32 v141, 0
    v_mov_b32 v142, 0
    v_mov_b32 v143, 0
    v_mov_b32 v144, 0
    v_mov_b32 v145, 0
    v_mov_b32 v146, 0
    v_mov_b32 v147, 0
    v_mov_b32 v148, 0
    v_mov_b32 v149, 0
    v_mov_b32 v150, 0
    v_mov_b32 v151, 0
    v_mov_b32 v152, 0
    v_mov_b32 v153, 0
    v_mov_b32 v154, 0
    v_mov_b32 v155, 0
    v_mov_b32 v156, 0
    v_mov_b32 v157, 0
    v_mov_b32 v158, 0
    v_mov_b32 v159, 0
    v_mov_b32 v160, 0
    v_mov_b32 v161, 0
    v_mov_b32 v162, 0
    v_mov_b32 v163, 0
    v_mov_b32 v164, 0
    v_mov_b32 v165, 0
    v_mov_b32 v166, 0
    v_mov_b32 v167, 0
    v_mov_b32 v168, 0
    v_mov_b32 v169, 0
    v_mov_b32 v170, 0
    v_mov_b32 v171, 0
    v_mov_b32 v172, 0
    v_mov_b32 v173, 0
    v_mov_b32 v174, 0
    v_mov_b32 v175, 0
    v_mov_b32 v176, 0
    v_mov_b32 v177, 0
    v_mov_b32 v178, 0
    v_mov_b32 v179, 0
    v_mov_b32 v180, 0
    v_mov_b32 v181, 0
    v_mov_b32 v182, 0
    v_mov_b32 v183, 0
    v_mov_b32 v184, 0
    v_mov_b32 v185, 0
    v_mov_b32 v186, 0
    v_mov_b32 v187, 0
    v_mov_b32 v188, 0
    v_mov_b32 v189, 0
    v_mov_b32 v190, 0
    v_mov_b32 v191, 0
    v_mov_b32 v192, 0
    v_mov_b32 v193, 0
    v_mov_b32 v194, 0
    v_mov_b32 v195, 0
    v_mov_b32 v196, 0
    v_mov_b32 v197, 0
    v_mov_b32 v198, 0
    v_mov_b32 v199, 0
    v_mov_b32 v200, 0
    v_mov_b32 v201, 0
    v_mov_b32 v202, 0
    v_mov_b32 v203, 0
    v_mov_b32 v204, 0
    v_mov_b32 v205, 0
    v_mov_b32 v206, 0
    v_mov_b32 v207, 0
    v_mov_b32 v208, 0
    v_mov_b32 v209, 0
    v_mov_b32 v210, 0
    v_mov_b32 v211, 0
    v_mov_b32 v212, 0
    v_mov_b32 v213, 0
    v_mov_b32 v214, 0
    v_mov_b32 v215, 0
    v_mov_b32 v216, 0
    v_mov_b32 v217, 0
    v_mov_b32 v218, 0
    v_mov_b32 v219, 0
    v_mov_b32 v220, 0
    v_mov_b32 v221, 0
    v_mov_b32 v222, 0
    v_mov_b32 v223, 0
    v_mov_b32 v224, 0
    v_mov_b32 v225, 0
    v_mov_b32 v226, 0
    v_mov_b32 v227, 0
    v_mov_b32 v228, 0
    v_mov_b32 v229, 0
    v_mov_b32 v230, 0
    v_mov_b32 v231, 0
    v_mov_b32 v232, 0
    v_mov_b32 v233, 0
    v_mov_b32 v234, 0
    v_mov_b32 v235, 0
    v_mov_b32 v236, 0
    v_mov_b32 v237, 0
    v_mov_b32 v238, 0
    v_mov_b32 v239, 0
    v_mov_b32 v240, 0
    v_mov_b32 v241, 0
    v_mov_b32 v242, 0
    v_mov_b32 v243, 0
    s_barrier
    ds_read_b128 v[16:19], v2 offset:10240
    ds_read_b128 v[20:23], v2 offset:12288
    ds_read_b128 v[24:27], v2 offset:14336
    ds_read_b128 v[28:31], v2 offset:16384
    ds_read_b128 v[32:35], v2 offset:0
    ds_read_b64_tr_b16 v[36:37], v4 offset:256
    ds_read_b64_tr_b16 v[38:39], v4 offset:4096
    ds_read_b64_tr_b16 v[40:41], v4 offset:288
    ds_read_b64_tr_b16 v[42:43], v4 offset:4128
    ds_read_b64_tr_b16 v[44:45], v4 offset:320
    ds_read_b64_tr_b16 v[46:47], v4 offset:4160
    ds_read_b64_tr_b16 v[48:49], v4 offset:352
    ds_read_b64_tr_b16 v[50:51], v4 offset:4192
    ds_read_b64_tr_b16 v[52:53], v4 offset:384
    ds_read_b64_tr_b16 v[54:55], v4 offset:4224
    ds_read_b64_tr_b16 v[56:57], v4 offset:416
    ds_read_b64_tr_b16 v[58:59], v4 offset:4256
    ds_read_b64_tr_b16 v[60:61], v4 offset:448
    ds_read_b64_tr_b16 v[62:63], v4 offset:4288
    s_waitcnt lgkmcnt(0)
    s_barrier
    s_mov_b32 s26, 0
K1q11_cloop:
    v_mfma_f32_16x16x32_bf16 v[120:123], v[36:39], v[16:19], v[120:123]
    ds_read_b128 v[68:71], v3 offset:10240
    v_mfma_f32_16x16x32_bf16 v[124:127], v[40:43], v[16:19], v[124:127]
    ds_read_b128 v[72:75], v3 offset:12288
    v_mfma_f32_16x16x32_bf16 v[128:131], v[44:47], v[16:19], v[128:131]
    ds_read_b128 v[76:79], v3 offset:14336
    v_mfma_f32_16x16x32_bf16 v[132:135], v[48:51], v[16:19], v[132:135]
    ds_read_b128 v[80:83], v3 offset:16384
    v_mfma_f32_16x16x32_bf16 v[136:139], v[52:55], v[16:19], v[136:139]
    ds_read_b128 v[84:87], v3 offset:0
    v_mfma_f32_16x16x32_bf16 v[140:143], v[56:59], v[16:19], v[140:143]
    ds_read_b64_tr_b16 v[88:89], v4 offset:15616
    v_mfma_f32_16x16x32_bf16 v[144:147], v[60:63], v[16:19], v[144:147]
    ds_read_b64_tr_b16 v[90:91], v4 offset:19456
    v_mfma_f32_16x16x32_bf16 v[148:151], v[36:39], v[20:23], v[148:151]
    ds_read_b64_tr_b16 v[92:93], v4 offset:15648
    v_mfma_f32_16x16x32_bf16 v[152:155], v[40:43], v[20:23], v[152:155]
    ds_read_b64_tr_b16 v[94:95], v4 offset:19488
    v_mfma_f32_16x16x32_bf16 v[156:159], v[44:47], v[20:23], v[156:159]
    ds_read_b64_tr_b16 v[96:97], v4 offset:15680
    v_mfma_f32_16x16x32_bf16 v[160:163], v[48:51], v[20:23], v[160:163]
    ds_read_b64_tr_b16 v[98:99], v4 offset:19520
    v_mfma_f32_16x16x32_bf16 v[164:167], v[52:55], v[20:23], v[164:167]
    ds_read_b64_tr_b16 v[100:101], v4 offset:15712
    v_mfma_f32_16x16x32_bf16 v[168:171], v[56:59], v[20:23], v[168:171]
    ds_read_b64_tr_b16 v[102:103], v4 offset:19552
    v_mfma_f32_16x16x32_bf16 v[172:175], v[60:63], v[20:23], v[172:175]
    ds_read_b64_tr_b16 v[104:105], v4 offset:15744
    v_mfma_f32_16x16x32_bf16 v[176:179], v[36:39], v[24:27], v[176:179]
    ds_read_b64_tr_b16 v[106:107], v4 offset:19584
    v_mfma_f32_16x16x32_bf16 v[180:183], v[40:43], v[24:27], v[180:183]
    ds_read_b64_tr_b16 v[108:109], v4 offset:15776
    v_mfma_f32_16x16x32_bf16 v[184:187], v[44:47], v[24:27], v[184:187]
    ds_read_b64_tr_b16 v[110:111], v4 offset:19616
    v_mfma_f32_16x16x32_bf16 v[188:191], v[48:51], v[24:27], v[188:191]
    ds_read_b64_tr_b16 v[112:113], v4 offset:15808
    v_mfma_f32_16x16x32_bf16 v[192:195], v[52:55], v[24:27], v[192:195]
    ds_read_b64_tr_b16 v[114:115], v4 offset:19648
    v_mfma_f32_16x16x32_bf16 v[196:199], v[56:59], v[24:27], v[196:199]
    v_mfma_f32_16x16x32_bf16 v[200:203], v[60:63], v[24:27], v[200:203]
    v_mfma_f32_16x16x32_bf16 v[204:207], v[36:39], v[28:31], v[204:207]
    v_mfma_f32_16x16x32_bf16 v[208:211], v[40:43], v[28:31], v[208:211]
    s_waitcnt lgkmcnt(0)
    s_barrier
    v_mfma_f32_16x16x32_bf16 v[212:215], v[44:47], v[28:31], v[212:215]
    v_mfma_f32_16x16x32_bf16 v[216:219], v[48:51], v[28:31], v[216:219]
    v_mfma_f32_16x16x32_bf16 v[220:223], v[52:55], v[28:31], v[220:223]
    v_mfma_f32_16x16x32_bf16 v[224:227], v[56:59], v[28:31], v[224:227]
    v_mfma_f32_16x16x32_bf16 v[228:231], v[60:63], v[28:31], v[228:231]
    v_mfma_f32_16x16x32_bf16 v[232:235], v[52:55], v[32:35], v[232:235]
    v_mfma_f32_16x16x32_bf16 v[236:239], v[56:59], v[32:35], v[236:239]
    v_mfma_f32_16x16x32_bf16 v[240:243], v[60:63], v[32:35], v[240:243]
    v_mfma_f32_16x16x32_bf16 v[120:123], v[88:91], v[68:71], v[120:123]
    ds_read_b128 v[16:19], v2 offset:28672
    v_mfma_f32_16x16x32_bf16 v[124:127], v[92:95], v[68:71], v[124:127]
    ds_read_b128 v[20:23], v2 offset:30720
    v_mfma_f32_16x16x32_bf16 v[128:131], v[96:99], v[68:71], v[128:131]
    ds_read_b128 v[24:27], v2 offset:32768
    v_mfma_f32_16x16x32_bf16 v[132:135], v[100:103], v[68:71], v[132:135]
    ds_read_b128 v[28:31], v2 offset:34816
    v_mfma_f32_16x16x32_bf16 v[136:139], v[104:107], v[68:71], v[136:139]
    ds_read_b128 v[32:35], v2 offset:18432
    v_mfma_f32_16x16x32_bf16 v[140:143], v[108:111], v[68:71], v[140:143]
    ds_read_b64_tr_b16 v[36:37], v4 offset:30976
    v_mfma_f32_16x16x32_bf16 v[144:147], v[112:115], v[68:71], v[144:147]
    ds_read_b64_tr_b16 v[38:39], v4 offset:34816
    v_mfma_f32_16x16x32_bf16 v[148:151], v[88:91], v[72:75], v[148:151]
    ds_read_b64_tr_b16 v[40:41], v4 offset:31008
    v_mfma_f32_16x16x32_bf16 v[152:155], v[92:95], v[72:75], v[152:155]
    ds_read_b64_tr_b16 v[42:43], v4 offset:34848
    v_mfma_f32_16x16x32_bf16 v[156:159], v[96:99], v[72:75], v[156:159]
    ds_read_b64_tr_b16 v[44:45], v4 offset:31040
    v_mfma_f32_16x16x32_bf16 v[160:163], v[100:103], v[72:75], v[160:163]
    ds_read_b64_tr_b16 v[46:47], v4 offset:34880
    v_mfma_f32_16x16x32_bf16 v[164:167], v[104:107], v[72:75], v[164:167]
    ds_read_b64_tr_b16 v[48:49], v4 offset:31072
    v_mfma_f32_16x16x32_bf16 v[168:171], v[108:111], v[72:75], v[168:171]
    ds_read_b64_tr_b16 v[50:51], v4 offset:34912
    v_mfma_f32_16x16x32_bf16 v[172:175], v[112:115], v[72:75], v[172:175]
    ds_read_b64_tr_b16 v[52:53], v4 offset:31104
    v_mfma_f32_16x16x32_bf16 v[176:179], v[88:91], v[76:79], v[176:179]
    ds_read_b64_tr_b16 v[54:55], v4 offset:34944
    v_mfma_f32_16x16x32_bf16 v[180:183], v[92:95], v[76:79], v[180:183]
    ds_read_b64_tr_b16 v[56:57], v4 offset:31136
    v_mfma_f32_16x16x32_bf16 v[184:187], v[96:99], v[76:79], v[184:187]
    ds_read_b64_tr_b16 v[58:59], v4 offset:34976
    v_mfma_f32_16x16x32_bf16 v[188:191], v[100:103], v[76:79], v[188:191]
    ds_read_b64_tr_b16 v[60:61], v4 offset:31168
    v_mfma_f32_16x16x32_bf16 v[192:195], v[104:107], v[76:79], v[192:195]
    ds_read_b64_tr_b16 v[62:63], v4 offset:35008
    v_mfma_f32_16x16x32_bf16 v[196:199], v[108:111], v[76:79], v[196:199]
    v_mfma_f32_16x16x32_bf16 v[200:203], v[112:115], v[76:79], v[200:203]
    v_mfma_f32_16x16x32_bf16 v[204:207], v[88:91], v[80:83], v[204:207]
    v_mfma_f32_16x16x32_bf16 v[208:211], v[92:95], v[80:83], v[208:211]
    s_waitcnt lgkmcnt(0)
    s_barrier
    v_mfma_f32_16x16x32_bf16 v[212:215], v[96:99], v[80:83], v[212:215]
    v_mfma_f32_16x16x32_bf16 v[216:219], v[100:103], v[80:83], v[216:219]
    v_mfma_f32_16x16x32_bf16 v[220:223], v[104:107], v[80:83], v[220:223]
    v_mfma_f32_16x16x32_bf16 v[224:227], v[108:111], v[80:83], v[224:227]
    v_mfma_f32_16x16x32_bf16 v[228:231], v[112:115], v[80:83], v[228:231]
    v_mfma_f32_16x16x32_bf16 v[232:235], v[104:107], v[84:87], v[232:235]
    v_mfma_f32_16x16x32_bf16 v[236:239], v[108:111], v[84:87], v[236:239]
    v_mfma_f32_16x16x32_bf16 v[240:243], v[112:115], v[84:87], v[240:243]
    v_mfma_f32_16x16x32_bf16 v[120:123], v[36:39], v[16:19], v[120:123]
    ds_read_b128 v[68:71], v3 offset:28672
    v_mfma_f32_16x16x32_bf16 v[124:127], v[40:43], v[16:19], v[124:127]
    ds_read_b128 v[72:75], v3 offset:30720
    v_mfma_f32_16x16x32_bf16 v[128:131], v[44:47], v[16:19], v[128:131]
    ds_read_b128 v[76:79], v3 offset:32768
    v_mfma_f32_16x16x32_bf16 v[132:135], v[48:51], v[16:19], v[132:135]
    ds_read_b128 v[80:83], v3 offset:34816
    v_mfma_f32_16x16x32_bf16 v[136:139], v[52:55], v[16:19], v[136:139]
    ds_read_b128 v[84:87], v3 offset:18432
    v_mfma_f32_16x16x32_bf16 v[140:143], v[56:59], v[16:19], v[140:143]
    ds_read_b64_tr_b16 v[88:89], v5 offset:256
    v_mfma_f32_16x16x32_bf16 v[144:147], v[60:63], v[16:19], v[144:147]
    ds_read_b64_tr_b16 v[90:91], v5 offset:4096
    v_mfma_f32_16x16x32_bf16 v[148:151], v[36:39], v[20:23], v[148:151]
    ds_read_b64_tr_b16 v[92:93], v5 offset:288
    v_mfma_f32_16x16x32_bf16 v[152:155], v[40:43], v[20:23], v[152:155]
    ds_read_b64_tr_b16 v[94:95], v5 offset:4128
    v_mfma_f32_16x16x32_bf16 v[156:159], v[44:47], v[20:23], v[156:159]
    ds_read_b64_tr_b16 v[96:97], v5 offset:320
    v_mfma_f32_16x16x32_bf16 v[160:163], v[48:51], v[20:23], v[160:163]
    ds_read_b64_tr_b16 v[98:99], v5 offset:4160
    v_mfma_f32_16x16x32_bf16 v[164:167], v[52:55], v[20:23], v[164:167]
    ds_read_b64_tr_b16 v[100:101], v5 offset:352
    v_mfma_f32_16x16x32_bf16 v[168:171], v[56:59], v[20:23], v[168:171]
    ds_read_b64_tr_b16 v[102:103], v5 offset:4192
    v_mfma_f32_16x16x32_bf16 v[172:175], v[60:63], v[20:23], v[172:175]
    ds_read_b64_tr_b16 v[104:105], v5 offset:384
    v_mfma_f32_16x16x32_bf16 v[176:179], v[36:39], v[24:27], v[176:179]
    ds_read_b64_tr_b16 v[106:107], v5 offset:4224
    v_mfma_f32_16x16x32_bf16 v[180:183], v[40:43], v[24:27], v[180:183]
    ds_read_b64_tr_b16 v[108:109], v5 offset:416
    v_mfma_f32_16x16x32_bf16 v[184:187], v[44:47], v[24:27], v[184:187]
    ds_read_b64_tr_b16 v[110:111], v5 offset:4256
    v_mfma_f32_16x16x32_bf16 v[188:191], v[48:51], v[24:27], v[188:191]
    ds_read_b64_tr_b16 v[112:113], v5 offset:448
    v_mfma_f32_16x16x32_bf16 v[192:195], v[52:55], v[24:27], v[192:195]
    ds_read_b64_tr_b16 v[114:115], v5 offset:4288
    v_mfma_f32_16x16x32_bf16 v[196:199], v[56:59], v[24:27], v[196:199]
    v_mfma_f32_16x16x32_bf16 v[200:203], v[60:63], v[24:27], v[200:203]
    v_mfma_f32_16x16x32_bf16 v[204:207], v[36:39], v[28:31], v[204:207]
    v_mfma_f32_16x16x32_bf16 v[208:211], v[40:43], v[28:31], v[208:211]
    s_waitcnt lgkmcnt(0)
    s_barrier
    v_mfma_f32_16x16x32_bf16 v[212:215], v[44:47], v[28:31], v[212:215]
    v_mfma_f32_16x16x32_bf16 v[216:219], v[48:51], v[28:31], v[216:219]
    v_mfma_f32_16x16x32_bf16 v[220:223], v[52:55], v[28:31], v[220:223]
    v_mfma_f32_16x16x32_bf16 v[224:227], v[56:59], v[28:31], v[224:227]
    v_mfma_f32_16x16x32_bf16 v[228:231], v[60:63], v[28:31], v[228:231]
    v_mfma_f32_16x16x32_bf16 v[232:235], v[52:55], v[32:35], v[232:235]
    v_mfma_f32_16x16x32_bf16 v[236:239], v[56:59], v[32:35], v[236:239]
    v_mfma_f32_16x16x32_bf16 v[240:243], v[60:63], v[32:35], v[240:243]
    v_mfma_f32_16x16x32_bf16 v[120:123], v[88:91], v[68:71], v[120:123]
    ds_read_b128 v[16:19], v2 offset:47104
    v_mfma_f32_16x16x32_bf16 v[124:127], v[92:95], v[68:71], v[124:127]
    ds_read_b128 v[20:23], v2 offset:49152
    v_mfma_f32_16x16x32_bf16 v[128:131], v[96:99], v[68:71], v[128:131]
    ds_read_b128 v[24:27], v2 offset:51200
    v_mfma_f32_16x16x32_bf16 v[132:135], v[100:103], v[68:71], v[132:135]
    ds_read_b128 v[28:31], v2 offset:53248
    v_mfma_f32_16x16x32_bf16 v[136:139], v[104:107], v[68:71], v[136:139]
    ds_read_b128 v[32:35], v2 offset:36864
    v_mfma_f32_16x16x32_bf16 v[140:143], v[108:111], v[68:71], v[140:143]
    ds_read_b64_tr_b16 v[36:37], v5 offset:15616
    v_mfma_f32_16x16x32_bf16 v[144:147], v[112:115], v[68:71], v[144:147]
    ds_read_b64_tr_b16 v[38:39], v5 offset:19456
    v_mfma_f32_16x16x32_bf16 v[148:151], v[88:91], v[72:75], v[148:151]
    ds_read_b64_tr_b16 v[40:41], v5 offset:15648
    v_mfma_f32_16x16x32_bf16 v[152:155], v[92:95], v[72:75], v[152:155]
    ds_read_b64_tr_b16 v[42:43], v5 offset:19488
    v_mfma_f32_16x16x32_bf16 v[156:159], v[96:99], v[72:75], v[156:159]
    ds_read_b64_tr_b16 v[44:45], v5 offset:15680
    v_mfma_f32_16x16x32_bf16 v[160:163], v[100:103], v[72:75], v[160:163]
    ds_read_b64_tr_b16 v[46:47], v5 offset:19520
    v_mfma_f32_16x16x32_bf16 v[164:167], v[104:107], v[72:75], v[164:167]
    ds_read_b64_tr_b16 v[48:49], v5 offset:15712
    v_mfma_f32_16x16x32_bf16 v[168:171], v[108:111], v[72:75], v[168:171]
    ds_read_b64_tr_b16 v[50:51], v5 offset:19552
    v_mfma_f32_16x16x32_bf16 v[172:175], v[112:115], v[72:75], v[172:175]
    ds_read_b64_tr_b16 v[52:53], v5 offset:15744
    v_mfma_f32_16x16x32_bf16 v[176:179], v[88:91], v[76:79], v[176:179]
    ds_read_b64_tr_b16 v[54:55], v5 offset:19584
    v_mfma_f32_16x16x32_bf16 v[180:183], v[92:95], v[76:79], v[180:183]
    ds_read_b64_tr_b16 v[56:57], v5 offset:15776
    v_mfma_f32_16x16x32_bf16 v[184:187], v[96:99], v[76:79], v[184:187]
    ds_read_b64_tr_b16 v[58:59], v5 offset:19616
    v_mfma_f32_16x16x32_bf16 v[188:191], v[100:103], v[76:79], v[188:191]
    ds_read_b64_tr_b16 v[60:61], v5 offset:15808
    v_mfma_f32_16x16x32_bf16 v[192:195], v[104:107], v[76:79], v[192:195]
    ds_read_b64_tr_b16 v[62:63], v5 offset:19648
    v_mfma_f32_16x16x32_bf16 v[196:199], v[108:111], v[76:79], v[196:199]
    v_mfma_f32_16x16x32_bf16 v[200:203], v[112:115], v[76:79], v[200:203]
    v_mfma_f32_16x16x32_bf16 v[204:207], v[88:91], v[80:83], v[204:207]
    v_mfma_f32_16x16x32_bf16 v[208:211], v[92:95], v[80:83], v[208:211]
    s_waitcnt lgkmcnt(0)
    s_barrier
    v_mfma_f32_16x16x32_bf16 v[212:215], v[96:99], v[80:83], v[212:215]
    v_mfma_f32_16x16x32_bf16 v[216:219], v[100:103], v[80:83], v[216:219]
    v_mfma_f32_16x16x32_bf16 v[220:223], v[104:107], v[80:83], v[220:223]
    v_mfma_f32_16x16x32_bf16 v[224:227], v[108:111], v[80:83], v[224:227]
    v_mfma_f32_16x16x32_bf16 v[228:231], v[112:115], v[80:83], v[228:231]
    v_mfma_f32_16x16x32_bf16 v[232:235], v[104:107], v[84:87], v[232:235]
    v_mfma_f32_16x16x32_bf16 v[236:239], v[108:111], v[84:87], v[236:239]
    v_mfma_f32_16x16x32_bf16 v[240:243], v[112:115], v[84:87], v[240:243]
    v_mfma_f32_16x16x32_bf16 v[120:123], v[36:39], v[16:19], v[120:123]
    ds_read_b128 v[68:71], v3 offset:47104
    v_mfma_f32_16x16x32_bf16 v[124:127], v[40:43], v[16:19], v[124:127]
    ds_read_b128 v[72:75], v3 offset:49152
    v_mfma_f32_16x16x32_bf16 v[128:131], v[44:47], v[16:19], v[128:131]
    ds_read_b128 v[76:79], v3 offset:51200
    v_mfma_f32_16x16x32_bf16 v[132:135], v[48:51], v[16:19], v[132:135]
    ds_read_b128 v[80:83], v3 offset:53248
    v_mfma_f32_16x16x32_bf16 v[136:139], v[52:55], v[16:19], v[136:139]
    ds_read_b128 v[84:87], v3 offset:36864
    v_mfma_f32_16x16x32_bf16 v[140:143], v[56:59], v[16:19], v[140:143]
    ds_read_b64_tr_b16 v[88:89], v5 offset:30976
    v_mfma_f32_16x16x32_bf16 v[144:147], v[60:63], v[16:19], v[144:147]
    ds_read_b64_tr_b16 v[90:91], v5 offset:34816
    v_mfma_f32_16x16x32_bf16 v[148:151], v[36:39], v[20:23], v[148:151]
    ds_read_b64_tr_b16 v[92:93], v5 offset:31008
    v_mfma_f32_16x16x32_bf16 v[152:155], v[40:43], v[20:23], v[152:155]
    ds_read_b64_tr_b16 v[94:95], v5 offset:34848
    v_mfma_f32_16x16x32_bf16 v[156:159], v[44:47], v[20:23], v[156:159]
    ds_read_b64_tr_b16 v[96:97], v5 offset:31040
    v_mfma_f32_16x16x32_bf16 v[160:163], v[48:51], v[20:23], v[160:163]
    ds_read_b64_tr_b16 v[98:99], v5 offset:34880
    v_mfma_f32_16x16x32_bf16 v[164:167], v[52:55], v[20:23], v[164:167]
    ds_read_b64_tr_b16 v[100:101], v5 offset:31072
    v_mfma_f32_16x16x32_bf16 v[168:171], v[56:59], v[20:23], v[168:171]
    ds_read_b64_tr_b16 v[102:103], v5 offset:34912
    v_mfma_f32_16x16x32_bf16 v[172:175], v[60:63], v[20:23], v[172:175]
    ds_read_b64_tr_b16 v[104:105], v5 offset:31104
    v_mfma_f32_16x16x32_bf16 v[176:179], v[36:39], v[24:27], v[176:179]
    ds_read_b64_tr_b16 v[106:107], v5 offset:34944
    v_mfma_f32_16x16x32_bf16 v[180:183], v[40:43], v[24:27], v[180:183]
    ds_read_b64_tr_b16 v[108:109], v5 offset:31136
    v_mfma_f32_16x16x32_bf16 v[184:187], v[44:47], v[24:27], v[184:187]
    ds_read_b64_tr_b16 v[110:111], v5 offset:34976
    v_mfma_f32_16x16x32_bf16 v[188:191], v[48:51], v[24:27], v[188:191]
    ds_read_b64_tr_b16 v[112:113], v5 offset:31168
    v_mfma_f32_16x16x32_bf16 v[192:195], v[52:55], v[24:27], v[192:195]
    ds_read_b64_tr_b16 v[114:115], v5 offset:35008
    v_mfma_f32_16x16x32_bf16 v[196:199], v[56:59], v[24:27], v[196:199]
    v_mfma_f32_16x16x32_bf16 v[200:203], v[60:63], v[24:27], v[200:203]
    v_mfma_f32_16x16x32_bf16 v[204:207], v[36:39], v[28:31], v[204:207]
    v_mfma_f32_16x16x32_bf16 v[208:211], v[40:43], v[28:31], v[208:211]
    s_waitcnt lgkmcnt(0)
    s_barrier
    v_mfma_f32_16x16x32_bf16 v[212:215], v[44:47], v[28:31], v[212:215]
    v_mfma_f32_16x16x32_bf16 v[216:219], v[48:51], v[28:31], v[216:219]
    v_mfma_f32_16x16x32_bf16 v[220:223], v[52:55], v[28:31], v[220:223]
    v_mfma_f32_16x16x32_bf16 v[224:227], v[56:59], v[28:31], v[224:227]
    v_mfma_f32_16x16x32_bf16 v[228:231], v[60:63], v[28:31], v[228:231]
    v_mfma_f32_16x16x32_bf16 v[232:235], v[52:55], v[32:35], v[232:235]
    v_mfma_f32_16x16x32_bf16 v[236:239], v[56:59], v[32:35], v[236:239]
    v_mfma_f32_16x16x32_bf16 v[240:243], v[60:63], v[32:35], v[240:243]
    v_mfma_f32_16x16x32_bf16 v[120:123], v[88:91], v[68:71], v[120:123]
    ds_read_b128 v[16:19], v2 offset:10240
    v_mfma_f32_16x16x32_bf16 v[124:127], v[92:95], v[68:71], v[124:127]
    ds_read_b128 v[20:23], v2 offset:12288
    v_mfma_f32_16x16x32_bf16 v[128:131], v[96:99], v[68:71], v[128:131]
    ds_read_b128 v[24:27], v2 offset:14336
    v_mfma_f32_16x16x32_bf16 v[132:135], v[100:103], v[68:71], v[132:135]
    ds_read_b128 v[28:31], v2 offset:16384
    v_mfma_f32_16x16x32_bf16 v[136:139], v[104:107], v[68:71], v[136:139]
    ds_read_b128 v[32:35], v2 offset:0
    v_mfma_f32_16x16x32_bf16 v[140:143], v[108:111], v[68:71], v[140:143]
    ds_read_b64_tr_b16 v[36:37], v4 offset:256
    v_mfma_f32_16x16x32_bf16 v[144:147], v[112:115], v[68:71], v[144:147]
    ds_read_b64_tr_b16 v[38:39], v4 offset:4096
    v_mfma_f32_16x16x32_bf16 v[148:151], v[88:91], v[72:75], v[148:151]
    ds_read_b64_tr_b16 v[40:41], v4 offset:288
    v_mfma_f32_16x16x32_bf16 v[152:155], v[92:95], v[72:75], v[152:155]
    ds_read_b64_tr_b16 v[42:43], v4 offset:4128
    v_mfma_f32_16x16x32_bf16 v[156:159], v[96:99], v[72:75], v[156:159]
    ds_read_b64_tr_b16 v[44:45], v4 offset:320
    v_mfma_f32_16x16x32_bf16 v[160:163], v[100:103], v[72:75], v[160:163]
    ds_read_b64_tr_b16 v[46:47], v4 offset:4160
    v_mfma_f32_16x16x32_bf16 v[164:167], v[104:107], v[72:75], v[164:167]
    ds_read_b64_tr_b16 v[48:49], v4 offset:352
    v_mfma_f32_16x16x32_bf16 v[168:171], v[108:111], v[72:75], v[168:171]
    ds_read_b64_tr_b16 v[50:51], v4 offset:4192
    v_mfma_f32_16x16x32_bf16 v[172:175], v[112:115], v[72:75], v[172:175]
    ds_read_b64_tr_b16 v[52:53], v4 offset:384
    v_mfma_f32_16x16x32_bf16 v[176:179], v[88:91], v[76:79], v[176:179]
    ds_read_b64_tr_b16 v[54:55], v4 offset:4224
    v_mfma_f32_16x16x32_bf16 v[180:183], v[92:95], v[76:79], v[180:183]
    ds_read_b64_tr_b16 v[56:57], v4 offset:416
    v_mfma_f32_16x16x32_bf16 v[184:187], v[96:99], v[76:79], v[184:187]
    ds_read_b64_tr_b16 v[58:59], v4 offset:4256
    v_mfma_f32_16x16x32_bf16 v[188:191], v[100:103], v[76:79], v[188:191]
    ds_read_b64_tr_b16 v[60:61], v4 offset:448
    v_mfma_f32_16x16x32_bf16 v[192:195], v[104:107], v[76:79], v[192:195]
    ds_read_b64_tr_b16 v[62:63], v4 offset:4288
    v_mfma_f32_16x16x32_bf16 v[196:199], v[108:111], v[76:79], v[196:199]
    v_mfma_f32_16x16x32_bf16 v[200:203], v[112:115], v[76:79], v[200:203]
    v_mfma_f32_16x16x32_bf16 v[204:207], v[88:91], v[80:83], v[204:207]
    v_mfma_f32_16x16x32_bf16 v[208:211], v[92:95], v[80:83], v[208:211]
    s_waitcnt lgkmcnt(0)
    s_barrier
    v_mfma_f32_16x16x32_bf16 v[212:215], v[96:99], v[80:83], v[212:215]
    v_mfma_f32_16x16x32_bf16 v[216:219], v[100:103], v[80:83], v[216:219]
    v_mfma_f32_16x16x32_bf16 v[220:223], v[104:107], v[80:83], v[220:223]
    v_mfma_f32_16x16x32_bf16 v[224:227], v[108:111], v[80:83], v[224:227]
    v_mfma_f32_16x16x32_bf16 v[228:231], v[112:115], v[80:83], v[228:231]
    v_mfma_f32_16x16x32_bf16 v[232:235], v[104:107], v[84:87], v[232:235]
    v_mfma_f32_16x16x32_bf16 v[236:239], v[108:111], v[84:87], v[236:239]
    v_mfma_f32_16x16x32_bf16 v[240:243], v[112:115], v[84:87], v[240:243]
    s_add_u32 s26, s26, 1
    s_cmp_lt_u32 s26, 3
    s_cbranch_scc1 K1q11_cloop
    v_mfma_f32_16x16x32_bf16 v[120:123], v[36:39], v[16:19], v[120:123]
    ds_read_b128 v[68:71], v3 offset:10240
    v_mfma_f32_16x16x32_bf16 v[124:127], v[40:43], v[16:19], v[124:127]
    ds_read_b128 v[72:75], v3 offset:12288
    v_mfma_f32_16x16x32_bf16 v[128:131], v[44:47], v[16:19], v[128:131]
    ds_read_b128 v[76:79], v3 offset:14336
    v_mfma_f32_16x16x32_bf16 v[132:135], v[48:51], v[16:19], v[132:135]
    ds_read_b128 v[80:83], v3 offset:16384
    v_mfma_f32_16x16x32_bf16 v[136:139], v[52:55], v[16:19], v[136:139]
    ds_read_b128 v[84:87], v3 offset:0
    v_mfma_f32_16x16x32_bf16 v[140:143], v[56:59], v[16:19], v[140:143]
    ds_read_b64_tr_b16 v[88:89], v4 offset:15616
    v_mfma_f32_16x16x32_bf16 v[144:147], v[60:63], v[16:19], v[144:147]
    ds_read_b64_tr_b16 v[90:91], v4 offset:19456
    v_mfma_f32_16x16x32_bf16 v[148:151], v[36:39], v[20:23], v[148:151]
    ds_read_b64_tr_b16 v[92:93], v4 offset:15648
    v_mfma_f32_16x16x32_bf16 v[152:155], v[40:43], v[20:23], v[152:155]
    ds_read_b64_tr_b16 v[94:95], v4 offset:19488
    v_mfma_f32_16x16x32_bf16 v[156:159], v[44:47], v[20:23], v[156:159]
    ds_read_b64_tr_b16 v[96:97], v4 offset:15680
    v_mfma_f32_16x16x32_bf16 v[160:163], v[48:51], v[20:23], v[160:163]
    ds_read_b64_tr_b16 v[98:99], v4 offset:19520
    v_mfma_f32_16x16x32_bf16 v[164:167], v[52:55], v[20:23], v[164:167]
    ds_read_b64_tr_b16 v[100:101], v4 offset:15712
    v_mfma_f32_16x16x32_bf16 v[168:171], v[56:59], v[20:23], v[168:171]
    ds_read_b64_tr_b16 v[102:103], v4 offset:19552
    v_mfma_f32_16x16x32_bf16 v[172:175], v[60:63], v[20:23], v[172:175]
    ds_read_b64_tr_b16 v[104:105], v4 offset:15744
    v_mfma_f32_16x16x32_bf16 v[176:179], v[36:39], v[24:27], v[176:179]
    ds_read_b64_tr_b16 v[106:107], v4 offset:19584
    v_mfma_f32_16x16x32_bf16 v[180:183], v[40:43], v[24:27], v[180:183]
    ds_read_b64_tr_b16 v[108:109], v4 offset:15776
    v_mfma_f32_16x16x32_bf16 v[184:187], v[44:47], v[24:27], v[184:187]
    ds_read_b64_tr_b16 v[110:111], v4 offset:19616
    v_mfma_f32_16x16x32_bf16 v[188:191], v[48:51], v[24:27], v[188:191]
    ds_read_b64_tr_b16 v[112:113], v4 offset:15808
    v_mfma_f32_16x16x32_bf16 v[192:195], v[52:55], v[24:27], v[192:195]
    ds_read_b64_tr_b16 v[114:115], v4 offset:19648
    v_mfma_f32_16x16x32_bf16 v[196:199], v[56:59], v[24:27], v[196:199]
    v_mfma_f32_16x16x32_bf16 v[200:203], v[60:63], v[24:27], v[200:203]
    v_mfma_f32_16x16x32_bf16 v[204:207], v[36:39], v[28:31], v[204:207]
    v_mfma_f32_16x16x32_bf16 v[208:211], v[40:43], v[28:31], v[208:211]
    s_waitcnt lgkmcnt(0)
    s_barrier
    v_mfma_f32_16x16x32_bf16 v[212:215], v[44:47], v[28:31], v[212:215]
    v_mfma_f32_16x16x32_bf16 v[216:219], v[48:51], v[28:31], v[216:219]
    v_mfma_f32_16x16x32_bf16 v[220:223], v[52:55], v[28:31], v[220:223]
    v_mfma_f32_16x16x32_bf16 v[224:227], v[56:59], v[28:31], v[224:227]
    v_mfma_f32_16x16x32_bf16 v[228:231], v[60:63], v[28:31], v[228:231]
    v_mfma_f32_16x16x32_bf16 v[232:235], v[52:55], v[32:35], v[232:235]
    v_mfma_f32_16x16x32_bf16 v[236:239], v[56:59], v[32:35], v[236:239]
    v_mfma_f32_16x16x32_bf16 v[240:243], v[60:63], v[32:35], v[240:243]
    v_mfma_f32_16x16x32_bf16 v[120:123], v[88:91], v[68:71], v[120:123]
    v_mfma_f32_16x16x32_bf16 v[124:127], v[92:95], v[68:71], v[124:127]
    v_mfma_f32_16x16x32_bf16 v[128:131], v[96:99], v[68:71], v[128:131]
    v_mfma_f32_16x16x32_bf16 v[132:135], v[100:103], v[68:71], v[132:135]
    v_mfma_f32_16x16x32_bf16 v[136:139], v[104:107], v[68:71], v[136:139]
    v_mfma_f32_16x16x32_bf16 v[140:143], v[108:111], v[68:71], v[140:143]
    v_mfma_f32_16x16x32_bf16 v[144:147], v[112:115], v[68:71], v[144:147]
    v_mfma_f32_16x16x32_bf16 v[148:151], v[88:91], v[72:75], v[148:151]
    v_mfma_f32_16x16x32_bf16 v[152:155], v[92:95], v[72:75], v[152:155]
    v_mfma_f32_16x16x32_bf16 v[156:159], v[96:99], v[72:75], v[156:159]
    v_mfma_f32_16x16x32_bf16 v[160:163], v[100:103], v[72:75], v[160:163]
    v_mfma_f32_16x16x32_bf16 v[164:167], v[104:107], v[72:75], v[164:167]
    v_mfma_f32_16x16x32_bf16 v[168:171], v[108:111], v[72:75], v[168:171]
    v_mfma_f32_16x16x32_bf16 v[172:175], v[112:115], v[72:75], v[172:175]
    v_mfma_f32_16x16x32_bf16 v[176:179], v[88:91], v[76:79], v[176:179]
    v_mfma_f32_16x16x32_bf16 v[180:183], v[92:95], v[76:79], v[180:183]
    v_mfma_f32_16x16x32_bf16 v[184:187], v[96:99], v[76:79], v[184:187]
    v_mfma_f32_16x16x32_bf16 v[188:191], v[100:103], v[76:79], v[188:191]
    v_mfma_f32_16x16x32_bf16 v[192:195], v[104:107], v[76:79], v[192:195]
    v_mfma_f32_16x16x32_bf16 v[196:199], v[108:111], v[76:79], v[196:199]
    v_mfma_f32_16x16x32_bf16 v[200:203], v[112:115], v[76:79], v[200:203]
    v_mfma_f32_16x16x32_bf16 v[204:207], v[88:91], v[80:83], v[204:207]
    v_mfma_f32_16x16x32_bf16 v[208:211], v[92:95], v[80:83], v[208:211]
    s_waitcnt lgkmcnt(0)
    s_barrier
    v_mfma_f32_16x16x32_bf16 v[212:215], v[96:99], v[80:83], v[212:215]
    v_mfma_f32_16x16x32_bf16 v[216:219], v[100:103], v[80:83], v[216:219]
    v_mfma_f32_16x16x32_bf16 v[220:223], v[104:107], v[80:83], v[220:223]
    v_mfma_f32_16x16x32_bf16 v[224:227], v[108:111], v[80:83], v[224:227]
    v_mfma_f32_16x16x32_bf16 v[228:231], v[112:115], v[80:83], v[228:231]
    v_mfma_f32_16x16x32_bf16 v[232:235], v[104:107], v[84:87], v[232:235]
    v_mfma_f32_16x16x32_bf16 v[236:239], v[108:111], v[84:87], v[236:239]
    v_mfma_f32_16x16x32_bf16 v[240:243], v[112:115], v[84:87], v[240:243]
    v_and_b32 v6, 15, v0
    v_mul_u32_u24 v6, 504, v6
    v_lshrrev_b32 v7, 4, v0
    v_lshl_add_u32 v6, v7, 3, v6
    v_cvt_pk_bf16_f32 v16, v120, v121
    v_cvt_pk_bf16_f32 v17, v122, v123
    v_cvt_pk_bf16_f32 v18, v124, v125
    v_cvt_pk_bf16_f32 v19, v126, v127
    v_cvt_pk_bf16_f32 v20, v128, v129
    v_cvt_pk_bf16_f32 v21, v130, v131
    v_cvt_pk_bf16_f32 v22, v132, v133
    v_cvt_pk_bf16_f32 v23, v134, v135
    v_cvt_pk_bf16_f32 v24, v136, v137
    v_cvt_pk_bf16_f32 v25, v138, v139
    v_cvt_pk_bf16_f32 v26, v140, v141
    v_cvt_pk_bf16_f32 v27, v142, v143
    v_cvt_pk_bf16_f32 v28, v144, v145
    v_cvt_pk_bf16_f32 v29, v146, v147
    v_cvt_pk_bf16_f32 v30, v148, v149
    v_cvt_pk_bf16_f32 v31, v150, v151
    v_cvt_pk_bf16_f32 v32, v152, v153
    v_cvt_pk_bf16_f32 v33, v154, v155
    v_cvt_pk_bf16_f32 v34, v156, v157
    v_cvt_pk_bf16_f32 v35, v158, v159
    v_cvt_pk_bf16_f32 v36, v160, v161
    v_cvt_pk_bf16_f32 v37, v162, v163
    v_cvt_pk_bf16_f32 v38, v164, v165
    v_cvt_pk_bf16_f32 v39, v166, v167
    v_cvt_pk_bf16_f32 v40, v168, v169
    v_cvt_pk_bf16_f32 v41, v170, v171
    v_cvt_pk_bf16_f32 v42, v172, v173
    v_cvt_pk_bf16_f32 v43, v174, v175
    v_cvt_pk_bf16_f32 v44, v176, v177
    v_cvt_pk_bf16_f32 v45, v178, v179
    v_cvt_pk_bf16_f32 v46, v180, v181
    v_cvt_pk_bf16_f32 v47, v182, v183
    v_cvt_pk_bf16_f32 v48, v184, v185
    v_cvt_pk_bf16_f32 v49, v186, v187
    v_cvt_pk_bf16_f32 v50, v188, v189
    v_cvt_pk_bf16_f32 v51, v190, v191
    v_cvt_pk_bf16_f32 v52, v192, v193
    v_cvt_pk_bf16_f32 v53, v194, v195
    v_cvt_pk_bf16_f32 v54, v196, v197
    v_cvt_pk_bf16_f32 v55, v198, v199
    v_cvt_pk_bf16_f32 v56, v200, v201
    v_cvt_pk_bf16_f32 v57, v202, v203
    v_cvt_pk_bf16_f32 v58, v204, v205
    v_cvt_pk_bf16_f32 v59, v206, v207
    v_cvt_pk_bf16_f32 v60, v208, v209
    v_cvt_pk_bf16_f32 v61, v210, v211
    v_cvt_pk_bf16_f32 v62, v212, v213
    v_cvt_pk_bf16_f32 v63, v214, v215
    v_cvt_pk_bf16_f32 v64, v216, v217
    v_cvt_pk_bf16_f32 v65, v218, v219
    v_cvt_pk_bf16_f32 v66, v220, v221
    v_cvt_pk_bf16_f32 v67, v222, v223
    v_cvt_pk_bf16_f32 v68, v224, v225
    v_cvt_pk_bf16_f32 v69, v226, v227
    v_cvt_pk_bf16_f32 v70, v228, v229
    v_cvt_pk_bf16_f32 v71, v230, v231
    v_cvt_pk_bf16_f32 v72, v232, v233
    v_cvt_pk_bf16_f32 v73, v234, v235
    v_cvt_pk_bf16_f32 v74, v236, v237
    v_cvt_pk_bf16_f32 v75, v238, v239
    v_cvt_pk_bf16_f32 v76, v240, v241
    v_cvt_pk_bf16_f32 v77, v242, v243
    v_add_u32 v7, 0x8000, v6
    ds_write_b64 v6, v[16:17] offset:40576
    ds_write_b64 v6, v[18:19] offset:40608
    ds_write_b64 v6, v[20:21] offset:40640
    ds_write_b64 v6, v[22:23] offset:40672
    ds_write_b64 v6, v[24:25] offset:40704
    ds_write_b64 v6, v[26:27] offset:40736
    ds_write_b64 v6, v[28:29] offset:40768
    ds_write_b64 v6, v[30:31] offset:48640
    ds_write_b64 v6, v[32:33] offset:48672
    ds_write_b64 v6, v[34:35] offset:48704
    ds_write_b64 v6, v[36:37] offset:48736
    ds_write_b64 v6, v[38:39] offset:48768
    ds_write_b64 v6, v[40:41] offset:48800
    ds_write_b64 v6, v[42:43] offset:48832
    ds_write_b64 v6, v[44:45] offset:56704
    ds_write_b64 v6, v[46:47] offset:56736
    ds_write_b64 v6, v[48:49] offset:56768
    ds_write_b64 v6, v[50:51] offset:56800
    ds_write_b64 v6, v[52:53] offset:56832
    ds_write_b64 v6, v[54:55] offset:56864
    ds_write_b64 v6, v[56:57] offset:56896
    ds_write_b64 v6, v[58:59] offset:64768
    ds_write_b64 v6, v[60:61] offset:64800
    ds_write_b64 v6, v[62:63] offset:64832
    ds_write_b64 v6, v[64:65] offset:64864
    ds_write_b64 v6, v[66:67] offset:64896
    ds_write_b64 v6, v[68:69] offset:64928
    ds_write_b64 v6, v[70:71] offset:64960
    ds_write_b64 v6, v[72:73] offset:384
    ds_write_b64 v6, v[74:75] offset:416
    ds_write_b64 v6, v[76:77] offset:448
K1_att:
    s_and_b32 s46, s16, 3
    s_lshr_b32 s47, s16, 2
    s_mul_i32 s45, s46, 40
    s_mul_i32 s43, s47, 32256
    s_add_u32 s45, s45, s43
    s_or_b32 s43, s48, s47
    v_lshrrev_b32 v104, 3, v0
    v_lshlrev_b32 v104, 2, v104
    v_and_b32 v105, 3, v0
    v_add_u32 v104, v104, v105
    v_lshrrev_b32 v105, 2, v0
    v_and_b32 v105, 1, v105
    v_lshl_add_u32 v104, v104, 1, v105
    v_mul_u32_u24 v104, 504, v104
    v_add_u32 v102, s45, v104
    v_add_u32 v101, 8064, v102
    v_lshrrev_b32 v105, 4, v0
    v_lshlrev_b32 v105, 2, v105
    v_and_b32 v106, 3, v0
    v_add_u32 v105, v105, v106
    v_lshrrev_b32 v106, 1, v105
    v_lshlrev_b32 v106, 2, v106
    v_and_b32 v105, 1, v105
    v_lshrrev_b32 v103, 2, v0
    v_and_b32 v103, 3, v103
    v_add_u32 v103, v103, v106
    v_lshl_add_u32 v103, v103, 1, v105
    v_mul_u32_u24 v103, 504, v103
    v_add_u32 v103, s45, v103
    v_and_b32 v105, 3, v0
    v_mov_b32 v107, 0xffff
    v_mov_b32 v106, -1
    v_cmp_le_u32 vcc, 1, v105
    s_nop 1
    v_cndmask_b32 v107, v107, v106, vcc
    v_mov_b32 v108, 0
    v_mov_b32 v106, 0xffff
    v_cmp_le_u32 vcc, 2, v105
    s_nop 1
    v_cndmask_b32 v108, v108, v106, vcc
    v_mov_b32 v106, -1
    v_cmp_eq_u32 vcc, 3, v105
    s_nop 1
    v_cndmask_b32 v108, v108, v106, vcc
    v_not_b32 v109, v107
    v_not_b32 v110, v108
    v_mov_b32 v112, 0
    v_mov_b32 v113, 0
    v_mov_b32 v114, 0
    v_mov_b32 v115, 0
    v_mov_b32 v116, 0
    v_mov_b32 v117, 0
    v_mov_b32 v118, 0
    v_mov_b32 v119, 0
    v_mov_b32 v120, 0
    v_mov_b32 v121, 0
    v_mov_b32 v122, 0
    v_mov_b32 v123, 0
    v_mov_b32 v196, 0
    v_mov_b32 v197, 0
    v_mov_b32 v198, 0
    v_mov_b32 v199, 0
    v_mov_b32 v200, 0
    v_mov_b32 v201, 0
    v_mov_b32 v202, 0
    v_mov_b32 v203, 0
    v_mov_b32 v204, 0
    v_mov_b32 v205, 0
    v_mov_b32 v206, 0
    v_mov_b32 v207, 0
    v_mov_b32 v208, 0
    v_mov_b32 v209, 0
    v_mov_b32 v210, 0
    v_mov_b32 v211, 0
    v_mov_b32 v212, 0
    v_mov_b32 v213, 0
    v_mov_b32 v214, 0
    v_mov_b32 v215, 0
    s_mov_b32 s22, 0xeeeeeeee
    s_mov_b32 s23, 0xeeeeeeee
    s_mov_b32 s24, 0xcccccccc
    s_mov_b32 s25, 0xcccccccc
    s_mov_b32 s26, 0x88888888
    s_mov_b32 s27, 0x88888888
    s_lshl_b32 s20, s16, 6
    v_add_u32 v86, s20, v0
    v_add_u32 v87, 0, v86
    v_mul_u32_u24 v88, 6554, v87
    v_lshrrev_b32 v88, 16, v88
    v_mul_u32_u24 v89, 10, v88
    v_sub_u32 v89, v87, v89
    v_mul_u32_u24 v90, 504, v88
    v_lshl_add_u32 v90, v89, 4, v90
    v_add_u32 v90, 8064, v90
    s_lshl_b32 s20, s48, 7
    v_add_u32 v91, s20, v88
    v_mul_u32_u24 v91, 2816, v91
    v_lshl_add_u32 v91, v89, 4, v91
    s_mul_i32 s20, s49, 160
    v_add_u32 v91, s20, v91
    v_add_u32 v87, 512, v86
    v_mul_u32_u24 v88, 6554, v87
    v_lshrrev_b32 v88, 16, v88
    v_mul_u32_u24 v89, 10, v88
    v_sub_u32 v89, v87, v89
    v_mul_u32_u24 v92, 504, v88
    v_lshl_add_u32 v92, v89, 4, v92
    v_add_u32 v92, 8064, v92
    s_lshl_b32 s20, s48, 7
    v_add_u32 v93, s20, v88
    v_mul_u32_u24 v93, 2816, v93
    v_lshl_add_u32 v93, v89, 4, v93
    s_mul_i32 s20, s49, 160
    v_add_u32 v93, s20, v93
    v_add_u32 v87, 1024, v86
    v_mul_u32_u24 v88, 6554, v87
    v_lshrrev_b32 v88, 16, v88
    v_mul_u32_u24 v89, 10, v88
    v_sub_u32 v89, v87, v89
    v_mul_u32_u24 v94, 504, v88
    v_lshl_add_u32 v94, v89, 4, v94
    v_add_u32 v94, 8064, v94
    s_lshl_b32 s20, s48, 7
    v_add_u32 v95, s20, v88
    v_mul_u32_u24 v95, 2816, v95
    v_lshl_add_u32 v95, v89, 4, v95
    s_mul_i32 s20, s49, 160
    v_add_u32 v95, s20, v95
    v_mov_b32 v89, 1073741824
    v_cmp_le_u32 vcc, 1280, v87
    s_nop 1
    v_cndmask_b32 v95, v95, v89, vcc
    v_mov_b32 v89, 0
    v_cndmask_b32 v94, v94, v89, vcc
    s_add_u32 s12, s32, 15728640
    s_addc_u32 s13, s33, 0
    s_mov_b32 s14, 5767168
    s_mov_b32 s15, 0x20000
    s_waitcnt lgkmcnt(0)
    s_barrier
    ds_read_b64 v[124:125], v101 offset:0
    ds_read_b64 v[134:135], v102 offset:160
    ds_read_b64 v[144:145], v102 offset:4192
    ds_read_b64 v[154:155], v102 offset:8224
    ds_read_b64 v[126:127], v101 offset:8
    ds_read_b64 v[136:137], v102 offset:168
    ds_read_b64 v[146:147], v102 offset:4200
    ds_read_b64 v[156:157], v102 offset:8232
    ds_read_b64 v[128:129], v101 offset:16
    ds_read_b64 v[138:139], v102 offset:176
    ds_read_b64 v[148:149], v102 offset:4208
    ds_read_b64 v[158:159], v102 offset:8240
    ds_read_b64 v[130:131], v101 offset:24
    ds_read_b64 v[140:141], v102 offset:184
    ds_read_b64 v[150:151], v102 offset:4216
    ds_read_b64 v[160:161], v102 offset:8248
    ds_read_b64 v[132:133], v101 offset:32
    ds_read_b64 v[142:143], v102 offset:192
    ds_read_b64 v[152:153], v102 offset:4224
    ds_read_b64 v[162:163], v102 offset:8256
    s_waitcnt lgkmcnt(15)
    s_waitcnt lgkmcnt(15)
    v_mfma_f32_4x4x4_16b_bf16 v[112:115], v[134:135], v[124:125], v[112:115]
    v_mfma_f32_4x4x4_16b_bf16 v[116:119], v[144:145], v[124:125], v[116:119]
    v_mfma_f32_4x4x4_16b_bf16 v[120:123], v[154:155], v[124:125], v[120:123]
    s_waitcnt lgkmcnt(12)
    v_mfma_f32_4x4x4_16b_bf16 v[112:115], v[136:137], v[126:127], v[112:115]
    v_mfma_f32_4x4x4_16b_bf16 v[116:119], v[146:147], v[126:127], v[116:119]
    v_mfma_f32_4x4x4_16b_bf16 v[120:123], v[156:157], v[126:127], v[120:123]
    s_waitcnt lgkmcnt(8)
    v_mfma_f32_4x4x4_16b_bf16 v[112:115], v[138:139], v[128:129], v[112:115]
    v_mfma_f32_4x4x4_16b_bf16 v[116:119], v[148:149], v[128:129], v[116:119]
    v_mfma_f32_4x4x4_16b_bf16 v[120:123], v[158:159], v[128:129], v[120:123]
    s_waitcnt lgkmcnt(4)
    v_mfma_f32_4x4x4_16b_bf16 v[112:115], v[140:141], v[130:131], v[112:115]
    v_mfma_f32_4x4x4_16b_bf16 v[116:119], v[150:151], v[130:131], v[116:119]
    v_mfma_f32_4x4x4_16b_bf16 v[120:123], v[160:161], v[130:131], v[120:123]
    s_waitcnt lgkmcnt(0)
    v_mfma_f32_4x4x4_16b_bf16 v[112:115], v[142:143], v[132:133], v[112:115]
    v_mfma_f32_4x4x4_16b_bf16 v[116:119], v[152:153], v[132:133], v[116:119]
    v_mfma_f32_4x4x4_16b_bf16 v[120:123], v[162:163], v[132:133], v[120:123]
    ds_read_b64_tr_b16 v[164:165], v103 offset:320
    ds_read_b64_tr_b16 v[166:167], v103 offset:328
    ds_read_b64_tr_b16 v[168:169], v103 offset:336
    ds_read_b64_tr_b16 v[170:171], v103 offset:344
    ds_read_b64_tr_b16 v[172:173], v103 offset:352
    ds_read_b64_tr_b16 v[174:175], v103 offset:4352
    ds_read_b64_tr_b16 v[176:177], v103 offset:4360
    ds_read_b64_tr_b16 v[178:179], v103 offset:4368
    ds_read_b64_tr_b16 v[180:181], v103 offset:4376
    ds_read_b64_tr_b16 v[182:183], v103 offset:4384
    ds_read_b64_tr_b16 v[184:185], v103 offset:8384
    ds_read_b64_tr_b16 v[186:187], v103 offset:8392
    ds_read_b64_tr_b16 v[188:189], v103 offset:8400
    ds_read_b64_tr_b16 v[190:191], v103 offset:8408
    ds_read_b64_tr_b16 v[192:193], v103 offset:8416
    s_cmp_lg_u32 s43, 0
    s_cbranch_scc1 att_nomask_1
    v_mov_b32 v106, 4048155338
    v_cmp_gt_u32 vcc, 16, v0
    s_nop 1
    v_cndmask_b32 v112, v112, v106, vcc
    v_cndmask_b32 v113, v113, v106, vcc
    v_cndmask_b32 v114, v114, v106, vcc
    v_cndmask_b32 v115, v115, v106, vcc
    v_cmp_gt_u32 vcc, 8, v0
    s_nop 1
    v_cndmask_b32 v116, v116, v106, vcc
    v_cndmask_b32 v117, v117, v106, vcc
    v_cndmask_b32 v118, v118, v106, vcc
    v_cndmask_b32 v119, v119, v106, vcc
    s_nop 4
att_nomask_1:
    s_nop 4
    v_cndmask_b32 v121, v113, v121, s[22:23]
    v_cndmask_b32 v122, v114, v122, s[24:25]
    v_cndmask_b32 v123, v115, v123, s[26:27]
    v_max3_f32 v104, v116, v117, v118
    v_max3_f32 v105, v119, v120, v121
    v_max3_f32 v104, v104, v122, v123
    v_max_f32 v104, v104, v105
    s_mov_b32 s20, 1051011932
    v_mul_f32 v104, s20, v104
    v_fma_f32 v116, v116, s20, -v104
    v_fma_f32 v117, v117, s20, -v104
    v_fma_f32 v118, v118, s20, -v104
    v_fma_f32 v119, v119, s20, -v104
    v_fma_f32 v120, v120, s20, -v104
    v_fma_f32 v121, v121, s20, -v104
    v_fma_f32 v122, v122, s20, -v104
    v_fma_f32 v123, v123, s20, -v104
    v_exp_f32 v116, v116
    v_exp_f32 v117, v117
    v_exp_f32 v118, v118
    v_exp_f32 v119, v119
    v_exp_f32 v120, v120
    v_exp_f32 v121, v121
    v_exp_f32 v122, v122
    v_exp_f32 v123, v123
    v_add_f32 v104, v116, v117
    v_add_f32 v105, v118, v119
    v_add_f32 v106, v120, v121
    v_add_f32 v104, v104, v105
    v_add_f32 v105, v122, v123
    v_add_f32 v104, v104, v106
    v_add_f32 v104, v104, v105
    v_rcp_f32 v104, v104
    s_nop 0
    v_mul_f32 v116, v116, v104
    v_mul_f32 v117, v117, v104
    v_mul_f32 v118, v118, v104
    v_mul_f32 v119, v119, v104
    v_mul_f32 v120, v120, v104
    v_mul_f32 v121, v121, v104
    v_mul_f32 v122, v122, v104
    v_mul_f32 v123, v123, v104
    v_cvt_pk_bf16_f32 v126, v116, v117
    v_cvt_pk_bf16_f32 v127, v118, v119
    v_cvt_pk_bf16_f32 v105, v120, v121
    v_cvt_pk_bf16_f32 v106, v122, v123
    v_and_b32 v128, v105, v107
    v_and_b32 v129, v106, v108
    v_and_b32 v124, v105, v109
    v_and_b32 v125, v106, v110
    s_waitcnt lgkmcnt(0)
    v_mfma_f32_4x4x4_16b_bf16 v[196:199], v[174:175], v[126:127], v[196:199]
    v_mfma_f32_4x4x4_16b_bf16 v[200:203], v[176:177], v[126:127], v[200:203]
    v_mfma_f32_4x4x4_16b_bf16 v[204:207], v[178:179], v[126:127], v[204:207]
    v_mfma_f32_4x4x4_16b_bf16 v[208:211], v[180:181], v[126:127], v[208:211]
    v_mfma_f32_4x4x4_16b_bf16 v[212:215], v[182:183], v[126:127], v[212:215]
    v_mfma_f32_4x4x4_16b_bf16 v[196:199], v[164:165], v[124:125], v[196:199]
    v_mfma_f32_4x4x4_16b_bf16 v[200:203], v[166:167], v[124:125], v[200:203]
    v_mfma_f32_4x4x4_16b_bf16 v[204:207], v[168:169], v[124:125], v[204:207]
    v_mfma_f32_4x4x4_16b_bf16 v[208:211], v[170:171], v[124:125], v[208:211]
    v_mfma_f32_4x4x4_16b_bf16 v[212:215], v[172:173], v[124:125], v[212:215]
    v_mfma_f32_4x4x4_16b_bf16 v[196:199], v[184:185], v[128:129], v[196:199]
    v_mfma_f32_4x4x4_16b_bf16 v[200:203], v[186:187], v[128:129], v[200:203]
    v_mfma_f32_4x4x4_16b_bf16 v[204:207], v[188:189], v[128:129], v[204:207]
    v_mfma_f32_4x4x4_16b_bf16 v[208:211], v[190:191], v[128:129], v[208:211]
    v_mfma_f32_4x4x4_16b_bf16 v[212:215], v[192:193], v[128:129], v[212:215]
    s_nop 0
    v_cvt_pk_bf16_f32 v134, v196, v197
    v_cvt_pk_bf16_f32 v135, v198, v199
    v_cvt_pk_bf16_f32 v136, v200, v201
    v_cvt_pk_bf16_f32 v137, v202, v203
    v_cvt_pk_bf16_f32 v138, v204, v205
    v_cvt_pk_bf16_f32 v139, v206, v207
    v_cvt_pk_bf16_f32 v140, v208, v209
    v_cvt_pk_bf16_f32 v141, v210, v211
    v_cvt_pk_bf16_f32 v142, v212, v213
    v_cvt_pk_bf16_f32 v143, v214, v215
    ds_write_b64 v101, v[134:135] offset:0
    ds_write_b64 v101, v[136:137] offset:8
    ds_write_b64 v101, v[138:139] offset:16
    ds_write_b64 v101, v[140:141] offset:24
    ds_write_b64 v101, v[142:143] offset:32
    s_waitcnt lgkmcnt(0)
    s_barrier
    ds_read_b64 v[16:17], v90
    ds_read_b64 v[18:19], v90 offset:8
    ds_read_b64 v[20:21], v92
    ds_read_b64 v[22:23], v92 offset:8
    ds_read_b64 v[24:25], v94
    ds_read_b64 v[26:27], v94 offset:8
    s_waitcnt lgkmcnt(0)
    buffer_store_dwordx4 v[16:19], v91, s[12:15], 0 offen sc1
    buffer_store_dwordx4 v[20:23], v93, s[12:15], 0 offen sc1
    buffer_store_dwordx4 v[24:27], v95, s[12:15], 0 offen sc1
K1_qnost:
    s_and_b32 s60, s2, 1
    s_lshl_b32 s60, s60, 2
    s_lshr_b32 s61, s2, 6
    s_add_u32 s60, s60, s61
    s_add_u32 s12, s32, 24707072
    s_addc_u32 s13, s33, 0
    s_mov_b32 s14, 2048
    s_mov_b32 s15, 0x20000
    s_lshl_b32 s60, s60, 8
    v_and_b32 v14, 31, v0
    v_lshlrev_b32 v14, 3, v14
    v_add_u32 v14, s60, v14
    s_cmp_lg_u32 s16, 4
    s_cbranch_scc1 K1_nopre_2
    buffer_load_dwordx2 v[18:19], v14, s[12:15], 0 offen sc1
K1_nopre_2:
    s_waitcnt vmcnt(0)
    s_barrier
    s_add_u32 s12, s32, 24641536
    s_addc_u32 s13, s33, 0
    s_mov_b32 s14, 1024
    s_mov_b32 s15, 0x20000
    s_lshl_b32 s20, s48, 6
    s_lshl_b32 s21, s49, 3
    s_add_u32 s20, s20, s21
    s_branch K1_flag
K1_ztype:
    s_and_b32 s48, s40, 1
    s_lshl_b32 s48, s48, 4
    s_and_b32 s42, s41, 15
    s_add_u32 s48, s48, s42
    s_lshr_b32 s49, s40, 1
    s_and_b32 s28, s42, 3
    s_and_b32 s28, s28, 3
    s_lshl_b32 s28, s28, 2
    s_lshr_b32 s28, 34096, s28
    s_and_b32 s28, s28, 15
    s_mul_i32 s17, s48, 81920
    s_mul_i32 s19, s49, 384
    s_add_u32 s18, s19, 1536
    s_cmp_lt_u32 s16, 4
    s_cbranch_scc1 K1_zcomp
    s_mov_b32 s4, s30
    s_mov_b32 s5, s31
    s_mov_b32 s6, 2621440
    s_mov_b32 s7, 0x20000
    s_mov_b32 s8, s36
    s_mov_b32 s9, s37
    s_mov_b32 s10, 1966080
    s_mov_b32 s11, 0x20000
    s_sub_u32 s21, s16, 4
    v_lshrrev_b32 v7, 3, v0
    v_and_b32 v2, 7, v0
    v_xor_b32 v2, v2, v7
    v_mul_u32_u24 v7, 1280, v7
    v_lshl_add_u32 v2, v2, 4, v7
    v_add_u32 v10, 0, v0
    v_mul_u32_u24 v11, 2731, v10
    v_lshrrev_b32 v11, 16, v11
    v_mul_u32_u24 v12, 24, v11
    v_sub_u32 v12, v10, v12
    v_and_b32 v13, 2, v11
    v_add_u32 v13, 0, v13
    v_xor_b32 v12, v12, v13
    v_add_u32 v11, 0, v11
    v_mul_u32_u24 v11, 3072, v11
    v_lshl_add_u32 v3, v12, 4, v11
    v_add_u32 v10, 64, v0
    v_mul_u32_u24 v11, 2731, v10
    v_lshrrev_b32 v11, 16, v11
    v_mul_u32_u24 v12, 24, v11
    v_sub_u32 v12, v10, v12
    v_and_b32 v13, 2, v11
    v_add_u32 v13, 0, v13
    v_xor_b32 v12, v12, v13
    v_add_u32 v11, 0, v11
    v_mul_u32_u24 v11, 3072, v11
    v_lshl_add_u32 v4, v12, 4, v11
    v_subrev_u32 v4, 1024, v4
    v_add_u32 v10, 128, v0
    v_mul_u32_u24 v11, 2731, v10
    v_lshrrev_b32 v11, 16, v11
    v_mul_u32_u24 v12, 24, v11
    v_sub_u32 v12, v10, v12
    v_and_b32 v13, 2, v11
    v_add_u32 v13, 0, v13
    v_xor_b32 v12, v12, v13
    v_add_u32 v11, 0, v11
    v_mul_u32_u24 v11, 3072, v11
    v_lshl_add_u32 v5, v12, 4, v11
    v_subrev_u32 v5, 2048, v5
    v_add_u32 v10, 0, v0
    v_mul_u32_u24 v11, 2731, v10
    v_lshrrev_b32 v11, 16, v11
    v_mul_u32_u24 v12, 24, v11
    v_sub_u32 v12, v10, v12
    v_and_b32 v13, 2, v11
    v_add_u32 v13, 4, v13
    v_xor_b32 v12, v12, v13
    v_add_u32 v11, 8, v11
    v_mul_u32_u24 v11, 3072, v11
    v_lshl_add_u32 v6, v12, 4, v11
    v_add_u32 v10, 64, v0
    v_mul_u32_u24 v11, 2731, v10
    v_lshrrev_b32 v11, 16, v11
    v_mul_u32_u24 v12, 24, v11
    v_sub_u32 v12, v10, v12
    v_and_b32 v13, 2, v11
    v_add_u32 v13, 4, v13
    v_xor_b32 v12, v12, v13
    v_add_u32 v11, 8, v11
    v_mul_u32_u24 v11, 3072, v11
    v_lshl_add_u32 v7, v12, 4, v11
    v_subrev_u32 v7, 1024, v7
    v_add_u32 v10, 128, v0
    v_mul_u32_u24 v11, 2731, v10
    v_lshrrev_b32 v11, 16, v11
    v_mul_u32_u24 v12, 24, v11
    v_sub_u32 v12, v10, v12
    v_and_b32 v13, 2, v11
    v_add_u32 v13, 4, v13
    v_xor_b32 v12, v12, v13
    v_add_u32 v11, 8, v11
    v_mul_u32_u24 v11, 3072, v11
    v_lshl_add_u32 v8, v12, 4, v11
    v_subrev_u32 v8, 2048, v8
    s_mul_i32 s20, s21, 20480
    s_add_u32 s22, s17, s20
    s_lshl_b32 s23, s21, 11
    s_mul_i32 s20, s21, 49152
    s_add_u32 s24, s18, s20
    s_add_u32 s25, s19, s20
    s_mul_i32 s26, s21, 6144
    s_add_u32 s26, s26, 81920
    s_mov_b32 s58, s28
    s_lshl_b32 s27, s58, 7
    s_add_u32 s27, s27, s22
    s_add_u32 m0, s23, 0
    s_add_u32 s20, s27, 9216
    buffer_load_dwordx4 v2, s[4:7], s27 offen lds
    buffer_load_dwordx4 v2, s[4:7], s20 offen offset:1024 lds
    s_mul_i32 s27, s58, 196608
    s_add_u32 s27, s27, s24
    s_add_u32 m0, s26, 0
    s_add_u32 s58, s58, 1
    s_cmp_eq_u32 s58, 10
    buffer_load_dwordx4 v3, s[8:11], s27 offen offset:0 lds
    s_cselect_b32 s58, 0, s58
    buffer_load_dwordx4 v4, s[8:11], s27 offen offset:1024 lds
    buffer_load_dwordx4 v5, s[8:11], s27 offen offset:2048 lds
    s_add_u32 m0, m0, 3072
    s_nop 0
    buffer_load_dwordx4 v6, s[8:11], s27 offen offset:0 lds
    buffer_load_dwordx4 v7, s[8:11], s27 offen offset:1024 lds
    buffer_load_dwordx4 v8, s[8:11], s27 offen offset:2048 lds
    s_lshl_b32 s27, s58, 7
    s_add_u32 s27, s27, s22
    s_add_u32 m0, s23, 8192
    s_add_u32 s20, s27, 9216
    buffer_load_dwordx4 v2, s[4:7], s27 offen lds
    buffer_load_dwordx4 v2, s[4:7], s20 offen offset:1024 lds
    s_mul_i32 s27, s58, 196608
    s_add_u32 s27, s27, s24
    s_add_u32 m0, s26, 24576
    s_add_u32 s58, s58, 1
    s_cmp_eq_u32 s58, 10
    buffer_load_dwordx4 v3, s[8:11], s27 offen offset:0 lds
    s_cselect_b32 s58, 0, s58
    buffer_load_dwordx4 v4, s[8:11], s27 offen offset:1024 lds
    buffer_load_dwordx4 v5, s[8:11], s27 offen offset:2048 lds
    s_add_u32 m0, m0, 3072
    s_nop 0
    buffer_load_dwordx4 v6, s[8:11], s27 offen offset:0 lds
    buffer_load_dwordx4 v7, s[8:11], s27 offen offset:1024 lds
    buffer_load_dwordx4 v8, s[8:11], s27 offen offset:2048 lds
    s_waitcnt vmcnt(8)
    s_barrier
    s_lshl_b32 s27, s58, 7
    s_add_u32 s27, s27, s22
    s_add_u32 m0, s23, 16384
    s_add_u32 s20, s27, 9216
    buffer_load_dwordx4 v2, s[4:7], s27 offen lds
    buffer_load_dwordx4 v2, s[4:7], s20 offen offset:1024 lds
    s_mul_i32 s27, s58, 196608
    s_add_u32 s27, s27, s24
    s_add_u32 m0, s26, 49152
    s_add_u32 s58, s58, 1
    s_cmp_eq_u32 s58, 10
    buffer_load_dwordx4 v3, s[8:11], s27 offen offset:0 lds
    s_cselect_b32 s58, 0, s58
    buffer_load_dwordx4 v4, s[8:11], s27 offen offset:1024 lds
    buffer_load_dwordx4 v5, s[8:11], s27 offen offset:2048 lds
    s_add_u32 m0, m0, 3072
    s_nop 0
    buffer_load_dwordx4 v6, s[8:11], s27 offen offset:0 lds
    buffer_load_dwordx4 v7, s[8:11], s27 offen offset:1024 lds
    buffer_load_dwordx4 v8, s[8:11], s27 offen offset:2048 lds
    s_waitcnt vmcnt(8)
    s_barrier
    s_lshl_b32 s27, s58, 7
    s_add_u32 s27, s27, s22
    s_add_u32 m0, s23, 24576
    s_add_u32 s20, s27, 9216
    buffer_load_dwordx4 v2, s[4:7], s27 offen lds
    buffer_load_dwordx4 v2, s[4:7], s20 offen offset:1024 lds
    s_mul_i32 s27, s58, 196608
    s_add_u32 s27, s27, s24
    s_add_u32 m0, s26, 0
    s_add_u32 s58, s58, 1
    s_cmp_eq_u32 s58, 10
    buffer_load_dwordx4 v3, s[8:11], s27 offen offset:0 lds
    s_cselect_b32 s58, 0, s58
    buffer_load_dwordx4 v4, s[8:11], s27 offen offset:1024 lds
    buffer_load_dwordx4 v5, s[8:11], s27 offen offset:2048 lds
    s_add_u32 m0, m0, 3072
    s_nop 0
    buffer_load_dwordx4 v6, s[8:11], s27 offen offset:0 lds
    buffer_load_dwordx4 v7, s[8:11], s27 offen offset:1024 lds
    buffer_load_dwordx4 v8, s[8:11], s27 offen offset:2048 lds
    s_waitcnt vmcnt(8)
    s_barrier
    s_lshl_b32 s27, s58, 7
    s_add_u32 s27, s27, s22
    s_add_u32 m0, s23, 32768
    s_add_u32 s20, s27, 9216
    buffer_load_dwordx4 v2, s[4:7], s27 offen lds
    buffer_load_dwordx4 v2, s[4:7], s20 offen offset:1024 lds
    s_mul_i32 s27, s58, 196608
    s_add_u32 s27, s27, s24
    s_add_u32 m0, s26, 24576
    s_add_u32 s58, s58, 1
    s_cmp_eq_u32 s58, 10
    buffer_load_dwordx4 v3, s[8:11], s27 offen offset:0 lds
    s_cselect_b32 s58, 0, s58
    buffer_load_dwordx4 v4, s[8:11], s27 offen offset:1024 lds
    buffer_load_dwordx4 v5, s[8:11], s27 offen offset:2048 lds
    s_add_u32 m0, m0, 3072
    s_nop 0
    buffer_load_dwordx4 v6, s[8:11], s27 offen offset:0 lds
    buffer_load_dwordx4 v7, s[8:11], s27 offen offset:1024 lds
    buffer_load_dwordx4 v8, s[8:11], s27 offen offset:2048 lds
    s_waitcnt vmcnt(8)
    s_barrier
    s_lshl_b32 s27, s58, 7
    s_add_u32 s27, s27, s22
    s_add_u32 m0, s23, 40960
    s_add_u32 s20, s27, 9216
    buffer_load_dwordx4 v2, s[4:7], s27 offen lds
    buffer_load_dwordx4 v2, s[4:7], s20 offen offset:1024 lds
    s_mul_i32 s27, s58, 196608
    s_add_u32 s27, s27, s24
    s_add_u32 m0, s26, 49152
    s_add_u32 s58, s58, 1
    s_cmp_eq_u32 s58, 10
    buffer_load_dwordx4 v3, s[8:11], s27 offen offset:0 lds
    s_cselect_b32 s58, 0, s58
    buffer_load_dwordx4 v4, s[8:11], s27 offen offset:1024 lds
    buffer_load_dwordx4 v5, s[8:11], s27 offen offset:2048 lds
    s_add_u32 m0, m0, 3072
    s_nop 0
    buffer_load_dwordx4 v6, s[8:11], s27 offen offset:0 lds
    buffer_load_dwordx4 v7, s[8:11], s27 offen offset:1024 lds
    buffer_load_dwordx4 v8, s[8:11], s27 offen offset:2048 lds
    s_waitcnt vmcnt(8)
    s_barrier
    s_lshl_b32 s27, s58, 7
    s_add_u32 s27, s27, s22
    s_add_u32 m0, s23, 49152
    s_add_u32 s20, s27, 9216
    buffer_load_dwordx4 v2, s[4:7], s27 offen lds
    buffer_load_dwordx4 v2, s[4:7], s20 offen offset:1024 lds
    s_mul_i32 s27, s58, 196608
    s_add_u32 s27, s27, s24
    s_add_u32 m0, s26, 0
    s_add_u32 s58, s58, 1
    s_cmp_eq_u32 s58, 10
    buffer_load_dwordx4 v3, s[8:11], s27 offen offset:0 lds
    s_cselect_b32 s58, 0, s58
    buffer_load_dwordx4 v4, s[8:11], s27 offen offset:1024 lds
    buffer_load_dwordx4 v5, s[8:11], s27 offen offset:2048 lds
    s_add_u32 m0, m0, 3072
    s_nop 0
    buffer_load_dwordx4 v6, s[8:11], s27 offen offset:0 lds
    buffer_load_dwordx4 v7, s[8:11], s27 offen offset:1024 lds
    buffer_load_dwordx4 v8, s[8:11], s27 offen offset:2048 lds
    s_waitcnt vmcnt(8)
    s_barrier
    s_lshl_b32 s27, s58, 7
    s_add_u32 s27, s27, s22
    s_add_u32 m0, s23, 57344
    s_add_u32 s20, s27, 9216
    buffer_load_dwordx4 v2, s[4:7], s27 offen lds
    buffer_load_dwordx4 v2, s[4:7], s20 offen offset:1024 lds
    s_mul_i32 s27, s58, 196608
    s_add_u32 s27, s27, s24
    s_add_u32 m0, s26, 24576
    s_add_u32 s58, s58, 1
    s_cmp_eq_u32 s58, 10
    buffer_load_dwordx4 v3, s[8:11], s27 offen offset:0 lds
    s_cselect_b32 s58, 0, s58
    buffer_load_dwordx4 v4, s[8:11], s27 offen offset:1024 lds
    buffer_load_dwordx4 v5, s[8:11], s27 offen offset:2048 lds
    s_add_u32 m0, m0, 3072
    s_nop 0
    buffer_load_dwordx4 v6, s[8:11], s27 offen offset:0 lds
    buffer_load_dwordx4 v7, s[8:11], s27 offen offset:1024 lds
    buffer_load_dwordx4 v8, s[8:11], s27 offen offset:2048 lds
    s_waitcnt vmcnt(8)
    s_barrier
    s_lshl_b32 s27, s58, 7
    s_add_u32 s27, s27, s22
    s_add_u32 m0, s23, 65536
    s_add_u32 s20, s27, 9216
    buffer_load_dwordx4 v2, s[4:7], s27 offen lds
    buffer_load_dwordx4 v2, s[4:7], s20 offen offset:1024 lds
    s_mul_i32 s27, s58, 196608
    s_add_u32 s27, s27, s24
    s_add_u32 m0, s26, 49152
    s_add_u32 s58, s58, 1
    s_cmp_eq_u32 s58, 10
    buffer_load_dwordx4 v3, s[8:11], s27 offen offset:0 lds
    s_cselect_b32 s58, 0, s58
    buffer_load_dwordx4 v4, s[8:11], s27 offen offset:1024 lds
    buffer_load_dwordx4 v5, s[8:11], s27 offen offset:2048 lds
    s_add_u32 m0, m0, 3072
    s_nop 0
    buffer_load_dwordx4 v6, s[8:11], s27 offen offset:0 lds
    buffer_load_dwordx4 v7, s[8:11], s27 offen offset:1024 lds
    buffer_load_dwordx4 v8, s[8:11], s27 offen offset:2048 lds
    s_waitcnt vmcnt(8)
    s_barrier
    s_lshl_b32 s27, s58, 7
    s_add_u32 s27, s27, s22
    s_add_u32 m0, s23, 73728
    s_add_u32 s20, s27, 9216
    buffer_load_dwordx4 v2, s[4:7], s27 offen lds
    buffer_load_dwordx4 v2, s[4:7], s20 offen offset:1024 lds
    s_mul_i32 s27, s58, 196608
    s_add_u32 s27, s27, s24
    s_add_u32 m0, s26, 0
    s_add_u32 s58, s58, 1
    s_cmp_eq_u32 s58, 10
    buffer_load_dwordx4 v3, s[8:11], s27 offen offset:0 lds
    s_cselect_b32 s58, 0, s58
    buffer_load_dwordx4 v4, s[8:11], s27 offen offset:1024 lds
    buffer_load_dwordx4 v5, s[8:11], s27 offen offset:2048 lds
    s_add_u32 m0, m0, 3072
    s_nop 0
    buffer_load_dwordx4 v6, s[8:11], s27 offen offset:0 lds
    buffer_load_dwordx4 v7, s[8:11], s27 offen offset:1024 lds
    buffer_load_dwordx4 v8, s[8:11], s27 offen offset:2048 lds
    s_waitcnt vmcnt(8)
    s_barrier
    s_mul_i32 s27, s58, 196608
    s_add_u32 s27, s27, s25
    s_add_u32 m0, s26, 24576
    s_add_u32 s58, s58, 1
    s_cmp_eq_u32 s58, 10
    buffer_load_dwordx4 v3, s[8:11], s27 offen offset:0 lds
    s_cselect_b32 s58, 0, s58
    buffer_load_dwordx4 v4, s[8:11], s27 offen offset:1024 lds
    buffer_load_dwordx4 v5, s[8:11], s27 offen offset:2048 lds
    s_add_u32 m0, m0, 3072
    s_nop 0
    buffer_load_dwordx4 v6, s[8:11], s27 offen offset:0 lds
    buffer_load_dwordx4 v7, s[8:11], s27 offen offset:1024 lds
    buffer_load_dwordx4 v8, s[8:11], s27 offen offset:2048 lds
    s_waitcnt vmcnt(6)
    s_barrier
    s_mul_i32 s27, s58, 196608
    s_add_u32 s27, s27, s25
    s_add_u32 m0, s26, 49152
    s_add_u32 s58, s58, 1
    s_cmp_eq_u32 s58, 10
    buffer_load_dwordx4 v3, s[8:11], s27 offen offset:0 lds
    s_cselect_b32 s58, 0, s58
    buffer_load_dwordx4 v4, s[8:11], s27 offen offset:1024 lds
    buffer_load_dwordx4 v5, s[8:11], s27 offen offset:2048 lds
    s_add_u32 m0, m0, 3072
    s_nop 0
    buffer_load_dwordx4 v6, s[8:11], s27 offen offset:0 lds
    buffer_load_dwordx4 v7, s[8:11], s27 offen offset:1024 lds
    buffer_load_dwordx4 v8, s[8:11], s27 offen offset:2048 lds
    s_waitcnt vmcnt(6)
    s_barrier
    s_mul_i32 s27, s58, 196608
    s_add_u32 s27, s27, s25
    s_add_u32 m0, s26, 0
    s_add_u32 s58, s58, 1
    s_cmp_eq_u32 s58, 10
    buffer_load_dwordx4 v3, s[8:11], s27 offen offset:0 lds
    s_cselect_b32 s58, 0, s58
    buffer_load_dwordx4 v4, s[8:11], s27 offen offset:1024 lds
    buffer_load_dwordx4 v5, s[8:11], s27 offen offset:2048 lds
    s_add_u32 m0, m0, 3072
    s_nop 0
    buffer_load_dwordx4 v6, s[8:11], s27 offen offset:0 lds
    buffer_load_dwordx4 v7, s[8:11], s27 offen offset:1024 lds
    buffer_load_dwordx4 v8, s[8:11], s27 offen offset:2048 lds
    s_sub_u32 s40, s16, 4
    s_lshl_b32 s40, s40, 6
    v_add_u32 v30, s40, v0
    v_and_b32 v31, 127, v30
    v_lshrrev_b32 v32, 7, v30
    v_lshrrev_b32 v33, 1, v31
    v_and_b32 v34, 0x33, v33
    v_and_b32 v35, 4, v33
    v_lshl_or_b32 v34, v35, 1, v34
    v_and_b32 v35, 8, v33
    v_lshrrev_b32 v35, 1, v35
    v_or_b32 v34, v34, v35
    v_mul_u32_u24 v34, 1280, v34
    v_and_b32 v35, 1, v31
    v_lshl_add_u32 v34, v35, 4, v34
    v_lshl_add_u32 v34, v32, 5, v34
    v_lshlrev_b32 v252, 4, v31
    v_lshl_add_u32 v252, v32, 11, v252
    v_mov_b32 v35, 1073741824
    v_cmp_eq_u32 vcc, 1, v32
    s_nop 1
    v_cndmask_b32 v253, v252, v35, vcc
    v_cndmask_b32 v33, v34, v35, vcc
    s_lshl_b32 s54, s48, 2
    s_add_u32 s54, s54, s49
    s_add_u32 s55, s54, 0
    s_mul_hi_u32 s41, s55, 195225787
    s_mul_i32 s42, s41, 22
    s_sub_u32 s42, s55, s42
    s_cmp_lt_u32 s42, 10
    s_cselect_b32 s12, s44, s46
    s_cselect_b32 s13, s45, s47
    s_mov_b32 s14, 983040
    s_cselect_b32 s14, 819200, s14
    s_mov_b32 s15, 0x20000
    s_cselect_b32 s43, 0, 10
    s_sub_u32 s43, s42, s43
    s_mul_i32 s43, s43, 81920
    s_mul_i32 s40, s41, 160
    s_add_u32 s43, s43, s40
    s_cmp_ge_u32 s55, 176
    s_cselect_b32 s40, 1073741824, 0
    s_add_u32 s43, s43, s40
    buffer_load_dwordx4 v[224:227], v34, s[12:15], s43 offen
    buffer_load_dwordx4 v[228:231], v34, s[12:15], s43 offen offset:64
    buffer_load_dwordx4 v[232:235], v33, s[12:15], s43 offen offset:128
    s_add_u32 s55, s54, 128
    s_mul_hi_u32 s41, s55, 195225787
    s_mul_i32 s42, s41, 22
    s_sub_u32 s42, s55, s42
    s_cmp_lt_u32 s42, 10
    s_cselect_b32 s12, s44, s46
    s_cselect_b32 s13, s45, s47
    s_mov_b32 s14, 983040
    s_cselect_b32 s14, 819200, s14
    s_mov_b32 s15, 0x20000
    s_cselect_b32 s43, 0, 10
    s_sub_u32 s43, s42, s43
    s_mul_i32 s43, s43, 81920
    s_mul_i32 s40, s41, 160
    s_add_u32 s43, s43, s40
    s_cmp_ge_u32 s55, 176
    s_cselect_b32 s40, 1073741824, 0
    s_add_u32 s43, s43, s40
    buffer_load_dwordx4 v[236:239], v34, s[12:15], s43 offen
    buffer_load_dwordx4 v[240:243], v34, s[12:15], s43 offen offset:64
    buffer_load_dwordx4 v[244:247], v33, s[12:15], s43 offen offset:128
    s_mov_b32 s4, s30
    s_mov_b32 s5, s31
    s_mov_b32 s6, 2621440
    s_mov_b32 s7, 0x20000
    s_mov_b32 s12, s38
    s_mov_b32 s13, s39
    s_mov_b32 s14, 1280
    s_mov_b32 s15, 0x20000
    s_lshl_b32 s86, s48, 6
    s_lshl_b32 s47, s49, 4
    s_add_u32 s86, s86, s47
    s_sub_u32 s47, s16, 4
    s_lshl_b32 s47, s47, 2
    s_add_u32 s86, s86, s47
    v_lshlrev_b32 v146, 4, v0
    v_add_u32 v147, 1024, v146
    v_mov_b32 v148, 1073741824
    v_cmp_le_u32 vcc, 16, v0
    s_nop 1
    v_cndmask_b32 v147, v147, v148, vcc
    buffer_load_dwordx4 v[184:187], v146, s[12:15], 0 offen
    buffer_load_dwordx4 v[188:191], v147, s[12:15], 0 offen
    s_mul_i32 s87, s86, 1280
    s_add_u32 s85, s87, 0
    buffer_load_dwordx4 v[152:155], v146, s[4:7], s85 offen
    buffer_load_dwordx4 v[156:159], v147, s[4:7], s85 offen
    s_add_u32 s85, s87, 1280
    buffer_load_dwordx4 v[160:163], v146, s[4:7], s85 offen
    buffer_load_dwordx4 v[164:167], v147, s[4:7], s85 offen
    s_add_u32 s85, s87, 2560
    buffer_load_dwordx4 v[168:171], v146, s[4:7], s85 offen
    buffer_load_dwordx4 v[172:175], v147, s[4:7], s85 offen
    s_add_u32 s85, s87, 3840
    buffer_load_dwordx4 v[176:179], v146, s[4:7], s85 offen
    buffer_load_dwordx4 v[180:183], v147, s[4:7], s85 offen
    s_mov_b32 s4, s30
    s_mov_b32 s5, s31
    s_mov_b32 s6, 2621440
    s_mov_b32 s7, 0x20000
    s_waitcnt vmcnt(22)
    s_barrier
    s_mul_i32 s27, s58, 196608
    s_add_u32 s27, s27, s25
    s_add_u32 m0, s26, 24576
    s_add_u32 s58, s58, 1
    s_cmp_eq_u32 s58, 10
    buffer_load_dwordx4 v3, s[8:11], s27 offen offset:0 lds
    s_cselect_b32 s58, 0, s58
    buffer_load_dwordx4 v4, s[8:11], s27 offen offset:1024 lds
    buffer_load_dwordx4 v5, s[8:11], s27 offen offset:2048 lds
    s_add_u32 m0, m0, 3072
    s_nop 0
    buffer_load_dwordx4 v6, s[8:11], s27 offen offset:0 lds
    buffer_load_dwordx4 v7, s[8:11], s27 offen offset:1024 lds
    buffer_load_dwordx4 v8, s[8:11], s27 offen offset:2048 lds
    s_waitcnt vmcnt(22)
    s_barrier
    s_mul_i32 s27, s58, 196608
    s_add_u32 s27, s27, s25
    s_add_u32 m0, s26, 49152
    s_add_u32 s58, s58, 1
    s_cmp_eq_u32 s58, 10
    buffer_load_dwordx4 v3, s[8:11], s27 offen offset:0 lds
    s_cselect_b32 s58, 0, s58
    buffer_load_dwordx4 v4, s[8:11], s27 offen offset:1024 lds
    buffer_load_dwordx4 v5, s[8:11], s27 offen offset:2048 lds
    s_add_u32 m0, m0, 3072
    s_nop 0
    buffer_load_dwordx4 v6, s[8:11], s27 offen offset:0 lds
    buffer_load_dwordx4 v7, s[8:11], s27 offen offset:1024 lds
    buffer_load_dwordx4 v8, s[8:11], s27 offen offset:2048 lds
    s_waitcnt vmcnt(6)
    s_barrier
    s_mul_i32 s27, s58, 196608
    s_add_u32 s27, s27, s25
    s_add_u32 m0, s26, 0
    s_add_u32 s58, s58, 1
    s_cmp_eq_u32 s58, 10
    buffer_load_dwordx4 v3, s[8:11], s27 offen offset:0 lds
    s_cselect_b32 s58, 0, s58
    buffer_load_dwordx4 v4, s[8:11], s27 offen offset:1024 lds
    buffer_load_dwordx4 v5, s[8:11], s27 offen offset:2048 lds
    s_add_u32 m0, m0, 3072
    s_nop 0
    buffer_load_dwordx4 v6, s[8:11], s27 offen offset:0 lds
    buffer_load_dwordx4 v7, s[8:11], s27 offen offset:1024 lds
    buffer_load_dwordx4 v8, s[8:11], s27 offen offset:2048 lds
    s_waitcnt vmcnt(18)
    v_mov_b32 v192, 0
    v_dot2_f32_bf16 v192, v152, v184, v192
    v_dot2_f32_bf16 v192, v153, v185, v192
    v_dot2_f32_bf16 v192, v154, v186, v192
    v_dot2_f32_bf16 v192, v155, v187, v192
    v_dot2_f32_bf16 v192, v156, v188, v192
    v_dot2_f32_bf16 v192, v157, v189, v192
    v_dot2_f32_bf16 v192, v158, v190, v192
    v_dot2_f32_bf16 v192, v159, v191, v192
    v_mov_b32 v193, 0
    v_dot2_f32_bf16 v193, v160, v184, v193
    v_dot2_f32_bf16 v193, v161, v185, v193
    v_dot2_f32_bf16 v193, v162, v186, v193
    v_dot2_f32_bf16 v193, v163, v187, v193
    v_dot2_f32_bf16 v193, v164, v188, v193
    v_dot2_f32_bf16 v193, v165, v189, v193
    v_dot2_f32_bf16 v193, v166, v190, v193
    v_dot2_f32_bf16 v193, v167, v191, v193
    v_mov_b32 v194, 0
    v_dot2_f32_bf16 v194, v168, v184, v194
    v_dot2_f32_bf16 v194, v169, v185, v194
    v_dot2_f32_bf16 v194, v170, v186, v194
    v_dot2_f32_bf16 v194, v171, v187, v194
    v_dot2_f32_bf16 v194, v172, v188, v194
    v_dot2_f32_bf16 v194, v173, v189, v194
    v_dot2_f32_bf16 v194, v174, v190, v194
    v_dot2_f32_bf16 v194, v175, v191, v194
    v_mov_b32 v195, 0
    v_dot2_f32_bf16 v195, v176, v184, v195
    v_dot2_f32_bf16 v195, v177, v185, v195
    v_dot2_f32_bf16 v195, v178, v186, v195
    v_dot2_f32_bf16 v195, v179, v187, v195
    v_dot2_f32_bf16 v195, v180, v188, v195
    v_dot2_f32_bf16 v195, v181, v189, v195
    v_dot2_f32_bf16 v195, v182, v190, v195
    v_dot2_f32_bf16 v195, v183, v191, v195
    v_add_f32_dpp v192, v192, v192 row_shr:1 row_mask:0xf bank_mask:0xf bound_ctrl:0
    v_add_f32_dpp v193, v193, v193 row_shr:1 row_mask:0xf bank_mask:0xf bound_ctrl:0
    v_add_f32_dpp v194, v194, v194 row_shr:1 row_mask:0xf bank_mask:0xf bound_ctrl:0
    v_add_f32_dpp v195, v195, v195 row_shr:1 row_mask:0xf bank_mask:0xf bound_ctrl:0
    v_add_f32_dpp v192, v192, v192 row_shr:2 row_mask:0xf bank_mask:0xf bound_ctrl:0
    v_add_f32_dpp v193, v193, v193 row_shr:2 row_mask:0xf bank_mask:0xf bound_ctrl:0
    v_add_f32_dpp v194, v194, v194 row_shr:2 row_mask:0xf bank_mask:0xf bound_ctrl:0
    v_add_f32_dpp v195, v195, v195 row_shr:2 row_mask:0xf bank_mask:0xf bound_ctrl:0
    v_add_f32_dpp v192, v192, v192 row_shr:4 row_mask:0xf bank_mask:0xf bound_ctrl:0
    v_add_f32_dpp v193, v193, v193 row_shr:4 row_mask:0xf bank_mask:0xf bound_ctrl:0
    v_add_f32_dpp v194, v194, v194 row_shr:4 row_mask:0xf bank_mask:0xf bound_ctrl:0
    v_add_f32_dpp v195, v195, v195 row_shr:4 row_mask:0xf bank_mask:0xf bound_ctrl:0
    v_add_f32_dpp v192, v192, v192 row_shr:8 row_mask:0xf bank_mask:0xf bound_ctrl:0
    v_add_f32_dpp v193, v193, v193 row_shr:8 row_mask:0xf bank_mask:0xf bound_ctrl:0
    v_add_f32_dpp v194, v194, v194 row_shr:8 row_mask:0xf bank_mask:0xf bound_ctrl:0
    v_add_f32_dpp v195, v195, v195 row_shr:8 row_mask:0xf bank_mask:0xf bound_ctrl:0
    v_add_f32_dpp v192, v192, v192 row_bcast:15 row_mask:0xa bank_mask:0xf
    v_add_f32_dpp v193, v193, v193 row_bcast:15 row_mask:0xa bank_mask:0xf
    v_add_f32_dpp v194, v194, v194 row_bcast:15 row_mask:0xa bank_mask:0xf
    v_add_f32_dpp v195, v195, v195 row_bcast:15 row_mask:0xa bank_mask:0xf
    v_add_f32_dpp v192, v192, v192 row_bcast:31 row_mask:0xc bank_mask:0xf
    v_add_f32_dpp v193, v193, v193 row_bcast:31 row_mask:0xc bank_mask:0xf
    v_add_f32_dpp v194, v194, v194 row_bcast:31 row_mask:0xc bank_mask:0xf
    v_add_f32_dpp v195, v195, v195 row_bcast:31 row_mask:0xc bank_mask:0xf
    v_mul_f32 v192, 3216550459, v192
    v_mul_f32 v193, 3216550459, v193
    v_mul_f32 v194, 3216550459, v194
    v_mul_f32 v195, 3216550459, v195
    v_exp_f32 v192, v192
    v_exp_f32 v193, v193
    v_exp_f32 v194, v194
    v_exp_f32 v195, v195
    v_add_f32 v192, 1.0, v192
    v_add_f32 v193, 1.0, v193
    v_add_f32 v194, 1.0, v194
    v_add_f32 v195, 1.0, v195
    v_rcp_f32 v192, v192
    v_rcp_f32 v193, v193
    v_rcp_f32 v194, v194
    v_rcp_f32 v195, v195
    s_waitcnt vmcnt(6)
    s_barrier
    s_mul_i32 s27, s58, 196608
    s_add_u32 s27, s27, s25
    s_add_u32 m0, s26, 24576
    s_add_u32 s58, s58, 1
    s_cmp_eq_u32 s58, 10
    buffer_load_dwordx4 v3, s[8:11], s27 offen offset:0 lds
    s_cselect_b32 s58, 0, s58
    buffer_load_dwordx4 v4, s[8:11], s27 offen offset:1024 lds
    buffer_load_dwordx4 v5, s[8:11], s27 offen offset:2048 lds
    s_add_u32 m0, m0, 3072
    s_nop 0
    buffer_load_dwordx4 v6, s[8:11], s27 offen offset:0 lds
    buffer_load_dwordx4 v7, s[8:11], s27 offen offset:1024 lds
    buffer_load_dwordx4 v8, s[8:11], s27 offen offset:2048 lds
    s_waitcnt vmcnt(6)
    s_barrier
    s_mul_i32 s27, s58, 196608
    s_add_u32 s27, s27, s25
    s_add_u32 m0, s26, 49152
    s_add_u32 s58, s58, 1
    s_cmp_eq_u32 s58, 10
    buffer_load_dwordx4 v3, s[8:11], s27 offen offset:0 lds
    s_cselect_b32 s58, 0, s58
    buffer_load_dwordx4 v4, s[8:11], s27 offen offset:1024 lds
    buffer_load_dwordx4 v5, s[8:11], s27 offen offset:2048 lds
    s_add_u32 m0, m0, 3072
    s_nop 0
    buffer_load_dwordx4 v6, s[8:11], s27 offen offset:0 lds
    buffer_load_dwordx4 v7, s[8:11], s27 offen offset:1024 lds
    buffer_load_dwordx4 v8, s[8:11], s27 offen offset:2048 lds
    s_waitcnt vmcnt(6)
    s_barrier
    s_mul_i32 s27, s58, 196608
    s_add_u32 s27, s27, s25
    s_add_u32 m0, s26, 0
    s_add_u32 s58, s58, 1
    s_cmp_eq_u32 s58, 10
    buffer_load_dwordx4 v3, s[8:11], s27 offen offset:0 lds
    s_cselect_b32 s58, 0, s58
    buffer_load_dwordx4 v4, s[8:11], s27 offen offset:1024 lds
    buffer_load_dwordx4 v5, s[8:11], s27 offen offset:2048 lds
    s_add_u32 m0, m0, 3072
    s_nop 0
    buffer_load_dwordx4 v6, s[8:11], s27 offen offset:0 lds
    buffer_load_dwordx4 v7, s[8:11], s27 offen offset:1024 lds
    buffer_load_dwordx4 v8, s[8:11], s27 offen offset:2048 lds
    s_waitcnt vmcnt(6)
    s_barrier
    s_mul_i32 s27, s58, 196608
    s_add_u32 s27, s27, s25
    s_add_u32 m0, s26, 24576
    s_add_u32 s58, s58, 1
    s_cmp_eq_u32 s58, 10
    buffer_load_dwordx4 v3, s[8:11], s27 offen offset:0 lds
    s_cselect_b32 s58, 0, s58
    buffer_load_dwordx4 v4, s[8:11], s27 offen offset:1024 lds
    buffer_load_dwordx4 v5, s[8:11], s27 offen offset:2048 lds
    s_add_u32 m0, m0, 3072
    s_nop 0
    buffer_load_dwordx4 v6, s[8:11], s27 offen offset:0 lds
    buffer_load_dwordx4 v7, s[8:11], s27 offen offset:1024 lds
    buffer_load_dwordx4 v8, s[8:11], s27 offen offset:2048 lds
    s_waitcnt vmcnt(6)
    s_barrier
    s_waitcnt vmcnt(0)
    s_barrier
    s_add_u32 s12, s32, 22020096
    s_addc_u32 s13, s33, 0
    s_mov_b32 s14, 1802240
    s_mov_b32 s15, 0x20000
    s_add_u32 s55, s54, 0
    s_mul_i32 s41, s55, 10240
    s_cmp_ge_u32 s55, 176
    s_cselect_b32 s42, 1073741824, 0
    s_add_u32 s41, s41, s42
    s_add_u32 s42, s41, 4096
    s_add_u32 s43, s41, 8192
    buffer_store_dwordx4 v[224:227], v252, s[12:15], s41 offen sc1
    buffer_store_dwordx4 v[228:231], v252, s[12:15], s42 offen sc1
    buffer_store_dwordx4 v[232:235], v253, s[12:15], s43 offen sc1
    s_add_u32 s55, s54, 128
    s_mul_i32 s41, s55, 10240
    s_cmp_ge_u32 s55, 176
    s_cselect_b32 s42, 1073741824, 0
    s_add_u32 s41, s41, s42
    s_add_u32 s42, s41, 4096
    s_add_u32 s43, s41, 8192
    buffer_store_dwordx4 v[236:239], v252, s[12:15], s41 offen sc1
    buffer_store_dwordx4 v[240:243], v252, s[12:15], s42 offen sc1
    buffer_store_dwordx4 v[244:247], v253, s[12:15], s43 offen sc1
    s_add_u32 s4, s32, 24379392
    s_addc_u32 s5, s33, 0
    s_mov_b32 s6, 8192
    s_mov_b32 s7, 0x20000
    s_lshl_b32 s86, s86, 2
    v_mov_b32 v146, 0
    s_mov_b32 s42, 0
    s_mov_b32 s43, 0x80000000
    s_mov_b64 exec, s[42:43]
    buffer_store_dword v192, v146, s[4:7], s86 offen offset:0 sc1
    buffer_store_dword v193, v146, s[4:7], s86 offen offset:4 sc1
    buffer_store_dword v194, v146, s[4:7], s86 offen offset:8 sc1
    buffer_store_dword v195, v146, s[4:7], s86 offen offset:12 sc1
    s_mov_b64 exec, -1
    s_barrier
    s_branch K1_znost
K1_zcomp:
    s_lshr_b32 s20, s16, 1
    s_lshl_b32 s20, s20, 2
    s_add_u32 s20, s20, 155664
    v_mov_b32 v14, s20
    v_mov_b32 v15, 0
    ds_write_b32 v14, v15
    s_and_b32 s20, s16, 1
    s_lshr_b32 s21, s16, 1
    v_and_b32 v14, 15, v0
    v_lshrrev_b32 v15, 4, v0
    v_and_b32 v6, 7, v14
    v_xor_b32 v6, v15, v6
    v_lshlrev_b32 v14, 7, v14
    v_lshl_add_u32 v14, v6, 4, v14
    s_lshl_b32 s22, s20, 12
    v_add_u32 v2, s22, v14
    v_xor_b32 v3, 64, v2
    v_add_u32 v4, 0x10000, v2
    v_add_u32 v5, 0x10000, v3
    v_lshrrev_b32 v14, 2, v0
    v_and_b32 v14, 3, v14
    v_lshl_add_u32 v13, v15, 3, v14
    v_mul_u32_u24 v13, 384, v13
    v_and_b32 v12, 3, v0
    v_lshl_add_u32 v13, v12, 3, v13
    v_lshrrev_b32 v14, 1, v14
    v_and_b32 v12, 1, v15
    v_lshl_add_u32 v14, v12, 1, v14
    v_add_u32 v15, 81920, v13
    s_mul_i32 s23, s21, 6
    s_add_u32 s22, s23, 0
    s_and_b32 s24, s22, 3
    s_andn2_b32 s22, s22, 3
    v_xor_b32 v13, s24, v14
    v_add_u32 v13, s22, v13
    v_lshl_add_u32 v6, v13, 5, v15
    s_add_u32 s22, s23, 1
    s_and_b32 s24, s22, 3
    s_andn2_b32 s22, s22, 3
    v_xor_b32 v13, s24, v14
    v_add_u32 v13, s22, v13
    v_lshl_add_u32 v7, v13, 5, v15
    s_add_u32 s22, s23, 2
    s_and_b32 s24, s22, 3
    s_andn2_b32 s22, s22, 3
    v_xor_b32 v13, s24, v14
    v_add_u32 v13, s22, v13
    v_lshl_add_u32 v8, v13, 5, v15
    s_add_u32 s22, s23, 3
    s_and_b32 s24, s22, 3
    s_andn2_b32 s22, s22, 3
    v_xor_b32 v13, s24, v14
    v_add_u32 v13, s22, v13
    v_lshl_add_u32 v9, v13, 5, v15
    s_add_u32 s22, s23, 4
    s_and_b32 s24, s22, 3
    s_andn2_b32 s22, s22, 3
    v_xor_b32 v13, s24, v14
    v_add_u32 v13, s22, v13
    v_lshl_add_u32 v10, v13, 5, v15
    s_add_u32 s22, s23, 5
    s_and_b32 s24, s22, 3
    s_andn2_b32 s22, s22, 3
    v_xor_b32 v13, s24, v14
    v_add_u32 v13, s22, v13
    v_lshl_add_u32 v11, v13, 5, v15
    v_mov_b32 v80, 0
    v_mov_b32 v81, 0
    v_mov_b32 v82, 0
    v_mov_b32 v83, 0
    v_mov_b32 v84, 0
    v_mov_b32 v85, 0
    v_mov_b32 v86, 0
    v_mov_b32 v87, 0
    v_mov_b32 v88, 0
    v_mov_b32 v89, 0
    v_mov_b32 v90, 0
    v_mov_b32 v91, 0
    v_mov_b32 v92, 0
    v_mov_b32 v93, 0
    v_mov_b32 v94, 0
    v_mov_b32 v95, 0
    v_mov_b32 v96, 0
    v_mov_b32 v97, 0
    v_mov_b32 v98, 0
    v_mov_b32 v99, 0
    v_mov_b32 v100, 0
    v_mov_b32 v101, 0
    v_mov_b32 v102, 0
    v_mov_b32 v103, 0
    v_mov_b32 v104, 0
    v_mov_b32 v105, 0
    v_mov_b32 v106, 0
    v_mov_b32 v107, 0
    v_mov_b32 v108, 0
    v_mov_b32 v109, 0
    v_mov_b32 v110, 0
    v_mov_b32 v111, 0
    v_mov_b32 v112, 0
    v_mov_b32 v113, 0
    v_mov_b32 v114, 0
    v_mov_b32 v115, 0
    v_mov_b32 v116, 0
    v_mov_b32 v117, 0
    v_mov_b32 v118, 0
    v_mov_b32 v119, 0
    v_mov_b32 v120, 0
    v_mov_b32 v121, 0
    v_mov_b32 v122, 0
    v_mov_b32 v123, 0
    v_mov_b32 v124, 0
    v_mov_b32 v125, 0
    v_mov_b32 v126, 0
    v_mov_b32 v127, 0
    v_mov_b32 v128, 0
    v_mov_b32 v129, 0
    v_mov_b32 v130, 0
    v_mov_b32 v131, 0
    v_mov_b32 v132, 0
    v_mov_b32 v133, 0
    v_mov_b32 v134, 0
    v_mov_b32 v135, 0
    v_mov_b32 v136, 0
    v_mov_b32 v137, 0
    v_mov_b32 v138, 0
    v_mov_b32 v139, 0
    v_mov_b32 v140, 0
    v_mov_b32 v141, 0
    v_mov_b32 v142, 0
    v_mov_b32 v143, 0
    v_mov_b32 v144, 0
    v_mov_b32 v145, 0
    v_mov_b32 v146, 0
    v_mov_b32 v147, 0
    v_mov_b32 v148, 0
    v_mov_b32 v149, 0
    v_mov_b32 v150, 0
    v_mov_b32 v151, 0
    v_mov_b32 v152, 0
    v_mov_b32 v153, 0
    v_mov_b32 v154, 0
    v_mov_b32 v155, 0
    v_mov_b32 v156, 0
    v_mov_b32 v157, 0
    v_mov_b32 v158, 0
    v_mov_b32 v159, 0
    v_mov_b32 v160, 0
    v_mov_b32 v161, 0
    v_mov_b32 v162, 0
    v_mov_b32 v163, 0
    v_mov_b32 v164, 0
    v_mov_b32 v165, 0
    v_mov_b32 v166, 0
    v_mov_b32 v167, 0
    v_mov_b32 v168, 0
    v_mov_b32 v169, 0
    v_mov_b32 v170, 0
    v_mov_b32 v171, 0
    v_mov_b32 v172, 0
    v_mov_b32 v173, 0
    v_mov_b32 v174, 0
    v_mov_b32 v175, 0
    s_barrier
    ds_read_b128 v[16:19], v2 offset:0
    ds_read_b128 v[20:23], v2 offset:2048
    ds_read_b64_tr_b16 v[24:25], v6 offset:0
    ds_read_b64_tr_b16 v[26:27], v6 offset:1536
    ds_read_b64_tr_b16 v[28:29], v7 offset:0
    ds_read_b64_tr_b16 v[30:31], v7 offset:1536
    ds_read_b64_tr_b16 v[32:33], v8 offset:0
    ds_read_b64_tr_b16 v[34:35], v8 offset:1536
    ds_read_b64_tr_b16 v[36:37], v9 offset:0
    ds_read_b64_tr_b16 v[38:39], v9 offset:1536
    ds_read_b64_tr_b16 v[40:41], v10 offset:0
    ds_read_b64_tr_b16 v[42:43], v10 offset:1536
    ds_read_b64_tr_b16 v[44:45], v11 offset:0
    ds_read_b64_tr_b16 v[46:47], v11 offset:1536
    ds_read_b128 v[48:51], v3 offset:0
    ds_read_b128 v[52:55], v3 offset:2048
    ds_read_b64_tr_b16 v[56:57], v6 offset:12288
    ds_read_b64_tr_b16 v[58:59], v6 offset:13824
    ds_read_b64_tr_b16 v[60:61], v7 offset:12288
    ds_read_b64_tr_b16 v[62:63], v7 offset:13824
    ds_read_b64_tr_b16 v[64:65], v8 offset:12288
    ds_read_b64_tr_b16 v[66:67], v8 offset:13824
    ds_read_b64_tr_b16 v[68:69], v9 offset:12288
    ds_read_b64_tr_b16 v[70:71], v9 offset:13824
    ds_read_b64_tr_b16 v[72:73], v10 offset:12288
    ds_read_b64_tr_b16 v[74:75], v10 offset:13824
    ds_read_b64_tr_b16 v[76:77], v11 offset:12288
    ds_read_b64_tr_b16 v[78:79], v11 offset:13824
    s_waitcnt lgkmcnt(0)
    s_barrier
    ds_read_b128 v[176:179], v2 offset:8192
    ds_read_b128 v[180:183], v2 offset:10240
    v_mfma_f32_16x16x32_bf16 v[80:83], v[24:27], v[16:19], v[80:83]
    ds_read_b64_tr_b16 v[184:185], v6 offset:24576
    ds_read_b64_tr_b16 v[186:187], v6 offset:26112
    v_mfma_f32_16x16x32_bf16 v[84:87], v[28:31], v[16:19], v[84:87]
    ds_read_b64_tr_b16 v[188:189], v7 offset:24576
    ds_read_b64_tr_b16 v[190:191], v7 offset:26112
    v_mfma_f32_16x16x32_bf16 v[88:91], v[32:35], v[16:19], v[88:91]
    ds_read_b64_tr_b16 v[192:193], v8 offset:24576
    ds_read_b64_tr_b16 v[194:195], v8 offset:26112
    v_mfma_f32_16x16x32_bf16 v[92:95], v[36:39], v[16:19], v[92:95]
    ds_read_b64_tr_b16 v[196:197], v9 offset:24576
    ds_read_b64_tr_b16 v[198:199], v9 offset:26112
    v_mfma_f32_16x16x32_bf16 v[96:99], v[40:43], v[16:19], v[96:99]
    ds_read_b64_tr_b16 v[200:201], v10 offset:24576
    ds_read_b64_tr_b16 v[202:203], v10 offset:26112
    v_mfma_f32_16x16x32_bf16 v[100:103], v[44:47], v[16:19], v[100:103]
    ds_read_b64_tr_b16 v[204:205], v11 offset:24576
    ds_read_b64_tr_b16 v[206:207], v11 offset:26112
    v_mfma_f32_16x16x32_bf16 v[104:107], v[24:27], v[20:23], v[104:107]
    ds_read_b128 v[208:211], v3 offset:8192
    ds_read_b128 v[212:215], v3 offset:10240
    v_mfma_f32_16x16x32_bf16 v[108:111], v[28:31], v[20:23], v[108:111]
    ds_read_b64_tr_b16 v[216:217], v6 offset:36864
    ds_read_b64_tr_b16 v[218:219], v6 offset:38400
    v_mfma_f32_16x16x32_bf16 v[112:115], v[32:35], v[20:23], v[112:115]
    ds_read_b64_tr_b16 v[220:221], v7 offset:36864
    ds_read_b64_tr_b16 v[222:223], v7 offset:38400
    v_mfma_f32_16x16x32_bf16 v[116:119], v[36:39], v[20:23], v[116:119]
    ds_read_b64_tr_b16 v[224:225], v8 offset:36864
    v_mfma_f32_16x16x32_bf16 v[120:123], v[40:43], v[20:23], v[120:123]
    ds_read_b64_tr_b16 v[226:227], v8 offset:38400
    v_mfma_f32_16x16x32_bf16 v[124:127], v[44:47], v[20:23], v[124:127]
    ds_read_b64_tr_b16 v[228:229], v9 offset:36864
    v_mfma_f32_16x16x32_bf16 v[80:83], v[56:59], v[48:51], v[80:83]
    ds_read_b64_tr_b16 v[230:231], v9 offset:38400
    v_mfma_f32_16x16x32_bf16 v[84:87], v[60:63], v[48:51], v[84:87]
    ds_read_b64_tr_b16 v[232:233], v10 offset:36864
    v_mfma_f32_16x16x32_bf16 v[88:91], v[64:67], v[48:51], v[88:91]
    ds_read_b64_tr_b16 v[234:235], v10 offset:38400
    v_mfma_f32_16x16x32_bf16 v[92:95], v[68:71], v[48:51], v[92:95]
    ds_read_b64_tr_b16 v[236:237], v11 offset:36864
    v_mfma_f32_16x16x32_bf16 v[96:99], v[72:75], v[48:51], v[96:99]
    ds_read_b64_tr_b16 v[238:239], v11 offset:38400
    v_mfma_f32_16x16x32_bf16 v[100:103], v[76:79], v[48:51], v[100:103]
    v_mfma_f32_16x16x32_bf16 v[104:107], v[56:59], v[52:55], v[104:107]
    v_mfma_f32_16x16x32_bf16 v[108:111], v[60:63], v[52:55], v[108:111]
    v_mfma_f32_16x16x32_bf16 v[112:115], v[64:67], v[52:55], v[112:115]
    v_mfma_f32_16x16x32_bf16 v[116:119], v[68:71], v[52:55], v[116:119]
    v_mfma_f32_16x16x32_bf16 v[120:123], v[72:75], v[52:55], v[120:123]
    v_mfma_f32_16x16x32_bf16 v[124:127], v[76:79], v[52:55], v[124:127]
    s_waitcnt lgkmcnt(0)
    s_barrier
    ds_read_b128 v[16:19], v2 offset:16384
    ds_read_b128 v[20:23], v2 offset:18432
    v_mfma_f32_16x16x32_bf16 v[80:83], v[184:187], v[176:179], v[80:83]
    ds_read_b64_tr_b16 v[24:25], v6 offset:49152
    ds_read_b64_tr_b16 v[26:27], v6 offset:50688
    v_mfma_f32_16x16x32_bf16 v[84:87], v[188:191], v[176:179], v[84:87]
    ds_read_b64_tr_b16 v[28:29], v7 offset:49152
    ds_read_b64_tr_b16 v[30:31], v7 offset:50688
    v_mfma_f32_16x16x32_bf16 v[88:91], v[192:195], v[176:179], v[88:91]
    ds_read_b64_tr_b16 v[32:33], v8 offset:49152
    ds_read_b64_tr_b16 v[34:35], v8 offset:50688
    v_mfma_f32_16x16x32_bf16 v[92:95], v[196:199], v[176:179], v[92:95]
    ds_read_b64_tr_b16 v[36:37], v9 offset:49152
    ds_read_b64_tr_b16 v[38:39], v9 offset:50688
    v_mfma_f32_16x16x32_bf16 v[96:99], v[200:203], v[176:179], v[96:99]
    ds_read_b64_tr_b16 v[40:41], v10 offset:49152
    ds_read_b64_tr_b16 v[42:43], v10 offset:50688
    v_mfma_f32_16x16x32_bf16 v[100:103], v[204:207], v[176:179], v[100:103]
    ds_read_b64_tr_b16 v[44:45], v11 offset:49152
    ds_read_b64_tr_b16 v[46:47], v11 offset:50688
    v_mfma_f32_16x16x32_bf16 v[104:107], v[184:187], v[180:183], v[104:107]
    ds_read_b128 v[48:51], v3 offset:16384
    ds_read_b128 v[52:55], v3 offset:18432
    v_mfma_f32_16x16x32_bf16 v[108:111], v[188:191], v[180:183], v[108:111]
    ds_read_b64_tr_b16 v[56:57], v6 offset:61440
    ds_read_b64_tr_b16 v[58:59], v6 offset:62976
    v_mfma_f32_16x16x32_bf16 v[112:115], v[192:195], v[180:183], v[112:115]
    ds_read_b64_tr_b16 v[60:61], v7 offset:61440
    ds_read_b64_tr_b16 v[62:63], v7 offset:62976
    v_mfma_f32_16x16x32_bf16 v[116:119], v[196:199], v[180:183], v[116:119]
    ds_read_b64_tr_b16 v[64:65], v8 offset:61440
    v_mfma_f32_16x16x32_bf16 v[120:123], v[200:203], v[180:183], v[120:123]
    ds_read_b64_tr_b16 v[66:67], v8 offset:62976
    v_mfma_f32_16x16x32_bf16 v[124:127], v[204:207], v[180:183], v[124:127]
    ds_read_b64_tr_b16 v[68:69], v9 offset:61440
    v_mfma_f32_16x16x32_bf16 v[80:83], v[216:219], v[208:211], v[80:83]
    ds_read_b64_tr_b16 v[70:71], v9 offset:62976
    v_mfma_f32_16x16x32_bf16 v[84:87], v[220:223], v[208:211], v[84:87]
    ds_read_b64_tr_b16 v[72:73], v10 offset:61440
    v_mfma_f32_16x16x32_bf16 v[88:91], v[224:227], v[208:211], v[88:91]
    ds_read_b64_tr_b16 v[74:75], v10 offset:62976
    v_mfma_f32_16x16x32_bf16 v[92:95], v[228:231], v[208:211], v[92:95]
    ds_read_b64_tr_b16 v[76:77], v11 offset:61440
    v_mfma_f32_16x16x32_bf16 v[96:99], v[232:235], v[208:211], v[96:99]
    ds_read_b64_tr_b16 v[78:79], v11 offset:62976
    v_mfma_f32_16x16x32_bf16 v[100:103], v[236:239], v[208:211], v[100:103]
    v_mfma_f32_16x16x32_bf16 v[104:107], v[216:219], v[212:215], v[104:107]
    v_mfma_f32_16x16x32_bf16 v[108:111], v[220:223], v[212:215], v[108:111]
    v_mfma_f32_16x16x32_bf16 v[112:115], v[224:227], v[212:215], v[112:115]
    v_mfma_f32_16x16x32_bf16 v[116:119], v[228:231], v[212:215], v[116:119]
    v_mfma_f32_16x16x32_bf16 v[120:123], v[232:235], v[212:215], v[120:123]
    v_mfma_f32_16x16x32_bf16 v[124:127], v[236:239], v[212:215], v[124:127]
    s_waitcnt lgkmcnt(0)
    s_barrier
    ds_read_b128 v[176:179], v2 offset:24576
    ds_read_b128 v[180:183], v2 offset:26624
    v_mfma_f32_16x16x32_bf16 v[80:83], v[24:27], v[16:19], v[80:83]
    ds_read_b64_tr_b16 v[184:185], v6 offset:0
    ds_read_b64_tr_b16 v[186:187], v6 offset:1536
    v_mfma_f32_16x16x32_bf16 v[84:87], v[28:31], v[16:19], v[84:87]
    ds_read_b64_tr_b16 v[188:189], v7 offset:0
    ds_read_b64_tr_b16 v[190:191], v7 offset:1536
    v_mfma_f32_16x16x32_bf16 v[88:91], v[32:35], v[16:19], v[88:91]
    ds_read_b64_tr_b16 v[192:193], v8 offset:0
    ds_read_b64_tr_b16 v[194:195], v8 offset:1536
    v_mfma_f32_16x16x32_bf16 v[92:95], v[36:39], v[16:19], v[92:95]
    ds_read_b64_tr_b16 v[196:197], v9 offset:0
    ds_read_b64_tr_b16 v[198:199], v9 offset:1536
    v_mfma_f32_16x16x32_bf16 v[96:99], v[40:43], v[16:19], v[96:99]
    ds_read_b64_tr_b16 v[200:201], v10 offset:0
    ds_read_b64_tr_b16 v[202:203], v10 offset:1536
    v_mfma_f32_16x16x32_bf16 v[100:103], v[44:47], v[16:19], v[100:103]
    ds_read_b64_tr_b16 v[204:205], v11 offset:0
    ds_read_b64_tr_b16 v[206:207], v11 offset:1536
    v_mfma_f32_16x16x32_bf16 v[104:107], v[24:27], v[20:23], v[104:107]
    ds_read_b128 v[208:211], v3 offset:24576
    ds_read_b128 v[212:215], v3 offset:26624
    v_mfma_f32_16x16x32_bf16 v[108:111], v[28:31], v[20:23], v[108:111]
    ds_read_b64_tr_b16 v[216:217], v6 offset:12288
    ds_read_b64_tr_b16 v[218:219], v6 offset:13824
    v_mfma_f32_16x16x32_bf16 v[112:115], v[32:35], v[20:23], v[112:115]
    ds_read_b64_tr_b16 v[220:221], v7 offset:12288
    ds_read_b64_tr_b16 v[222:223], v7 offset:13824
    v_mfma_f32_16x16x32_bf16 v[116:119], v[36:39], v[20:23], v[116:119]
    ds_read_b64_tr_b16 v[224:225], v8 offset:12288
    v_mfma_f32_16x16x32_bf16 v[120:123], v[40:43], v[20:23], v[120:123]
    ds_read_b64_tr_b16 v[226:227], v8 offset:13824
    v_mfma_f32_16x16x32_bf16 v[124:127], v[44:47], v[20:23], v[124:127]
    ds_read_b64_tr_b16 v[228:229], v9 offset:12288
    v_mfma_f32_16x16x32_bf16 v[80:83], v[56:59], v[48:51], v[80:83]
    ds_read_b64_tr_b16 v[230:231], v9 offset:13824
    v_mfma_f32_16x16x32_bf16 v[84:87], v[60:63], v[48:51], v[84:87]
    ds_read_b64_tr_b16 v[232:233], v10 offset:12288
    v_mfma_f32_16x16x32_bf16 v[88:91], v[64:67], v[48:51], v[88:91]
    ds_read_b64_tr_b16 v[234:235], v10 offset:13824
    v_mfma_f32_16x16x32_bf16 v[92:95], v[68:71], v[48:51], v[92:95]
    ds_read_b64_tr_b16 v[236:237], v11 offset:12288
    v_mfma_f32_16x16x32_bf16 v[96:99], v[72:75], v[48:51], v[96:99]
    ds_read_b64_tr_b16 v[238:239], v11 offset:13824
    v_mfma_f32_16x16x32_bf16 v[100:103], v[76:79], v[48:51], v[100:103]
    v_mfma_f32_16x16x32_bf16 v[104:107], v[56:59], v[52:55], v[104:107]
    v_mfma_f32_16x16x32_bf16 v[108:111], v[60:63], v[52:55], v[108:111]
    v_mfma_f32_16x16x32_bf16 v[112:115], v[64:67], v[52:55], v[112:115]
    v_mfma_f32_16x16x32_bf16 v[116:119], v[68:71], v[52:55], v[116:119]
    v_mfma_f32_16x16x32_bf16 v[120:123], v[72:75], v[52:55], v[120:123]
    v_mfma_f32_16x16x32_bf16 v[124:127], v[76:79], v[52:55], v[124:127]
    s_waitcnt lgkmcnt(0)
    s_barrier
    ds_read_b128 v[16:19], v2 offset:32768
    ds_read_b128 v[20:23], v2 offset:34816
    v_mfma_f32_16x16x32_bf16 v[80:83], v[184:187], v[176:179], v[80:83]
    ds_read_b64_tr_b16 v[24:25], v6 offset:24576
    ds_read_b64_tr_b16 v[26:27], v6 offset:26112
    v_mfma_f32_16x16x32_bf16 v[84:87], v[188:191], v[176:179], v[84:87]
    ds_read_b64_tr_b16 v[28:29], v7 offset:24576
    ds_read_b64_tr_b16 v[30:31], v7 offset:26112
    v_mfma_f32_16x16x32_bf16 v[88:91], v[192:195], v[176:179], v[88:91]
    ds_read_b64_tr_b16 v[32:33], v8 offset:24576
    ds_read_b64_tr_b16 v[34:35], v8 offset:26112
    v_mfma_f32_16x16x32_bf16 v[92:95], v[196:199], v[176:179], v[92:95]
    ds_read_b64_tr_b16 v[36:37], v9 offset:24576
    ds_read_b64_tr_b16 v[38:39], v9 offset:26112
    v_mfma_f32_16x16x32_bf16 v[96:99], v[200:203], v[176:179], v[96:99]
    ds_read_b64_tr_b16 v[40:41], v10 offset:24576
    ds_read_b64_tr_b16 v[42:43], v10 offset:26112
    v_mfma_f32_16x16x32_bf16 v[100:103], v[204:207], v[176:179], v[100:103]
    ds_read_b64_tr_b16 v[44:45], v11 offset:24576
    ds_read_b64_tr_b16 v[46:47], v11 offset:26112
    v_mfma_f32_16x16x32_bf16 v[104:107], v[184:187], v[180:183], v[104:107]
    ds_read_b128 v[48:51], v3 offset:32768
    ds_read_b128 v[52:55], v3 offset:34816
    v_mfma_f32_16x16x32_bf16 v[108:111], v[188:191], v[180:183], v[108:111]
    ds_read_b64_tr_b16 v[56:57], v6 offset:36864
    ds_read_b64_tr_b16 v[58:59], v6 offset:38400
    v_mfma_f32_16x16x32_bf16 v[112:115], v[192:195], v[180:183], v[112:115]
    ds_read_b64_tr_b16 v[60:61], v7 offset:36864
    ds_read_b64_tr_b16 v[62:63], v7 offset:38400
    v_mfma_f32_16x16x32_bf16 v[116:119], v[196:199], v[180:183], v[116:119]
    ds_read_b64_tr_b16 v[64:65], v8 offset:36864
    v_mfma_f32_16x16x32_bf16 v[120:123], v[200:203], v[180:183], v[120:123]
    ds_read_b64_tr_b16 v[66:67], v8 offset:38400
    v_mfma_f32_16x16x32_bf16 v[124:127], v[204:207], v[180:183], v[124:127]
    ds_read_b64_tr_b16 v[68:69], v9 offset:36864
    v_mfma_f32_16x16x32_bf16 v[80:83], v[216:219], v[208:211], v[80:83]
    ds_read_b64_tr_b16 v[70:71], v9 offset:38400
    v_mfma_f32_16x16x32_bf16 v[84:87], v[220:223], v[208:211], v[84:87]
    ds_read_b64_tr_b16 v[72:73], v10 offset:36864
    v_mfma_f32_16x16x32_bf16 v[88:91], v[224:227], v[208:211], v[88:91]
    ds_read_b64_tr_b16 v[74:75], v10 offset:38400
    v_mfma_f32_16x16x32_bf16 v[92:95], v[228:231], v[208:211], v[92:95]
    ds_read_b64_tr_b16 v[76:77], v11 offset:36864
    v_mfma_f32_16x16x32_bf16 v[96:99], v[232:235], v[208:211], v[96:99]
    ds_read_b64_tr_b16 v[78:79], v11 offset:38400
    v_mfma_f32_16x16x32_bf16 v[100:103], v[236:239], v[208:211], v[100:103]
    v_mfma_f32_16x16x32_bf16 v[104:107], v[216:219], v[212:215], v[104:107]
    v_mfma_f32_16x16x32_bf16 v[108:111], v[220:223], v[212:215], v[108:111]
    v_mfma_f32_16x16x32_bf16 v[112:115], v[224:227], v[212:215], v[112:115]
    v_mfma_f32_16x16x32_bf16 v[116:119], v[228:231], v[212:215], v[116:119]
    v_mfma_f32_16x16x32_bf16 v[120:123], v[232:235], v[212:215], v[120:123]
    v_mfma_f32_16x16x32_bf16 v[124:127], v[236:239], v[212:215], v[124:127]
    s_waitcnt lgkmcnt(0)
    s_barrier
    ds_read_b128 v[176:179], v2 offset:40960
    ds_read_b128 v[180:183], v2 offset:43008
    v_mfma_f32_16x16x32_bf16 v[80:83], v[24:27], v[16:19], v[80:83]
    ds_read_b64_tr_b16 v[184:185], v6 offset:49152
    ds_read_b64_tr_b16 v[186:187], v6 offset:50688
    v_mfma_f32_16x16x32_bf16 v[84:87], v[28:31], v[16:19], v[84:87]
    ds_read_b64_tr_b16 v[188:189], v7 offset:49152
    ds_read_b64_tr_b16 v[190:191], v7 offset:50688
    v_mfma_f32_16x16x32_bf16 v[88:91], v[32:35], v[16:19], v[88:91]
    ds_read_b64_tr_b16 v[192:193], v8 offset:49152
    ds_read_b64_tr_b16 v[194:195], v8 offset:50688
    v_mfma_f32_16x16x32_bf16 v[92:95], v[36:39], v[16:19], v[92:95]
    ds_read_b64_tr_b16 v[196:197], v9 offset:49152
    ds_read_b64_tr_b16 v[198:199], v9 offset:50688
    v_mfma_f32_16x16x32_bf16 v[96:99], v[40:43], v[16:19], v[96:99]
    ds_read_b64_tr_b16 v[200:201], v10 offset:49152
    ds_read_b64_tr_b16 v[202:203], v10 offset:50688
    v_mfma_f32_16x16x32_bf16 v[100:103], v[44:47], v[16:19], v[100:103]
    ds_read_b64_tr_b16 v[204:205], v11 offset:49152
    ds_read_b64_tr_b16 v[206:207], v11 offset:50688
    v_mfma_f32_16x16x32_bf16 v[104:107], v[24:27], v[20:23], v[104:107]
    ds_read_b128 v[208:211], v3 offset:40960
    ds_read_b128 v[212:215], v3 offset:43008
    v_mfma_f32_16x16x32_bf16 v[108:111], v[28:31], v[20:23], v[108:111]
    ds_read_b64_tr_b16 v[216:217], v6 offset:61440
    ds_read_b64_tr_b16 v[218:219], v6 offset:62976
    v_mfma_f32_16x16x32_bf16 v[112:115], v[32:35], v[20:23], v[112:115]
    ds_read_b64_tr_b16 v[220:221], v7 offset:61440
    ds_read_b64_tr_b16 v[222:223], v7 offset:62976
    v_mfma_f32_16x16x32_bf16 v[116:119], v[36:39], v[20:23], v[116:119]
    ds_read_b64_tr_b16 v[224:225], v8 offset:61440
    v_mfma_f32_16x16x32_bf16 v[120:123], v[40:43], v[20:23], v[120:123]
    ds_read_b64_tr_b16 v[226:227], v8 offset:62976
    v_mfma_f32_16x16x32_bf16 v[124:127], v[44:47], v[20:23], v[124:127]
    ds_read_b64_tr_b16 v[228:229], v9 offset:61440
    v_mfma_f32_16x16x32_bf16 v[80:83], v[56:59], v[48:51], v[80:83]
    ds_read_b64_tr_b16 v[230:231], v9 offset:62976
    v_mfma_f32_16x16x32_bf16 v[84:87], v[60:63], v[48:51], v[84:87]
    ds_read_b64_tr_b16 v[232:233], v10 offset:61440
    v_mfma_f32_16x16x32_bf16 v[88:91], v[64:67], v[48:51], v[88:91]
    ds_read_b64_tr_b16 v[234:235], v10 offset:62976
    v_mfma_f32_16x16x32_bf16 v[92:95], v[68:71], v[48:51], v[92:95]
    ds_read_b64_tr_b16 v[236:237], v11 offset:61440
    v_mfma_f32_16x16x32_bf16 v[96:99], v[72:75], v[48:51], v[96:99]
    ds_read_b64_tr_b16 v[238:239], v11 offset:62976
    v_mfma_f32_16x16x32_bf16 v[100:103], v[76:79], v[48:51], v[100:103]
    v_mfma_f32_16x16x32_bf16 v[104:107], v[56:59], v[52:55], v[104:107]
    v_mfma_f32_16x16x32_bf16 v[108:111], v[60:63], v[52:55], v[108:111]
    v_mfma_f32_16x16x32_bf16 v[112:115], v[64:67], v[52:55], v[112:115]
    v_mfma_f32_16x16x32_bf16 v[116:119], v[68:71], v[52:55], v[116:119]
    v_mfma_f32_16x16x32_bf16 v[120:123], v[72:75], v[52:55], v[120:123]
    v_mfma_f32_16x16x32_bf16 v[124:127], v[76:79], v[52:55], v[124:127]
    s_waitcnt lgkmcnt(0)
    s_barrier
    ds_read_b128 v[16:19], v2 offset:49152
    ds_read_b128 v[20:23], v2 offset:51200
    v_mfma_f32_16x16x32_bf16 v[80:83], v[184:187], v[176:179], v[80:83]
    ds_read_b64_tr_b16 v[24:25], v6 offset:0
    ds_read_b64_tr_b16 v[26:27], v6 offset:1536
    v_mfma_f32_16x16x32_bf16 v[84:87], v[188:191], v[176:179], v[84:87]
    ds_read_b64_tr_b16 v[28:29], v7 offset:0
    ds_read_b64_tr_b16 v[30:31], v7 offset:1536
    v_mfma_f32_16x16x32_bf16 v[88:91], v[192:195], v[176:179], v[88:91]
    ds_read_b64_tr_b16 v[32:33], v8 offset:0
    ds_read_b64_tr_b16 v[34:35], v8 offset:1536
    v_mfma_f32_16x16x32_bf16 v[92:95], v[196:199], v[176:179], v[92:95]
    ds_read_b64_tr_b16 v[36:37], v9 offset:0
    ds_read_b64_tr_b16 v[38:39], v9 offset:1536
    v_mfma_f32_16x16x32_bf16 v[96:99], v[200:203], v[176:179], v[96:99]
    ds_read_b64_tr_b16 v[40:41], v10 offset:0
    ds_read_b64_tr_b16 v[42:43], v10 offset:1536
    v_mfma_f32_16x16x32_bf16 v[100:103], v[204:207], v[176:179], v[100:103]
    ds_read_b64_tr_b16 v[44:45], v11 offset:0
    ds_read_b64_tr_b16 v[46:47], v11 offset:1536
    v_mfma_f32_16x16x32_bf16 v[104:107], v[184:187], v[180:183], v[104:107]
    ds_read_b128 v[48:51], v3 offset:49152
    ds_read_b128 v[52:55], v3 offset:51200
    v_mfma_f32_16x16x32_bf16 v[108:111], v[188:191], v[180:183], v[108:111]
    ds_read_b64_tr_b16 v[56:57], v6 offset:12288
    ds_read_b64_tr_b16 v[58:59], v6 offset:13824
    v_mfma_f32_16x16x32_bf16 v[112:115], v[192:195], v[180:183], v[112:115]
    ds_read_b64_tr_b16 v[60:61], v7 offset:12288
    ds_read_b64_tr_b16 v[62:63], v7 offset:13824
    v_mfma_f32_16x16x32_bf16 v[116:119], v[196:199], v[180:183], v[116:119]
    ds_read_b64_tr_b16 v[64:65], v8 offset:12288
    v_mfma_f32_16x16x32_bf16 v[120:123], v[200:203], v[180:183], v[120:123]
    ds_read_b64_tr_b16 v[66:67], v8 offset:13824
    v_mfma_f32_16x16x32_bf16 v[124:127], v[204:207], v[180:183], v[124:127]
    ds_read_b64_tr_b16 v[68:69], v9 offset:12288
    v_mfma_f32_16x16x32_bf16 v[80:83], v[216:219], v[208:211], v[80:83]
    ds_read_b64_tr_b16 v[70:71], v9 offset:13824
    v_mfma_f32_16x16x32_bf16 v[84:87], v[220:223], v[208:211], v[84:87]
    ds_read_b64_tr_b16 v[72:73], v10 offset:12288
    v_mfma_f32_16x16x32_bf16 v[88:91], v[224:227], v[208:211], v[88:91]
    ds_read_b64_tr_b16 v[74:75], v10 offset:13824
    v_mfma_f32_16x16x32_bf16 v[92:95], v[228:231], v[208:211], v[92:95]
    ds_read_b64_tr_b16 v[76:77], v11 offset:12288
    v_mfma_f32_16x16x32_bf16 v[96:99], v[232:235], v[208:211], v[96:99]
    ds_read_b64_tr_b16 v[78:79], v11 offset:13824
    v_mfma_f32_16x16x32_bf16 v[100:103], v[236:239], v[208:211], v[100:103]
    v_mfma_f32_16x16x32_bf16 v[104:107], v[216:219], v[212:215], v[104:107]
    v_mfma_f32_16x16x32_bf16 v[108:111], v[220:223], v[212:215], v[108:111]
    v_mfma_f32_16x16x32_bf16 v[112:115], v[224:227], v[212:215], v[112:115]
    v_mfma_f32_16x16x32_bf16 v[116:119], v[228:231], v[212:215], v[116:119]
    v_mfma_f32_16x16x32_bf16 v[120:123], v[232:235], v[212:215], v[120:123]
    v_mfma_f32_16x16x32_bf16 v[124:127], v[236:239], v[212:215], v[124:127]
    s_waitcnt lgkmcnt(0)
    s_barrier
    ds_read_b128 v[176:179], v2 offset:57344
    ds_read_b128 v[180:183], v2 offset:59392
    v_mfma_f32_16x16x32_bf16 v[80:83], v[24:27], v[16:19], v[80:83]
    ds_read_b64_tr_b16 v[184:185], v6 offset:24576
    ds_read_b64_tr_b16 v[186:187], v6 offset:26112
    v_mfma_f32_16x16x32_bf16 v[84:87], v[28:31], v[16:19], v[84:87]
    ds_read_b64_tr_b16 v[188:189], v7 offset:24576
    ds_read_b64_tr_b16 v[190:191], v7 offset:26112
    v_mfma_f32_16x16x32_bf16 v[88:91], v[32:35], v[16:19], v[88:91]
    ds_read_b64_tr_b16 v[192:193], v8 offset:24576
    ds_read_b64_tr_b16 v[194:195], v8 offset:26112
    v_mfma_f32_16x16x32_bf16 v[92:95], v[36:39], v[16:19], v[92:95]
    ds_read_b64_tr_b16 v[196:197], v9 offset:24576
    ds_read_b64_tr_b16 v[198:199], v9 offset:26112
    v_mfma_f32_16x16x32_bf16 v[96:99], v[40:43], v[16:19], v[96:99]
    ds_read_b64_tr_b16 v[200:201], v10 offset:24576
    ds_read_b64_tr_b16 v[202:203], v10 offset:26112
    v_mfma_f32_16x16x32_bf16 v[100:103], v[44:47], v[16:19], v[100:103]
    ds_read_b64_tr_b16 v[204:205], v11 offset:24576
    ds_read_b64_tr_b16 v[206:207], v11 offset:26112
    v_mfma_f32_16x16x32_bf16 v[104:107], v[24:27], v[20:23], v[104:107]
    ds_read_b128 v[208:211], v3 offset:57344
    ds_read_b128 v[212:215], v3 offset:59392
    v_mfma_f32_16x16x32_bf16 v[108:111], v[28:31], v[20:23], v[108:111]
    ds_read_b64_tr_b16 v[216:217], v6 offset:36864
    ds_read_b64_tr_b16 v[218:219], v6 offset:38400
    v_mfma_f32_16x16x32_bf16 v[112:115], v[32:35], v[20:23], v[112:115]
    ds_read_b64_tr_b16 v[220:221], v7 offset:36864
    ds_read_b64_tr_b16 v[222:223], v7 offset:38400
    v_mfma_f32_16x16x32_bf16 v[116:119], v[36:39], v[20:23], v[116:119]
    ds_read_b64_tr_b16 v[224:225], v8 offset:36864
    v_mfma_f32_16x16x32_bf16 v[120:123], v[40:43], v[20:23], v[120:123]
    ds_read_b64_tr_b16 v[226:227], v8 offset:38400
    v_mfma_f32_16x16x32_bf16 v[124:127], v[44:47], v[20:23], v[124:127]
    ds_read_b64_tr_b16 v[228:229], v9 offset:36864
    v_mfma_f32_16x16x32_bf16 v[80:83], v[56:59], v[48:51], v[80:83]
    ds_read_b64_tr_b16 v[230:231], v9 offset:38400
    v_mfma_f32_16x16x32_bf16 v[84:87], v[60:63], v[48:51], v[84:87]
    ds_read_b64_tr_b16 v[232:233], v10 offset:36864
    v_mfma_f32_16x16x32_bf16 v[88:91], v[64:67], v[48:51], v[88:91]
    ds_read_b64_tr_b16 v[234:235], v10 offset:38400
    v_mfma_f32_16x16x32_bf16 v[92:95], v[68:71], v[48:51], v[92:95]
    ds_read_b64_tr_b16 v[236:237], v11 offset:36864
    v_mfma_f32_16x16x32_bf16 v[96:99], v[72:75], v[48:51], v[96:99]
    ds_read_b64_tr_b16 v[238:239], v11 offset:38400
    v_mfma_f32_16x16x32_bf16 v[100:103], v[76:79], v[48:51], v[100:103]
    v_mfma_f32_16x16x32_bf16 v[104:107], v[56:59], v[52:55], v[104:107]
    v_mfma_f32_16x16x32_bf16 v[108:111], v[60:63], v[52:55], v[108:111]
    v_mfma_f32_16x16x32_bf16 v[112:115], v[64:67], v[52:55], v[112:115]
    v_mfma_f32_16x16x32_bf16 v[116:119], v[68:71], v[52:55], v[116:119]
    v_mfma_f32_16x16x32_bf16 v[120:123], v[72:75], v[52:55], v[120:123]
    v_mfma_f32_16x16x32_bf16 v[124:127], v[76:79], v[52:55], v[124:127]
    s_waitcnt lgkmcnt(0)
    s_barrier
    ds_read_b128 v[16:19], v4 offset:0
    ds_read_b128 v[20:23], v4 offset:2048
    v_mfma_f32_16x16x32_bf16 v[80:83], v[184:187], v[176:179], v[80:83]
    ds_read_b64_tr_b16 v[24:25], v6 offset:49152
    ds_read_b64_tr_b16 v[26:27], v6 offset:50688
    v_mfma_f32_16x16x32_bf16 v[84:87], v[188:191], v[176:179], v[84:87]
    ds_read_b64_tr_b16 v[28:29], v7 offset:49152
    ds_read_b64_tr_b16 v[30:31], v7 offset:50688
    v_mfma_f32_16x16x32_bf16 v[88:91], v[192:195], v[176:179], v[88:91]
    ds_read_b64_tr_b16 v[32:33], v8 offset:49152
    ds_read_b64_tr_b16 v[34:35], v8 offset:50688
    v_mfma_f32_16x16x32_bf16 v[92:95], v[196:199], v[176:179], v[92:95]
    ds_read_b64_tr_b16 v[36:37], v9 offset:49152
    ds_read_b64_tr_b16 v[38:39], v9 offset:50688
    v_mfma_f32_16x16x32_bf16 v[96:99], v[200:203], v[176:179], v[96:99]
    ds_read_b64_tr_b16 v[40:41], v10 offset:49152
    ds_read_b64_tr_b16 v[42:43], v10 offset:50688
    v_mfma_f32_16x16x32_bf16 v[100:103], v[204:207], v[176:179], v[100:103]
    ds_read_b64_tr_b16 v[44:45], v11 offset:49152
    ds_read_b64_tr_b16 v[46:47], v11 offset:50688
    v_mfma_f32_16x16x32_bf16 v[104:107], v[184:187], v[180:183], v[104:107]
    ds_read_b128 v[48:51], v5 offset:0
    ds_read_b128 v[52:55], v5 offset:2048
    v_mfma_f32_16x16x32_bf16 v[108:111], v[188:191], v[180:183], v[108:111]
    ds_read_b64_tr_b16 v[56:57], v6 offset:61440
    ds_read_b64_tr_b16 v[58:59], v6 offset:62976
    v_mfma_f32_16x16x32_bf16 v[112:115], v[192:195], v[180:183], v[112:115]
    ds_read_b64_tr_b16 v[60:61], v7 offset:61440
    ds_read_b64_tr_b16 v[62:63], v7 offset:62976
    v_mfma_f32_16x16x32_bf16 v[116:119], v[196:199], v[180:183], v[116:119]
    ds_read_b64_tr_b16 v[64:65], v8 offset:61440
    v_mfma_f32_16x16x32_bf16 v[120:123], v[200:203], v[180:183], v[120:123]
    ds_read_b64_tr_b16 v[66:67], v8 offset:62976
    v_mfma_f32_16x16x32_bf16 v[124:127], v[204:207], v[180:183], v[124:127]
    ds_read_b64_tr_b16 v[68:69], v9 offset:61440
    v_mfma_f32_16x16x32_bf16 v[80:83], v[216:219], v[208:211], v[80:83]
    ds_read_b64_tr_b16 v[70:71], v9 offset:62976
    v_mfma_f32_16x16x32_bf16 v[84:87], v[220:223], v[208:211], v[84:87]
    ds_read_b64_tr_b16 v[72:73], v10 offset:61440
    v_mfma_f32_16x16x32_bf16 v[88:91], v[224:227], v[208:211], v[88:91]
    ds_read_b64_tr_b16 v[74:75], v10 offset:62976
    v_mfma_f32_16x16x32_bf16 v[92:95], v[228:231], v[208:211], v[92:95]
    ds_read_b64_tr_b16 v[76:77], v11 offset:61440
    v_mfma_f32_16x16x32_bf16 v[96:99], v[232:235], v[208:211], v[96:99]
    ds_read_b64_tr_b16 v[78:79], v11 offset:62976
    v_mfma_f32_16x16x32_bf16 v[100:103], v[236:239], v[208:211], v[100:103]
    v_mfma_f32_16x16x32_bf16 v[104:107], v[216:219], v[212:215], v[104:107]
    v_mfma_f32_16x16x32_bf16 v[108:111], v[220:223], v[212:215], v[108:111]
    v_mfma_f32_16x16x32_bf16 v[112:115], v[224:227], v[212:215], v[112:115]
    v_mfma_f32_16x16x32_bf16 v[116:119], v[228:231], v[212:215], v[116:119]
    v_mfma_f32_16x16x32_bf16 v[120:123], v[232:235], v[212:215], v[120:123]
    v_mfma_f32_16x16x32_bf16 v[124:127], v[236:239], v[212:215], v[124:127]
    s_waitcnt lgkmcnt(0)
    s_barrier
    ds_read_b128 v[176:179], v4 offset:8192
    ds_read_b128 v[180:183], v4 offset:10240
    v_mfma_f32_16x16x32_bf16 v[80:83], v[24:27], v[16:19], v[80:83]
    ds_read_b64_tr_b16 v[184:185], v6 offset:0
    ds_read_b64_tr_b16 v[186:187], v6 offset:1536
    v_mfma_f32_16x16x32_bf16 v[84:87], v[28:31], v[16:19], v[84:87]
    ds_read_b64_tr_b16 v[188:189], v7 offset:0
    ds_read_b64_tr_b16 v[190:191], v7 offset:1536
    v_mfma_f32_16x16x32_bf16 v[88:91], v[32:35], v[16:19], v[88:91]
    ds_read_b64_tr_b16 v[192:193], v8 offset:0
    ds_read_b64_tr_b16 v[194:195], v8 offset:1536
    v_mfma_f32_16x16x32_bf16 v[92:95], v[36:39], v[16:19], v[92:95]
    ds_read_b64_tr_b16 v[196:197], v9 offset:0
    ds_read_b64_tr_b16 v[198:199], v9 offset:1536
    v_mfma_f32_16x16x32_bf16 v[96:99], v[40:43], v[16:19], v[96:99]
    ds_read_b64_tr_b16 v[200:201], v10 offset:0
    ds_read_b64_tr_b16 v[202:203], v10 offset:1536
    v_mfma_f32_16x16x32_bf16 v[100:103], v[44:47], v[16:19], v[100:103]
    ds_read_b64_tr_b16 v[204:205], v11 offset:0
    ds_read_b64_tr_b16 v[206:207], v11 offset:1536
    v_mfma_f32_16x16x32_bf16 v[104:107], v[24:27], v[20:23], v[104:107]
    ds_read_b128 v[208:211], v5 offset:8192
    ds_read_b128 v[212:215], v5 offset:10240
    v_mfma_f32_16x16x32_bf16 v[108:111], v[28:31], v[20:23], v[108:111]
    ds_read_b64_tr_b16 v[216:217], v6 offset:12288
    ds_read_b64_tr_b16 v[218:219], v6 offset:13824
    v_mfma_f32_16x16x32_bf16 v[112:115], v[32:35], v[20:23], v[112:115]
    ds_read_b64_tr_b16 v[220:221], v7 offset:12288
    ds_read_b64_tr_b16 v[222:223], v7 offset:13824
    v_mfma_f32_16x16x32_bf16 v[116:119], v[36:39], v[20:23], v[116:119]
    ds_read_b64_tr_b16 v[224:225], v8 offset:12288
    v_mfma_f32_16x16x32_bf16 v[120:123], v[40:43], v[20:23], v[120:123]
    ds_read_b64_tr_b16 v[226:227], v8 offset:13824
    v_mfma_f32_16x16x32_bf16 v[124:127], v[44:47], v[20:23], v[124:127]
    ds_read_b64_tr_b16 v[228:229], v9 offset:12288
    v_mfma_f32_16x16x32_bf16 v[80:83], v[56:59], v[48:51], v[80:83]
    ds_read_b64_tr_b16 v[230:231], v9 offset:13824
    v_mfma_f32_16x16x32_bf16 v[84:87], v[60:63], v[48:51], v[84:87]
    ds_read_b64_tr_b16 v[232:233], v10 offset:12288
    v_mfma_f32_16x16x32_bf16 v[88:91], v[64:67], v[48:51], v[88:91]
    ds_read_b64_tr_b16 v[234:235], v10 offset:13824
    v_mfma_f32_16x16x32_bf16 v[92:95], v[68:71], v[48:51], v[92:95]
    ds_read_b64_tr_b16 v[236:237], v11 offset:12288
    v_mfma_f32_16x16x32_bf16 v[96:99], v[72:75], v[48:51], v[96:99]
    ds_read_b64_tr_b16 v[238:239], v11 offset:13824
    v_mfma_f32_16x16x32_bf16 v[100:103], v[76:79], v[48:51], v[100:103]
    v_mfma_f32_16x16x32_bf16 v[104:107], v[56:59], v[52:55], v[104:107]
    v_mfma_f32_16x16x32_bf16 v[108:111], v[60:63], v[52:55], v[108:111]
    v_mfma_f32_16x16x32_bf16 v[112:115], v[64:67], v[52:55], v[112:115]
    v_mfma_f32_16x16x32_bf16 v[116:119], v[68:71], v[52:55], v[116:119]
    v_mfma_f32_16x16x32_bf16 v[120:123], v[72:75], v[52:55], v[120:123]
    v_mfma_f32_16x16x32_bf16 v[124:127], v[76:79], v[52:55], v[124:127]
    s_waitcnt lgkmcnt(0)
    s_barrier
    ds_read_b128 v[16:19], v2 offset:0
    ds_read_b128 v[20:23], v2 offset:2048
    v_mfma_f32_16x16x32_bf16 v[80:83], v[184:187], v[176:179], v[80:83]
    ds_read_b64_tr_b16 v[24:25], v6 offset:24576
    ds_read_b64_tr_b16 v[26:27], v6 offset:26112
    v_mfma_f32_16x16x32_bf16 v[84:87], v[188:191], v[176:179], v[84:87]
    ds_read_b64_tr_b16 v[28:29], v7 offset:24576
    ds_read_b64_tr_b16 v[30:31], v7 offset:26112
    v_mfma_f32_16x16x32_bf16 v[88:91], v[192:195], v[176:179], v[88:91]
    ds_read_b64_tr_b16 v[32:33], v8 offset:24576
    ds_read_b64_tr_b16 v[34:35], v8 offset:26112
    v_mfma_f32_16x16x32_bf16 v[92:95], v[196:199], v[176:179], v[92:95]
    ds_read_b64_tr_b16 v[36:37], v9 offset:24576
    ds_read_b64_tr_b16 v[38:39], v9 offset:26112
    v_mfma_f32_16x16x32_bf16 v[96:99], v[200:203], v[176:179], v[96:99]
    ds_read_b64_tr_b16 v[40:41], v10 offset:24576
    ds_read_b64_tr_b16 v[42:43], v10 offset:26112
    v_mfma_f32_16x16x32_bf16 v[100:103], v[204:207], v[176:179], v[100:103]
    ds_read_b64_tr_b16 v[44:45], v11 offset:24576
    ds_read_b64_tr_b16 v[46:47], v11 offset:26112
    v_mfma_f32_16x16x32_bf16 v[104:107], v[184:187], v[180:183], v[104:107]
    ds_read_b128 v[48:51], v3 offset:0
    ds_read_b128 v[52:55], v3 offset:2048
    v_mfma_f32_16x16x32_bf16 v[108:111], v[188:191], v[180:183], v[108:111]
    ds_read_b64_tr_b16 v[56:57], v6 offset:36864
    ds_read_b64_tr_b16 v[58:59], v6 offset:38400
    v_mfma_f32_16x16x32_bf16 v[112:115], v[192:195], v[180:183], v[112:115]
    ds_read_b64_tr_b16 v[60:61], v7 offset:36864
    ds_read_b64_tr_b16 v[62:63], v7 offset:38400
    v_mfma_f32_16x16x32_bf16 v[116:119], v[196:199], v[180:183], v[116:119]
    ds_read_b64_tr_b16 v[64:65], v8 offset:36864
    v_mfma_f32_16x16x32_bf16 v[120:123], v[200:203], v[180:183], v[120:123]
    ds_read_b64_tr_b16 v[66:67], v8 offset:38400
    v_mfma_f32_16x16x32_bf16 v[124:127], v[204:207], v[180:183], v[124:127]
    ds_read_b64_tr_b16 v[68:69], v9 offset:36864
    v_mfma_f32_16x16x32_bf16 v[80:83], v[216:219], v[208:211], v[80:83]
    ds_read_b64_tr_b16 v[70:71], v9 offset:38400
    v_mfma_f32_16x16x32_bf16 v[84:87], v[220:223], v[208:211], v[84:87]
    ds_read_b64_tr_b16 v[72:73], v10 offset:36864
    v_mfma_f32_16x16x32_bf16 v[88:91], v[224:227], v[208:211], v[88:91]
    ds_read_b64_tr_b16 v[74:75], v10 offset:38400
    v_mfma_f32_16x16x32_bf16 v[92:95], v[228:231], v[208:211], v[92:95]
    ds_read_b64_tr_b16 v[76:77], v11 offset:36864
    v_mfma_f32_16x16x32_bf16 v[96:99], v[232:235], v[208:211], v[96:99]
    ds_read_b64_tr_b16 v[78:79], v11 offset:38400
    v_mfma_f32_16x16x32_bf16 v[100:103], v[236:239], v[208:211], v[100:103]
    v_mfma_f32_16x16x32_bf16 v[104:107], v[216:219], v[212:215], v[104:107]
    v_mfma_f32_16x16x32_bf16 v[108:111], v[220:223], v[212:215], v[108:111]
    v_mfma_f32_16x16x32_bf16 v[112:115], v[224:227], v[212:215], v[112:115]
    v_mfma_f32_16x16x32_bf16 v[116:119], v[228:231], v[212:215], v[116:119]
    v_mfma_f32_16x16x32_bf16 v[120:123], v[232:235], v[212:215], v[120:123]
    v_mfma_f32_16x16x32_bf16 v[124:127], v[236:239], v[212:215], v[124:127]
    s_waitcnt lgkmcnt(0)
    s_mov_b32 s56, 3184710632
    s_mov_b32 s57, 3184710632
    v_mov_b32 v12, 3222493025
    v_mov_b32 v13, 3222493025
    v_pk_mul_f32 v[176:177], v[80:81], v[80:81]
    v_pk_mul_f32 v[178:179], v[82:83], v[82:83]
    v_pk_mul_f32 v[180:181], v[84:85], v[84:85]
    v_pk_mul_f32 v[182:183], v[86:87], v[86:87]
    v_pk_mul_f32 v[184:185], v[88:89], v[88:89]
    v_pk_mul_f32 v[186:187], v[90:91], v[90:91]
    v_pk_mul_f32 v[188:189], v[92:93], v[92:93]
    v_pk_mul_f32 v[190:191], v[94:95], v[94:95]
    v_pk_mul_f32 v[192:193], v[96:97], v[96:97]
    v_pk_mul_f32 v[194:195], v[98:99], v[98:99]
    v_pk_mul_f32 v[196:197], v[100:101], v[100:101]
    v_pk_mul_f32 v[198:199], v[102:103], v[102:103]
    v_pk_mul_f32 v[200:201], v[104:105], v[104:105]
    v_pk_mul_f32 v[202:203], v[106:107], v[106:107]
    v_pk_mul_f32 v[204:205], v[108:109], v[108:109]
    v_pk_mul_f32 v[206:207], v[110:111], v[110:111]
    v_pk_mul_f32 v[208:209], v[112:113], v[112:113]
    v_pk_mul_f32 v[210:211], v[114:115], v[114:115]
    v_pk_mul_f32 v[212:213], v[116:117], v[116:117]
    v_pk_mul_f32 v[214:215], v[118:119], v[118:119]
    v_pk_mul_f32 v[216:217], v[120:121], v[120:121]
    v_pk_mul_f32 v[218:219], v[122:123], v[122:123]
    v_pk_mul_f32 v[220:221], v[124:125], v[124:125]
    v_pk_mul_f32 v[222:223], v[126:127], v[126:127]
    v_pk_fma_f32 v[176:177], v[176:177], s[56:57], v[12:13]
    v_pk_fma_f32 v[178:179], v[178:179], s[56:57], v[12:13]
    v_pk_fma_f32 v[180:181], v[180:181], s[56:57], v[12:13]
    v_pk_fma_f32 v[182:183], v[182:183], s[56:57], v[12:13]
    v_pk_fma_f32 v[184:185], v[184:185], s[56:57], v[12:13]
    v_pk_fma_f32 v[186:187], v[186:187], s[56:57], v[12:13]
    v_pk_fma_f32 v[188:189], v[188:189], s[56:57], v[12:13]
    v_pk_fma_f32 v[190:191], v[190:191], s[56:57], v[12:13]
    v_pk_fma_f32 v[192:193], v[192:193], s[56:57], v[12:13]
    v_pk_fma_f32 v[194:195], v[194:195], s[56:57], v[12:13]
    v_pk_fma_f32 v[196:197], v[196:197], s[56:57], v[12:13]
    v_pk_fma_f32 v[198:199], v[198:199], s[56:57], v[12:13]
    v_pk_fma_f32 v[200:201], v[200:201], s[56:57], v[12:13]
    v_pk_fma_f32 v[202:203], v[202:203], s[56:57], v[12:13]
    v_pk_fma_f32 v[204:205], v[204:205], s[56:57], v[12:13]
    v_pk_fma_f32 v[206:207], v[206:207], s[56:57], v[12:13]
    v_pk_fma_f32 v[208:209], v[208:209], s[56:57], v[12:13]
    v_pk_fma_f32 v[210:211], v[210:211], s[56:57], v[12:13]
    v_pk_fma_f32 v[212:213], v[212:213], s[56:57], v[12:13]
    v_pk_fma_f32 v[214:215], v[214:215], s[56:57], v[12:13]
    v_pk_fma_f32 v[216:217], v[216:217], s[56:57], v[12:13]
    v_pk_fma_f32 v[218:219], v[218:219], s[56:57], v[12:13]
    v_pk_fma_f32 v[220:221], v[220:221], s[56:57], v[12:13]
    v_pk_fma_f32 v[222:223], v[222:223], s[56:57], v[12:13]
    v_pk_mul_f32 v[176:177], v[176:177], v[80:81]
    v_pk_mul_f32 v[178:179], v[178:179], v[82:83]
    v_pk_mul_f32 v[180:181], v[180:181], v[84:85]
    v_pk_mul_f32 v[182:183], v[182:183], v[86:87]
    v_pk_mul_f32 v[184:185], v[184:185], v[88:89]
    v_pk_mul_f32 v[186:187], v[186:187], v[90:91]
    v_pk_mul_f32 v[188:189], v[188:189], v[92:93]
    v_pk_mul_f32 v[190:191], v[190:191], v[94:95]
    v_pk_mul_f32 v[192:193], v[192:193], v[96:97]
    v_pk_mul_f32 v[194:195], v[194:195], v[98:99]
    v_pk_mul_f32 v[196:197], v[196:197], v[100:101]
    v_pk_mul_f32 v[198:199], v[198:199], v[102:103]
    v_pk_mul_f32 v[200:201], v[200:201], v[104:105]
    v_pk_mul_f32 v[202:203], v[202:203], v[106:107]
    v_pk_mul_f32 v[204:205], v[204:205], v[108:109]
    v_pk_mul_f32 v[206:207], v[206:207], v[110:111]
    v_pk_mul_f32 v[208:209], v[208:209], v[112:113]
    v_pk_mul_f32 v[210:211], v[210:211], v[114:115]
    v_pk_mul_f32 v[212:213], v[212:213], v[116:117]
    v_pk_mul_f32 v[214:215], v[214:215], v[118:119]
    v_pk_mul_f32 v[216:217], v[216:217], v[120:121]
    v_pk_mul_f32 v[218:219], v[218:219], v[122:123]
    v_pk_mul_f32 v[220:221], v[220:221], v[124:125]
    v_pk_mul_f32 v[222:223], v[222:223], v[126:127]
    v_exp_f32 v176, v176
    v_exp_f32 v177, v177
    v_exp_f32 v178, v178
    v_exp_f32 v179, v179
    v_exp_f32 v180, v180
    v_exp_f32 v181, v181
    v_exp_f32 v182, v182
    v_exp_f32 v183, v183
    v_exp_f32 v184, v184
    v_exp_f32 v185, v185
    v_exp_f32 v186, v186
    v_exp_f32 v187, v187
    v_exp_f32 v188, v188
    v_exp_f32 v189, v189
    v_exp_f32 v190, v190
    v_exp_f32 v191, v191
    v_exp_f32 v192, v192
    v_exp_f32 v193, v193
    v_exp_f32 v194, v194
    v_exp_f32 v195, v195
    v_exp_f32 v196, v196
    v_exp_f32 v197, v197
    v_exp_f32 v198, v198
    v_exp_f32 v199, v199
    v_exp_f32 v200, v200
    v_exp_f32 v201, v201
    v_exp_f32 v202, v202
    v_exp_f32 v203, v203
    v_exp_f32 v204, v204
    v_exp_f32 v205, v205
    v_exp_f32 v206, v206
    v_exp_f32 v207, v207
    v_exp_f32 v208, v208
    v_exp_f32 v209, v209
    v_exp_f32 v210, v210
    v_exp_f32 v211, v211
    v_exp_f32 v212, v212
    v_exp_f32 v213, v213
    v_exp_f32 v214, v214
    v_exp_f32 v215, v215
    v_exp_f32 v216, v216
    v_exp_f32 v217, v217
    v_exp_f32 v218, v218
    v_exp_f32 v219, v219
    v_exp_f32 v220, v220
    v_exp_f32 v221, v221
    v_exp_f32 v222, v222
    v_exp_f32 v223, v223
    v_pk_add_f32 v[176:177], v[176:177], 1.0 op_sel_hi:[1,0]
    v_pk_add_f32 v[178:179], v[178:179], 1.0 op_sel_hi:[1,0]
    v_pk_add_f32 v[180:181], v[180:181], 1.0 op_sel_hi:[1,0]
    v_pk_add_f32 v[182:183], v[182:183], 1.0 op_sel_hi:[1,0]
    v_pk_add_f32 v[184:185], v[184:185], 1.0 op_sel_hi:[1,0]
    v_pk_add_f32 v[186:187], v[186:187], 1.0 op_sel_hi:[1,0]
    v_pk_add_f32 v[188:189], v[188:189], 1.0 op_sel_hi:[1,0]
    v_pk_add_f32 v[190:191], v[190:191], 1.0 op_sel_hi:[1,0]
    v_pk_add_f32 v[192:193], v[192:193], 1.0 op_sel_hi:[1,0]
    v_pk_add_f32 v[194:195], v[194:195], 1.0 op_sel_hi:[1,0]
    v_pk_add_f32 v[196:197], v[196:197], 1.0 op_sel_hi:[1,0]
    v_pk_add_f32 v[198:199], v[198:199], 1.0 op_sel_hi:[1,0]
    v_pk_add_f32 v[200:201], v[200:201], 1.0 op_sel_hi:[1,0]
    v_pk_add_f32 v[202:203], v[202:203], 1.0 op_sel_hi:[1,0]
    v_pk_add_f32 v[204:205], v[204:205], 1.0 op_sel_hi:[1,0]
    v_pk_add_f32 v[206:207], v[206:207], 1.0 op_sel_hi:[1,0]
    v_pk_add_f32 v[208:209], v[208:209], 1.0 op_sel_hi:[1,0]
    v_pk_add_f32 v[210:211], v[210:211], 1.0 op_sel_hi:[1,0]
    v_pk_add_f32 v[212:213], v[212:213], 1.0 op_sel_hi:[1,0]
    v_pk_add_f32 v[214:215], v[214:215], 1.0 op_sel_hi:[1,0]
    v_pk_add_f32 v[216:217], v[216:217], 1.0 op_sel_hi:[1,0]
    v_pk_add_f32 v[218:219], v[218:219], 1.0 op_sel_hi:[1,0]
    v_pk_add_f32 v[220:221], v[220:221], 1.0 op_sel_hi:[1,0]
    v_pk_add_f32 v[222:223], v[222:223], 1.0 op_sel_hi:[1,0]
    v_rcp_f32 v176, v176
    v_rcp_f32 v177, v177
    v_rcp_f32 v178, v178
    v_rcp_f32 v179, v179
    v_rcp_f32 v180, v180
    v_rcp_f32 v181, v181
    v_rcp_f32 v182, v182
    v_rcp_f32 v183, v183
    v_rcp_f32 v184, v184
    v_rcp_f32 v185, v185
    v_rcp_f32 v186, v186
    v_rcp_f32 v187, v187
    v_rcp_f32 v188, v188
    v_rcp_f32 v189, v189
    v_rcp_f32 v190, v190
    v_rcp_f32 v191, v191
    v_rcp_f32 v192, v192
    v_rcp_f32 v193, v193
    v_rcp_f32 v194, v194
    v_rcp_f32 v195, v195
    v_rcp_f32 v196, v196
    v_rcp_f32 v197, v197
    v_rcp_f32 v198, v198
    v_rcp_f32 v199, v199
    v_rcp_f32 v200, v200
    v_rcp_f32 v201, v201
    v_rcp_f32 v202, v202
    v_rcp_f32 v203, v203
    v_rcp_f32 v204, v204
    v_rcp_f32 v205, v205
    v_rcp_f32 v206, v206
    v_rcp_f32 v207, v207
    v_rcp_f32 v208, v208
    v_rcp_f32 v209, v209
    v_rcp_f32 v210, v210
    v_rcp_f32 v211, v211
    v_rcp_f32 v212, v212
    v_rcp_f32 v213, v213
    v_rcp_f32 v214, v214
    v_rcp_f32 v215, v215
    v_rcp_f32 v216, v216
    v_rcp_f32 v217, v217
    v_rcp_f32 v218, v218
    v_rcp_f32 v219, v219
    v_rcp_f32 v220, v220
    v_rcp_f32 v221, v221
    v_rcp_f32 v222, v222
    v_rcp_f32 v223, v223
    v_pk_mul_f32 v[80:81], v[80:81], v[176:177]
    v_pk_mul_f32 v[82:83], v[82:83], v[178:179]
    v_pk_mul_f32 v[84:85], v[84:85], v[180:181]
    v_pk_mul_f32 v[86:87], v[86:87], v[182:183]
    v_pk_mul_f32 v[88:89], v[88:89], v[184:185]
    v_pk_mul_f32 v[90:91], v[90:91], v[186:187]
    v_pk_mul_f32 v[92:93], v[92:93], v[188:189]
    v_pk_mul_f32 v[94:95], v[94:95], v[190:191]
    v_pk_mul_f32 v[96:97], v[96:97], v[192:193]
    v_pk_mul_f32 v[98:99], v[98:99], v[194:195]
    v_pk_mul_f32 v[100:101], v[100:101], v[196:197]
    v_pk_mul_f32 v[102:103], v[102:103], v[198:199]
    v_pk_mul_f32 v[104:105], v[104:105], v[200:201]
    v_pk_mul_f32 v[106:107], v[106:107], v[202:203]
    v_pk_mul_f32 v[108:109], v[108:109], v[204:205]
    v_pk_mul_f32 v[110:111], v[110:111], v[206:207]
    v_pk_mul_f32 v[112:113], v[112:113], v[208:209]
    v_pk_mul_f32 v[114:115], v[114:115], v[210:211]
    v_pk_mul_f32 v[116:117], v[116:117], v[212:213]
    v_pk_mul_f32 v[118:119], v[118:119], v[214:215]
    v_pk_mul_f32 v[120:121], v[120:121], v[216:217]
    v_pk_mul_f32 v[122:123], v[122:123], v[218:219]
    v_pk_mul_f32 v[124:125], v[124:125], v[220:221]
    v_pk_mul_f32 v[126:127], v[126:127], v[222:223]
    v_pk_add_f32 v[176:177], v[80:81], v[82:83]
    v_pk_mul_f32 v[184:185], v[80:81], v[80:81]
    v_pk_add_f32 v[178:179], v[92:93], v[94:95]
    v_pk_mul_f32 v[186:187], v[92:93], v[92:93]
    v_pk_add_f32 v[180:181], v[104:105], v[106:107]
    v_pk_mul_f32 v[188:189], v[104:105], v[104:105]
    v_pk_add_f32 v[182:183], v[116:117], v[118:119]
    v_pk_mul_f32 v[190:191], v[116:117], v[116:117]
    v_pk_fma_f32 v[184:185], v[82:83], v[82:83], v[184:185]
    v_pk_fma_f32 v[186:187], v[94:95], v[94:95], v[186:187]
    v_pk_fma_f32 v[188:189], v[106:107], v[106:107], v[188:189]
    v_pk_fma_f32 v[190:191], v[118:119], v[118:119], v[190:191]
    v_pk_add_f32 v[176:177], v[176:177], v[84:85]
    v_pk_fma_f32 v[184:185], v[84:85], v[84:85], v[184:185]
    v_pk_add_f32 v[178:179], v[178:179], v[96:97]
    v_pk_fma_f32 v[186:187], v[96:97], v[96:97], v[186:187]
    v_pk_add_f32 v[180:181], v[180:181], v[108:109]
    v_pk_fma_f32 v[188:189], v[108:109], v[108:109], v[188:189]
    v_pk_add_f32 v[182:183], v[182:183], v[120:121]
    v_pk_fma_f32 v[190:191], v[120:121], v[120:121], v[190:191]
    v_pk_add_f32 v[176:177], v[176:177], v[86:87]
    v_pk_fma_f32 v[184:185], v[86:87], v[86:87], v[184:185]
    v_pk_add_f32 v[178:179], v[178:179], v[98:99]
    v_pk_fma_f32 v[186:187], v[98:99], v[98:99], v[186:187]
    v_pk_add_f32 v[180:181], v[180:181], v[110:111]
    v_pk_fma_f32 v[188:189], v[110:111], v[110:111], v[188:189]
    v_pk_add_f32 v[182:183], v[182:183], v[122:123]
    v_pk_fma_f32 v[190:191], v[122:123], v[122:123], v[190:191]
    v_pk_add_f32 v[176:177], v[176:177], v[88:89]
    v_pk_fma_f32 v[184:185], v[88:89], v[88:89], v[184:185]
    v_pk_add_f32 v[178:179], v[178:179], v[100:101]
    v_pk_fma_f32 v[186:187], v[100:101], v[100:101], v[186:187]
    v_pk_add_f32 v[180:181], v[180:181], v[112:113]
    v_pk_fma_f32 v[188:189], v[112:113], v[112:113], v[188:189]
    v_pk_add_f32 v[182:183], v[182:183], v[124:125]
    v_pk_fma_f32 v[190:191], v[124:125], v[124:125], v[190:191]
    v_pk_add_f32 v[176:177], v[176:177], v[90:91]
    v_pk_fma_f32 v[184:185], v[90:91], v[90:91], v[184:185]
    v_pk_add_f32 v[178:179], v[178:179], v[102:103]
    v_pk_fma_f32 v[186:187], v[102:103], v[102:103], v[186:187]
    v_pk_add_f32 v[180:181], v[180:181], v[114:115]
    v_pk_fma_f32 v[188:189], v[114:115], v[114:115], v[188:189]
    v_pk_add_f32 v[182:183], v[182:183], v[126:127]
    v_pk_fma_f32 v[190:191], v[126:127], v[126:127], v[190:191]
    v_pk_add_f32 v[176:177], v[176:177], v[178:179]
    v_pk_add_f32 v[184:185], v[184:185], v[186:187]
    v_pk_add_f32 v[180:181], v[180:181], v[182:183]
    v_pk_add_f32 v[188:189], v[188:189], v[190:191]
    v_add_f32 v192, v176, v177
    v_add_f32 v193, v184, v185
    v_add_f32 v194, v180, v181
    v_add_f32 v195, v188, v189
    v_mov_b32 v196, v192
    v_mov_b32 v197, v193
    v_mov_b32 v198, v194
    v_mov_b32 v199, v195
    v_permlane16_swap_b32 v192, v196
    v_permlane16_swap_b32 v193, v197
    v_permlane16_swap_b32 v194, v198
    v_permlane16_swap_b32 v195, v199
    v_add_f32 v192, v192, v196
    v_add_f32 v193, v193, v197
    v_add_f32 v194, v194, v198
    v_add_f32 v195, v195, v199
    v_mov_b32 v196, v192
    v_mov_b32 v197, v193
    v_mov_b32 v198, v194
    v_mov_b32 v199, v195
    v_permlane32_swap_b32 v192, v196
    v_permlane32_swap_b32 v193, v197
    v_permlane32_swap_b32 v194, v198
    v_permlane32_swap_b32 v195, v199
    v_add_f32 v192, v192, v196
    v_add_f32 v193, v193, v197
    v_add_f32 v194, v194, v198
    v_add_f32 v195, v195, v199
    v_and_b32 v14, 16, v0
    v_cmp_ne_u32 vcc, 0, v14
    s_nop 1
    v_cndmask_b32 v192, v192, v194, vcc
    v_cndmask_b32 v193, v193, v195, vcc
    s_add_u32 s8, s32, 24117248
    s_addc_u32 s9, s33, 0
    s_mov_b32 s10, 262144
    s_mov_b32 s11, 0x20000
    s_lshl_b32 s49, s49, 1
    s_add_u32 s49, s49, s21
    s_lshl_b32 s22, s49, 15
    s_lshl_b32 s23, s48, 10
    s_add_u32 s22, s22, s23
    s_lshl_b32 s23, s20, 9
    s_add_u32 s22, s22, s23
    s_add_u32 s24, s98, 1
    v_mov_b32 v194, s24
    v_mov_b32 v195, s99
    v_lshlrev_b32 v14, 4, v0
    v_cmp_gt_u32 vcc, 32, v0
    s_nop 0
    s_and_saveexec_b64 s[24:25], vcc
    buffer_store_dwordx4 v[192:195], v14, s[8:11], s22 offen sc1
    s_mov_b64 exec, s[24:25]
    s_barrier
    ds_read_b128 v[176:179], v2 offset:8192
    ds_read_b128 v[180:183], v2 offset:10240
    v_mfma_f32_16x16x32_bf16 v[128:131], v[24:27], v[16:19], v[128:131]
    ds_read_b64_tr_b16 v[184:185], v6 offset:49152
    ds_read_b64_tr_b16 v[186:187], v6 offset:50688
    v_mfma_f32_16x16x32_bf16 v[132:135], v[28:31], v[16:19], v[132:135]
    ds_read_b64_tr_b16 v[188:189], v7 offset:49152
    ds_read_b64_tr_b16 v[190:191], v7 offset:50688
    v_mfma_f32_16x16x32_bf16 v[136:139], v[32:35], v[16:19], v[136:139]
    ds_read_b64_tr_b16 v[192:193], v8 offset:49152
    ds_read_b64_tr_b16 v[194:195], v8 offset:50688
    v_mfma_f32_16x16x32_bf16 v[140:143], v[36:39], v[16:19], v[140:143]
    ds_read_b64_tr_b16 v[196:197], v9 offset:49152
    ds_read_b64_tr_b16 v[198:199], v9 offset:50688
    v_mfma_f32_16x16x32_bf16 v[144:147], v[40:43], v[16:19], v[144:147]
    ds_read_b64_tr_b16 v[200:201], v10 offset:49152
    ds_read_b64_tr_b16 v[202:203], v10 offset:50688
    v_mfma_f32_16x16x32_bf16 v[148:151], v[44:47], v[16:19], v[148:151]
    ds_read_b64_tr_b16 v[204:205], v11 offset:49152
    ds_read_b64_tr_b16 v[206:207], v11 offset:50688
    v_mfma_f32_16x16x32_bf16 v[152:155], v[24:27], v[20:23], v[152:155]
    ds_read_b128 v[208:211], v3 offset:8192
    ds_read_b128 v[212:215], v3 offset:10240
    v_mfma_f32_16x16x32_bf16 v[156:159], v[28:31], v[20:23], v[156:159]
    ds_read_b64_tr_b16 v[216:217], v6 offset:61440
    ds_read_b64_tr_b16 v[218:219], v6 offset:62976
    v_mfma_f32_16x16x32_bf16 v[160:163], v[32:35], v[20:23], v[160:163]
    ds_read_b64_tr_b16 v[220:221], v7 offset:61440
    ds_read_b64_tr_b16 v[222:223], v7 offset:62976
    v_mfma_f32_16x16x32_bf16 v[164:167], v[36:39], v[20:23], v[164:167]
    ds_read_b64_tr_b16 v[224:225], v8 offset:61440
    v_mfma_f32_16x16x32_bf16 v[168:171], v[40:43], v[20:23], v[168:171]
    ds_read_b64_tr_b16 v[226:227], v8 offset:62976
    v_mfma_f32_16x16x32_bf16 v[172:175], v[44:47], v[20:23], v[172:175]
    ds_read_b64_tr_b16 v[228:229], v9 offset:61440
    v_mfma_f32_16x16x32_bf16 v[128:131], v[56:59], v[48:51], v[128:131]
    ds_read_b64_tr_b16 v[230:231], v9 offset:62976
    v_mfma_f32_16x16x32_bf16 v[132:135], v[60:63], v[48:51], v[132:135]
    ds_read_b64_tr_b16 v[232:233], v10 offset:61440
    v_mfma_f32_16x16x32_bf16 v[136:139], v[64:67], v[48:51], v[136:139]
    ds_read_b64_tr_b16 v[234:235], v10 offset:62976
    v_mfma_f32_16x16x32_bf16 v[140:143], v[68:71], v[48:51], v[140:143]
    ds_read_b64_tr_b16 v[236:237], v11 offset:61440
    v_mfma_f32_16x16x32_bf16 v[144:147], v[72:75], v[48:51], v[144:147]
    ds_read_b64_tr_b16 v[238:239], v11 offset:62976
    v_mfma_f32_16x16x32_bf16 v[148:151], v[76:79], v[48:51], v[148:151]
    v_mfma_f32_16x16x32_bf16 v[152:155], v[56:59], v[52:55], v[152:155]
    v_mfma_f32_16x16x32_bf16 v[156:159], v[60:63], v[52:55], v[156:159]
    v_mfma_f32_16x16x32_bf16 v[160:163], v[64:67], v[52:55], v[160:163]
    v_mfma_f32_16x16x32_bf16 v[164:167], v[68:71], v[52:55], v[164:167]
    v_mfma_f32_16x16x32_bf16 v[168:171], v[72:75], v[52:55], v[168:171]
    v_mfma_f32_16x16x32_bf16 v[172:175], v[76:79], v[52:55], v[172:175]
    s_waitcnt lgkmcnt(0)
    s_lshl_b32 s27, s48, 10
    s_lshl_b32 s23, s20, 9
    s_add_u32 s27, s27, s23
    v_and_b32 v15, 31, v0
    v_lshlrev_b32 v15, 4, v15
    v_lshrrev_b32 v14, 5, v0
    v_lshl_add_u32 v15, v14, 17, v15
    s_add_u32 s23, s27, 0
    buffer_load_dwordx4 v[240:243], v15, s[8:11], s23 offen sc1
    s_add_u32 s23, s27, 32768
    buffer_load_dwordx4 v[244:247], v15, s[8:11], s23 offen sc1
    s_add_u32 s23, s27, 65536
    buffer_load_dwordx4 v[248:251], v15, s[8:11], s23 offen sc1
    s_add_u32 s23, s27, 98304
    buffer_load_dwordx4 v[252:255], v15, s[8:11], s23 offen sc1
    s_barrier
    ds_read_b128 v[16:19], v2 offset:16384
    ds_read_b128 v[20:23], v2 offset:18432
    v_mfma_f32_16x16x32_bf16 v[128:131], v[184:187], v[176:179], v[128:131]
    ds_read_b64_tr_b16 v[24:25], v6 offset:0
    ds_read_b64_tr_b16 v[26:27], v6 offset:1536
    v_mfma_f32_16x16x32_bf16 v[132:135], v[188:191], v[176:179], v[132:135]
    ds_read_b64_tr_b16 v[28:29], v7 offset:0
    ds_read_b64_tr_b16 v[30:31], v7 offset:1536
    v_mfma_f32_16x16x32_bf16 v[136:139], v[192:195], v[176:179], v[136:139]
    ds_read_b64_tr_b16 v[32:33], v8 offset:0
    ds_read_b64_tr_b16 v[34:35], v8 offset:1536
    v_mfma_f32_16x16x32_bf16 v[140:143], v[196:199], v[176:179], v[140:143]
    ds_read_b64_tr_b16 v[36:37], v9 offset:0
    ds_read_b64_tr_b16 v[38:39], v9 offset:1536
    v_mfma_f32_16x16x32_bf16 v[144:147], v[200:203], v[176:179], v[144:147]
    ds_read_b64_tr_b16 v[40:41], v10 offset:0
    ds_read_b64_tr_b16 v[42:43], v10 offset:1536
    v_mfma_f32_16x16x32_bf16 v[148:151], v[204:207], v[176:179], v[148:151]
    ds_read_b64_tr_b16 v[44:45], v11 offset:0
    ds_read_b64_tr_b16 v[46:47], v11 offset:1536
    v_mfma_f32_16x16x32_bf16 v[152:155], v[184:187], v[180:183], v[152:155]
    ds_read_b128 v[48:51], v3 offset:16384
    ds_read_b128 v[52:55], v3 offset:18432
    v_mfma_f32_16x16x32_bf16 v[156:159], v[188:191], v[180:183], v[156:159]
    ds_read_b64_tr_b16 v[56:57], v6 offset:12288
    ds_read_b64_tr_b16 v[58:59], v6 offset:13824
    v_mfma_f32_16x16x32_bf16 v[160:163], v[192:195], v[180:183], v[160:163]
    ds_read_b64_tr_b16 v[60:61], v7 offset:12288
    ds_read_b64_tr_b16 v[62:63], v7 offset:13824
    v_mfma_f32_16x16x32_bf16 v[164:167], v[196:199], v[180:183], v[164:167]
    ds_read_b64_tr_b16 v[64:65], v8 offset:12288
    v_mfma_f32_16x16x32_bf16 v[168:171], v[200:203], v[180:183], v[168:171]
    ds_read_b64_tr_b16 v[66:67], v8 offset:13824
    v_mfma_f32_16x16x32_bf16 v[172:175], v[204:207], v[180:183], v[172:175]
    ds_read_b64_tr_b16 v[68:69], v9 offset:12288
    v_mfma_f32_16x16x32_bf16 v[128:131], v[216:219], v[208:211], v[128:131]
    ds_read_b64_tr_b16 v[70:71], v9 offset:13824
    v_mfma_f32_16x16x32_bf16 v[132:135], v[220:223], v[208:211], v[132:135]
    ds_read_b64_tr_b16 v[72:73], v10 offset:12288
    v_mfma_f32_16x16x32_bf16 v[136:139], v[224:227], v[208:211], v[136:139]
    ds_read_b64_tr_b16 v[74:75], v10 offset:13824
    v_mfma_f32_16x16x32_bf16 v[140:143], v[228:231], v[208:211], v[140:143]
    ds_read_b64_tr_b16 v[76:77], v11 offset:12288
    v_mfma_f32_16x16x32_bf16 v[144:147], v[232:235], v[208:211], v[144:147]
    ds_read_b64_tr_b16 v[78:79], v11 offset:13824
    v_mfma_f32_16x16x32_bf16 v[148:151], v[236:239], v[208:211], v[148:151]
    v_mfma_f32_16x16x32_bf16 v[152:155], v[216:219], v[212:215], v[152:155]
    v_mfma_f32_16x16x32_bf16 v[156:159], v[220:223], v[212:215], v[156:159]
    v_mfma_f32_16x16x32_bf16 v[160:163], v[224:227], v[212:215], v[160:163]
    v_mfma_f32_16x16x32_bf16 v[164:167], v[228:231], v[212:215], v[164:167]
    v_mfma_f32_16x16x32_bf16 v[168:171], v[232:235], v[212:215], v[168:171]
    v_mfma_f32_16x16x32_bf16 v[172:175], v[236:239], v[212:215], v[172:175]
    s_waitcnt lgkmcnt(0)
    s_add_u32 s24, s98, 1
    v_mov_b32 v12, s24
    v_mov_b32 v14, s99
    s_mov_b32 s24, 0
    s_branch K1_pollchk
K1_poll:
    s_sleep 8
    s_add_u32 s23, s27, 0
    buffer_load_dwordx4 v[240:243], v15, s[8:11], s23 offen sc1
    s_add_u32 s23, s27, 32768
    buffer_load_dwordx4 v[244:247], v15, s[8:11], s23 offen sc1
    s_add_u32 s23, s27, 65536
    buffer_load_dwordx4 v[248:251], v15, s[8:11], s23 offen sc1
    s_add_u32 s23, s27, 98304
    buffer_load_dwordx4 v[252:255], v15, s[8:11], s23 offen sc1
K1_pollchk:
    s_waitcnt vmcnt(0)
    v_xor_b32 v208, v242, v12
    v_xor_b32 v209, v243, v14
    v_or_b32 v208, v208, v209
    v_xor_b32 v209, v246, v12
    v_xor_b32 v210, v247, v14
    v_or3_b32 v208, v208, v209, v210
    v_xor_b32 v209, v250, v12
    v_xor_b32 v210, v251, v14
    v_or3_b32 v208, v208, v209, v210
    v_xor_b32 v209, v254, v12
    v_xor_b32 v210, v255, v14
    v_or3_b32 v208, v208, v209, v210
    v_cmp_ne_u32 vcc, 0, v208
    s_add_u32 s24, s24, 1
    s_nop 3
    s_cbranch_vccz K1_polled
    s_cmp_lt_u32 s24, 0x10000
    s_cbranch_scc1 K1_poll
K1_polled:
    v_add_f32 v176, v240, v244
    v_add_f32 v177, v241, v245
    v_add_f32 v178, v248, v252
    v_add_f32 v179, v249, v253
    v_add_f32 v176, v176, v178
    v_add_f32 v177, v177, v179
    v_mov_b32 v178, v176
    v_mov_b32 v179, v177
    s_nop 0
    v_permlane32_swap_b32 v176, v178
    v_permlane32_swap_b32 v177, v179
    v_add_f32 v176, v176, v178
    v_add_f32 v177, v177, v179
    v_mul_f32 v176, 984263339, v176
    v_mul_f32 v177, 984263339, v177
    v_fma_f32 v177, -v176, v176, v177
    v_max_f32 v177, 0, v177
    v_add_f32 v177, 925353388, v177
    v_rsq_f32 v177, v177
    s_nop 0
    v_mul_f32 v176, v176, v177
    v_sub_f32 v176, 0, v176
    v_and_b32 v13, 15, v0
    v_lshlrev_b32 v13, 2, v13
    v_add_u32 v12, 0, v13
    ds_bpermute_b32 v184, v12, v177
    ds_bpermute_b32 v185, v12, v176
    v_add_u32 v12, 64, v13
    ds_bpermute_b32 v186, v12, v177
    ds_bpermute_b32 v187, v12, v176
    s_add_u32 s12, s32, 12582912
    s_addc_u32 s13, s33, 0
    s_mov_b32 s14, 3145728
    s_mov_b32 s15, 0x20000
    s_lshl_b32 s22, s49, 5
    s_add_u32 s22, s22, s48
    s_mul_i32 s22, s22, 12288
    s_lshl_b32 s23, s20, 10
    s_add_u32 s22, s22, s23
    v_lshrrev_b32 v15, 4, v0
    v_and_b32 v12, 15, v0
    v_and_b32 v13, 3, v12
    v_and_b32 v14, 4, v12
    v_lshl_or_b32 v13, v14, 1, v13
    v_and_b32 v14, 8, v12
    v_lshrrev_b32 v14, 1, v14
    v_or_b32 v13, v13, v14
    v_and_b32 v14, 1, v15
    v_lshl_add_u32 v13, v14, 4, v13
    v_lshlrev_b32 v13, 5, v13
    v_lshrrev_b32 v14, 1, v15
    v_lshl_add_u32 v13, v14, 4, v13
    s_waitcnt lgkmcnt(0)
    v_fma_f32 v80, v80, v184, v185
    v_fma_f32 v81, v81, v184, v185
    v_fma_f32 v82, v82, v184, v185
    v_fma_f32 v83, v83, v184, v185
    v_fma_f32 v84, v84, v184, v185
    v_fma_f32 v85, v85, v184, v185
    v_fma_f32 v86, v86, v184, v185
    v_fma_f32 v87, v87, v184, v185
    v_fma_f32 v88, v88, v184, v185
    v_fma_f32 v89, v89, v184, v185
    v_fma_f32 v90, v90, v184, v185
    v_fma_f32 v91, v91, v184, v185
    v_fma_f32 v92, v92, v184, v185
    v_fma_f32 v93, v93, v184, v185
    v_fma_f32 v94, v94, v184, v185
    v_fma_f32 v95, v95, v184, v185
    v_fma_f32 v96, v96, v184, v185
    v_fma_f32 v97, v97, v184, v185
    v_fma_f32 v98, v98, v184, v185
    v_fma_f32 v99, v99, v184, v185
    v_fma_f32 v100, v100, v184, v185
    v_fma_f32 v101, v101, v184, v185
    v_fma_f32 v102, v102, v184, v185
    v_fma_f32 v103, v103, v184, v185
    v_fma_f32 v104, v104, v186, v187
    v_fma_f32 v105, v105, v186, v187
    v_fma_f32 v106, v106, v186, v187
    v_fma_f32 v107, v107, v186, v187
    v_fma_f32 v108, v108, v186, v187
    v_fma_f32 v109, v109, v186, v187
    v_fma_f32 v110, v110, v186, v187
    v_fma_f32 v111, v111, v186, v187
    v_fma_f32 v112, v112, v186, v187
    v_fma_f32 v113, v113, v186, v187
    v_fma_f32 v114, v114, v186, v187
    v_fma_f32 v115, v115, v186, v187
    v_fma_f32 v116, v116, v186, v187
    v_fma_f32 v117, v117, v186, v187
    v_fma_f32 v118, v118, v186, v187
    v_fma_f32 v119, v119, v186, v187
    v_fma_f32 v120, v120, v186, v187
    v_fma_f32 v121, v121, v186, v187
    v_fma_f32 v122, v122, v186, v187
    v_fma_f32 v123, v123, v186, v187
    v_fma_f32 v124, v124, v186, v187
    v_fma_f32 v125, v125, v186, v187
    v_fma_f32 v126, v126, v186, v187
    v_fma_f32 v127, v127, v186, v187
    v_cvt_pk_bf16_f32 v192, v80, v81
    v_cvt_pk_bf16_f32 v193, v82, v83
    v_cvt_pk_bf16_f32 v194, v104, v105
    v_cvt_pk_bf16_f32 v195, v106, v107
    v_cvt_pk_bf16_f32 v196, v84, v85
    v_cvt_pk_bf16_f32 v197, v86, v87
    v_cvt_pk_bf16_f32 v198, v108, v109
    v_cvt_pk_bf16_f32 v199, v110, v111
    v_cvt_pk_bf16_f32 v200, v88, v89
    v_cvt_pk_bf16_f32 v201, v90, v91
    v_cvt_pk_bf16_f32 v202, v112, v113
    v_cvt_pk_bf16_f32 v203, v114, v115
    v_cvt_pk_bf16_f32 v204, v92, v93
    v_cvt_pk_bf16_f32 v205, v94, v95
    v_cvt_pk_bf16_f32 v206, v116, v117
    v_cvt_pk_bf16_f32 v207, v118, v119
    v_cvt_pk_bf16_f32 v208, v96, v97
    v_cvt_pk_bf16_f32 v209, v98, v99
    v_cvt_pk_bf16_f32 v210, v120, v121
    v_cvt_pk_bf16_f32 v211, v122, v123
    v_cvt_pk_bf16_f32 v212, v100, v101
    v_cvt_pk_bf16_f32 v213, v102, v103
    v_cvt_pk_bf16_f32 v214, v124, v125
    v_cvt_pk_bf16_f32 v215, v126, v127
    v_permlane16_swap_b32 v192, v194
    v_permlane16_swap_b32 v193, v195
    v_permlane16_swap_b32 v196, v198
    v_permlane16_swap_b32 v197, v199
    v_permlane16_swap_b32 v200, v202
    v_permlane16_swap_b32 v201, v203
    v_permlane16_swap_b32 v204, v206
    v_permlane16_swap_b32 v205, v207
    v_permlane16_swap_b32 v208, v210
    v_permlane16_swap_b32 v209, v211
    v_permlane16_swap_b32 v212, v214
    v_permlane16_swap_b32 v213, v215
    s_add_u32 s23, s22, 0
    buffer_store_dwordx4 v[192:195], v13, s[12:15], s23 offen sc1
    s_add_u32 s23, s22, 2048
    buffer_store_dwordx4 v[196:199], v13, s[12:15], s23 offen sc1
    s_add_u32 s23, s22, 4096
    buffer_store_dwordx4 v[200:203], v13, s[12:15], s23 offen sc1
    s_add_u32 s23, s22, 6144
    buffer_store_dwordx4 v[204:207], v13, s[12:15], s23 offen sc1
    s_add_u32 s23, s22, 8192
    buffer_store_dwordx4 v[208:211], v13, s[12:15], s23 offen sc1
    s_add_u32 s23, s22, 10240
    buffer_store_dwordx4 v[212:215], v13, s[12:15], s23 offen sc1
    s_barrier
    ds_read_b128 v[176:179], v2 offset:24576
    ds_read_b128 v[180:183], v2 offset:26624
    v_mfma_f32_16x16x32_bf16 v[128:131], v[24:27], v[16:19], v[128:131]
    ds_read_b64_tr_b16 v[184:185], v6 offset:24576
    ds_read_b64_tr_b16 v[186:187], v6 offset:26112
    v_mfma_f32_16x16x32_bf16 v[132:135], v[28:31], v[16:19], v[132:135]
    ds_read_b64_tr_b16 v[188:189], v7 offset:24576
    ds_read_b64_tr_b16 v[190:191], v7 offset:26112
    v_mfma_f32_16x16x32_bf16 v[136:139], v[32:35], v[16:19], v[136:139]
    ds_read_b64_tr_b16 v[192:193], v8 offset:24576
    ds_read_b64_tr_b16 v[194:195], v8 offset:26112
    v_mfma_f32_16x16x32_bf16 v[140:143], v[36:39], v[16:19], v[140:143]
    ds_read_b64_tr_b16 v[196:197], v9 offset:24576
    ds_read_b64_tr_b16 v[198:199], v9 offset:26112
    v_mfma_f32_16x16x32_bf16 v[144:147], v[40:43], v[16:19], v[144:147]
    ds_read_b64_tr_b16 v[200:201], v10 offset:24576
    ds_read_b64_tr_b16 v[202:203], v10 offset:26112
    v_mfma_f32_16x16x32_bf16 v[148:151], v[44:47], v[16:19], v[148:151]
    ds_read_b64_tr_b16 v[204:205], v11 offset:24576
    ds_read_b64_tr_b16 v[206:207], v11 offset:26112
    v_mfma_f32_16x16x32_bf16 v[152:155], v[24:27], v[20:23], v[152:155]
    ds_read_b128 v[208:211], v3 offset:24576
    ds_read_b128 v[212:215], v3 offset:26624
    v_mfma_f32_16x16x32_bf16 v[156:159], v[28:31], v[20:23], v[156:159]
    ds_read_b64_tr_b16 v[216:217], v6 offset:36864
    ds_read_b64_tr_b16 v[218:219], v6 offset:38400
    v_mfma_f32_16x16x32_bf16 v[160:163], v[32:35], v[20:23], v[160:163]
    ds_read_b64_tr_b16 v[220:221], v7 offset:36864
    ds_read_b64_tr_b16 v[222:223], v7 offset:38400
    v_mfma_f32_16x16x32_bf16 v[164:167], v[36:39], v[20:23], v[164:167]
    ds_read_b64_tr_b16 v[224:225], v8 offset:36864
    v_mfma_f32_16x16x32_bf16 v[168:171], v[40:43], v[20:23], v[168:171]
    ds_read_b64_tr_b16 v[226:227], v8 offset:38400
    v_mfma_f32_16x16x32_bf16 v[172:175], v[44:47], v[20:23], v[172:175]
    ds_read_b64_tr_b16 v[228:229], v9 offset:36864
    v_mfma_f32_16x16x32_bf16 v[128:131], v[56:59], v[48:51], v[128:131]
    ds_read_b64_tr_b16 v[230:231], v9 offset:38400
    v_mfma_f32_16x16x32_bf16 v[132:135], v[60:63], v[48:51], v[132:135]
    ds_read_b64_tr_b16 v[232:233], v10 offset:36864
    v_mfma_f32_16x16x32_bf16 v[136:139], v[64:67], v[48:51], v[136:139]
    ds_read_b64_tr_b16 v[234:235], v10 offset:38400
    v_mfma_f32_16x16x32_bf16 v[140:143], v[68:71], v[48:51], v[140:143]
    ds_read_b64_tr_b16 v[236:237], v11 offset:36864
    v_mfma_f32_16x16x32_bf16 v[144:147], v[72:75], v[48:51], v[144:147]
    ds_read_b64_tr_b16 v[238:239], v11 offset:38400
    v_mfma_f32_16x16x32_bf16 v[148:151], v[76:79], v[48:51], v[148:151]
    v_mfma_f32_16x16x32_bf16 v[152:155], v[56:59], v[52:55], v[152:155]
    v_mfma_f32_16x16x32_bf16 v[156:159], v[60:63], v[52:55], v[156:159]
    v_mfma_f32_16x16x32_bf16 v[160:163], v[64:67], v[52:55], v[160:163]
    v_mfma_f32_16x16x32_bf16 v[164:167], v[68:71], v[52:55], v[164:167]
    v_mfma_f32_16x16x32_bf16 v[168:171], v[72:75], v[52:55], v[168:171]
    v_mfma_f32_16x16x32_bf16 v[172:175], v[76:79], v[52:55], v[172:175]
    s_waitcnt lgkmcnt(0)
    s_barrier
    ds_read_b128 v[16:19], v2 offset:32768
    ds_read_b128 v[20:23], v2 offset:34816
    v_mfma_f32_16x16x32_bf16 v[128:131], v[184:187], v[176:179], v[128:131]
    ds_read_b64_tr_b16 v[24:25], v6 offset:49152
    ds_read_b64_tr_b16 v[26:27], v6 offset:50688
    v_mfma_f32_16x16x32_bf16 v[132:135], v[188:191], v[176:179], v[132:135]
    ds_read_b64_tr_b16 v[28:29], v7 offset:49152
    ds_read_b64_tr_b16 v[30:31], v7 offset:50688
    v_mfma_f32_16x16x32_bf16 v[136:139], v[192:195], v[176:179], v[136:139]
    ds_read_b64_tr_b16 v[32:33], v8 offset:49152
    ds_read_b64_tr_b16 v[34:35], v8 offset:50688
    v_mfma_f32_16x16x32_bf16 v[140:143], v[196:199], v[176:179], v[140:143]
    ds_read_b64_tr_b16 v[36:37], v9 offset:49152
    ds_read_b64_tr_b16 v[38:39], v9 offset:50688
    v_mfma_f32_16x16x32_bf16 v[144:147], v[200:203], v[176:179], v[144:147]
    ds_read_b64_tr_b16 v[40:41], v10 offset:49152
    ds_read_b64_tr_b16 v[42:43], v10 offset:50688
    v_mfma_f32_16x16x32_bf16 v[148:151], v[204:207], v[176:179], v[148:151]
    ds_read_b64_tr_b16 v[44:45], v11 offset:49152
    ds_read_b64_tr_b16 v[46:47], v11 offset:50688
    v_mfma_f32_16x16x32_bf16 v[152:155], v[184:187], v[180:183], v[152:155]
    ds_read_b128 v[48:51], v3 offset:32768
    ds_read_b128 v[52:55], v3 offset:34816
    v_mfma_f32_16x16x32_bf16 v[156:159], v[188:191], v[180:183], v[156:159]
    ds_read_b64_tr_b16 v[56:57], v6 offset:61440
    ds_read_b64_tr_b16 v[58:59], v6 offset:62976
    v_mfma_f32_16x16x32_bf16 v[160:163], v[192:195], v[180:183], v[160:163]
    ds_read_b64_tr_b16 v[60:61], v7 offset:61440
    ds_read_b64_tr_b16 v[62:63], v7 offset:62976
    v_mfma_f32_16x16x32_bf16 v[164:167], v[196:199], v[180:183], v[164:167]
    ds_read_b64_tr_b16 v[64:65], v8 offset:61440
    v_mfma_f32_16x16x32_bf16 v[168:171], v[200:203], v[180:183], v[168:171]
    ds_read_b64_tr_b16 v[66:67], v8 offset:62976
    v_mfma_f32_16x16x32_bf16 v[172:175], v[204:207], v[180:183], v[172:175]
    ds_read_b64_tr_b16 v[68:69], v9 offset:61440
    v_mfma_f32_16x16x32_bf16 v[128:131], v[216:219], v[208:211], v[128:131]
    ds_read_b64_tr_b16 v[70:71], v9 offset:62976
    v_mfma_f32_16x16x32_bf16 v[132:135], v[220:223], v[208:211], v[132:135]
    ds_read_b64_tr_b16 v[72:73], v10 offset:61440
    v_mfma_f32_16x16x32_bf16 v[136:139], v[224:227], v[208:211], v[136:139]
    ds_read_b64_tr_b16 v[74:75], v10 offset:62976
    v_mfma_f32_16x16x32_bf16 v[140:143], v[228:231], v[208:211], v[140:143]
    ds_read_b64_tr_b16 v[76:77], v11 offset:61440
    v_mfma_f32_16x16x32_bf16 v[144:147], v[232:235], v[208:211], v[144:147]
    ds_read_b64_tr_b16 v[78:79], v11 offset:62976
    v_mfma_f32_16x16x32_bf16 v[148:151], v[236:239], v[208:211], v[148:151]
    v_mfma_f32_16x16x32_bf16 v[152:155], v[216:219], v[212:215], v[152:155]
    v_mfma_f32_16x16x32_bf16 v[156:159], v[220:223], v[212:215], v[156:159]
    v_mfma_f32_16x16x32_bf16 v[160:163], v[224:227], v[212:215], v[160:163]
    v_mfma_f32_16x16x32_bf16 v[164:167], v[228:231], v[212:215], v[164:167]
    v_mfma_f32_16x16x32_bf16 v[168:171], v[232:235], v[212:215], v[168:171]
    v_mfma_f32_16x16x32_bf16 v[172:175], v[236:239], v[212:215], v[172:175]
    s_waitcnt lgkmcnt(0)
    s_barrier
    ds_read_b128 v[176:179], v2 offset:40960
    ds_read_b128 v[180:183], v2 offset:43008
    v_mfma_f32_16x16x32_bf16 v[128:131], v[24:27], v[16:19], v[128:131]
    ds_read_b64_tr_b16 v[184:185], v6 offset:0
    ds_read_b64_tr_b16 v[186:187], v6 offset:1536
    v_mfma_f32_16x16x32_bf16 v[132:135], v[28:31], v[16:19], v[132:135]
    ds_read_b64_tr_b16 v[188:189], v7 offset:0
    ds_read_b64_tr_b16 v[190:191], v7 offset:1536
    v_mfma_f32_16x16x32_bf16 v[136:139], v[32:35], v[16:19], v[136:139]
    ds_read_b64_tr_b16 v[192:193], v8 offset:0
    ds_read_b64_tr_b16 v[194:195], v8 offset:1536
    v_mfma_f32_16x16x32_bf16 v[140:143], v[36:39], v[16:19], v[140:143]
    ds_read_b64_tr_b16 v[196:197], v9 offset:0
    ds_read_b64_tr_b16 v[198:199], v9 offset:1536
    v_mfma_f32_16x16x32_bf16 v[144:147], v[40:43], v[16:19], v[144:147]
    ds_read_b64_tr_b16 v[200:201], v10 offset:0
    ds_read_b64_tr_b16 v[202:203], v10 offset:1536
    v_mfma_f32_16x16x32_bf16 v[148:151], v[44:47], v[16:19], v[148:151]
    ds_read_b64_tr_b16 v[204:205], v11 offset:0
    ds_read_b64_tr_b16 v[206:207], v11 offset:1536
    v_mfma_f32_16x16x32_bf16 v[152:155], v[24:27], v[20:23], v[152:155]
    ds_read_b128 v[208:211], v3 offset:40960
    ds_read_b128 v[212:215], v3 offset:43008
    v_mfma_f32_16x16x32_bf16 v[156:159], v[28:31], v[20:23], v[156:159]
    ds_read_b64_tr_b16 v[216:217], v6 offset:12288
    ds_read_b64_tr_b16 v[218:219], v6 offset:13824
    v_mfma_f32_16x16x32_bf16 v[160:163], v[32:35], v[20:23], v[160:163]
    ds_read_b64_tr_b16 v[220:221], v7 offset:12288
    ds_read_b64_tr_b16 v[222:223], v7 offset:13824
    v_mfma_f32_16x16x32_bf16 v[164:167], v[36:39], v[20:23], v[164:167]
    ds_read_b64_tr_b16 v[224:225], v8 offset:12288
    v_mfma_f32_16x16x32_bf16 v[168:171], v[40:43], v[20:23], v[168:171]
    ds_read_b64_tr_b16 v[226:227], v8 offset:13824
    v_mfma_f32_16x16x32_bf16 v[172:175], v[44:47], v[20:23], v[172:175]
    ds_read_b64_tr_b16 v[228:229], v9 offset:12288
    v_mfma_f32_16x16x32_bf16 v[128:131], v[56:59], v[48:51], v[128:131]
    ds_read_b64_tr_b16 v[230:231], v9 offset:13824
    v_mfma_f32_16x16x32_bf16 v[132:135], v[60:63], v[48:51], v[132:135]
    ds_read_b64_tr_b16 v[232:233], v10 offset:12288
    v_mfma_f32_16x16x32_bf16 v[136:139], v[64:67], v[48:51], v[136:139]
    ds_read_b64_tr_b16 v[234:235], v10 offset:13824
    v_mfma_f32_16x16x32_bf16 v[140:143], v[68:71], v[48:51], v[140:143]
    ds_read_b64_tr_b16 v[236:237], v11 offset:12288
    v_mfma_f32_16x16x32_bf16 v[144:147], v[72:75], v[48:51], v[144:147]
    ds_read_b64_tr_b16 v[238:239], v11 offset:13824
    v_mfma_f32_16x16x32_bf16 v[148:151], v[76:79], v[48:51], v[148:151]
    v_mfma_f32_16x16x32_bf16 v[152:155], v[56:59], v[52:55], v[152:155]
    v_mfma_f32_16x16x32_bf16 v[156:159], v[60:63], v[52:55], v[156:159]
    v_mfma_f32_16x16x32_bf16 v[160:163], v[64:67], v[52:55], v[160:163]
    v_mfma_f32_16x16x32_bf16 v[164:167], v[68:71], v[52:55], v[164:167]
    v_mfma_f32_16x16x32_bf16 v[168:171], v[72:75], v[52:55], v[168:171]
    v_mfma_f32_16x16x32_bf16 v[172:175], v[76:79], v[52:55], v[172:175]
    s_waitcnt lgkmcnt(0)
    s_barrier
    ds_read_b128 v[16:19], v2 offset:49152
    ds_read_b128 v[20:23], v2 offset:51200
    v_mfma_f32_16x16x32_bf16 v[128:131], v[184:187], v[176:179], v[128:131]
    ds_read_b64_tr_b16 v[24:25], v6 offset:24576
    ds_read_b64_tr_b16 v[26:27], v6 offset:26112
    v_mfma_f32_16x16x32_bf16 v[132:135], v[188:191], v[176:179], v[132:135]
    ds_read_b64_tr_b16 v[28:29], v7 offset:24576
    ds_read_b64_tr_b16 v[30:31], v7 offset:26112
    v_mfma_f32_16x16x32_bf16 v[136:139], v[192:195], v[176:179], v[136:139]
    ds_read_b64_tr_b16 v[32:33], v8 offset:24576
    ds_read_b64_tr_b16 v[34:35], v8 offset:26112
    v_mfma_f32_16x16x32_bf16 v[140:143], v[196:199], v[176:179], v[140:143]
    ds_read_b64_tr_b16 v[36:37], v9 offset:24576
    ds_read_b64_tr_b16 v[38:39], v9 offset:26112
    v_mfma_f32_16x16x32_bf16 v[144:147], v[200:203], v[176:179], v[144:147]
    ds_read_b64_tr_b16 v[40:41], v10 offset:24576
    ds_read_b64_tr_b16 v[42:43], v10 offset:26112
    v_mfma_f32_16x16x32_bf16 v[148:151], v[204:207], v[176:179], v[148:151]
    ds_read_b64_tr_b16 v[44:45], v11 offset:24576
    ds_read_b64_tr_b16 v[46:47], v11 offset:26112
    v_mfma_f32_16x16x32_bf16 v[152:155], v[184:187], v[180:183], v[152:155]
    ds_read_b128 v[48:51], v3 offset:49152
    ds_read_b128 v[52:55], v3 offset:51200
    v_mfma_f32_16x16x32_bf16 v[156:159], v[188:191], v[180:183], v[156:159]
    ds_read_b64_tr_b16 v[56:57], v6 offset:36864
    ds_read_b64_tr_b16 v[58:59], v6 offset:38400
    v_mfma_f32_16x16x32_bf16 v[160:163], v[192:195], v[180:183], v[160:163]
    ds_read_b64_tr_b16 v[60:61], v7 offset:36864
    ds_read_b64_tr_b16 v[62:63], v7 offset:38400
    v_mfma_f32_16x16x32_bf16 v[164:167], v[196:199], v[180:183], v[164:167]
    ds_read_b64_tr_b16 v[64:65], v8 offset:36864
    v_mfma_f32_16x16x32_bf16 v[168:171], v[200:203], v[180:183], v[168:171]
    ds_read_b64_tr_b16 v[66:67], v8 offset:38400
    v_mfma_f32_16x16x32_bf16 v[172:175], v[204:207], v[180:183], v[172:175]
    ds_read_b64_tr_b16 v[68:69], v9 offset:36864
    v_mfma_f32_16x16x32_bf16 v[128:131], v[216:219], v[208:211], v[128:131]
    ds_read_b64_tr_b16 v[70:71], v9 offset:38400
    v_mfma_f32_16x16x32_bf16 v[132:135], v[220:223], v[208:211], v[132:135]
    ds_read_b64_tr_b16 v[72:73], v10 offset:36864
    v_mfma_f32_16x16x32_bf16 v[136:139], v[224:227], v[208:211], v[136:139]
    ds_read_b64_tr_b16 v[74:75], v10 offset:38400
    v_mfma_f32_16x16x32_bf16 v[140:143], v[228:231], v[208:211], v[140:143]
    ds_read_b64_tr_b16 v[76:77], v11 offset:36864
    v_mfma_f32_16x16x32_bf16 v[144:147], v[232:235], v[208:211], v[144:147]
    ds_read_b64_tr_b16 v[78:79], v11 offset:38400
    v_mfma_f32_16x16x32_bf16 v[148:151], v[236:239], v[208:211], v[148:151]
    v_mfma_f32_16x16x32_bf16 v[152:155], v[216:219], v[212:215], v[152:155]
    v_mfma_f32_16x16x32_bf16 v[156:159], v[220:223], v[212:215], v[156:159]
    v_mfma_f32_16x16x32_bf16 v[160:163], v[224:227], v[212:215], v[160:163]
    v_mfma_f32_16x16x32_bf16 v[164:167], v[228:231], v[212:215], v[164:167]
    v_mfma_f32_16x16x32_bf16 v[168:171], v[232:235], v[212:215], v[168:171]
    v_mfma_f32_16x16x32_bf16 v[172:175], v[236:239], v[212:215], v[172:175]
    s_waitcnt lgkmcnt(0)
    s_waitcnt vmcnt(0)
    s_lshl_b32 s22, s21, 2
    s_add_u32 s22, s22, 155664
    v_mov_b32 v12, s22
    v_mov_b32 v13, 1
    s_mov_b64 exec, 1
    ds_add_rtn_u32 v13, v12, v13
    s_waitcnt lgkmcnt(0)
    v_readfirstlane_b32 s22, v13
    s_nop 0
    s_cmp_lg_u32 s22, 1
    s_cbranch_scc1 K1_z2nosig
    s_add_u32 s12, s32, 24707072
    s_addc_u32 s13, s33, 0
    s_mov_b32 s14, 2048
    s_mov_b32 s15, 0x20000
    s_lshl_b32 s22, s49, 8
    s_lshl_b32 s23, s48, 3
    s_add_u32 s22, s22, s23
    v_mov_b32 v12, s22
    s_add_u32 s23, s98, 1
    v_mov_b32 v14, s23
    v_mov_b32 v15, s99
    buffer_store_dwordx2 v[14:15], v12, s[12:15], 0 offen sc1
K1_z2nosig:
    s_mov_b64 exec, -1
    s_barrier
    ds_read_b128 v[176:179], v2 offset:57344
    ds_read_b128 v[180:183], v2 offset:59392
    v_mfma_f32_16x16x32_bf16 v[128:131], v[24:27], v[16:19], v[128:131]
    ds_read_b64_tr_b16 v[184:185], v6 offset:49152
    ds_read_b64_tr_b16 v[186:187], v6 offset:50688
    v_mfma_f32_16x16x32_bf16 v[132:135], v[28:31], v[16:19], v[132:135]
    ds_read_b64_tr_b16 v[188:189], v7 offset:49152
    ds_read_b64_tr_b16 v[190:191], v7 offset:50688
    v_mfma_f32_16x16x32_bf16 v[136:139], v[32:35], v[16:19], v[136:139]
    ds_read_b64_tr_b16 v[192:193], v8 offset:49152
    ds_read_b64_tr_b16 v[194:195], v8 offset:50688
    v_mfma_f32_16x16x32_bf16 v[140:143], v[36:39], v[16:19], v[140:143]
    ds_read_b64_tr_b16 v[196:197], v9 offset:49152
    ds_read_b64_tr_b16 v[198:199], v9 offset:50688
    v_mfma_f32_16x16x32_bf16 v[144:147], v[40:43], v[16:19], v[144:147]
    ds_read_b64_tr_b16 v[200:201], v10 offset:49152
    ds_read_b64_tr_b16 v[202:203], v10 offset:50688
    v_mfma_f32_16x16x32_bf16 v[148:151], v[44:47], v[16:19], v[148:151]
    ds_read_b64_tr_b16 v[204:205], v11 offset:49152
    ds_read_b64_tr_b16 v[206:207], v11 offset:50688
    v_mfma_f32_16x16x32_bf16 v[152:155], v[24:27], v[20:23], v[152:155]
    ds_read_b128 v[208:211], v3 offset:57344
    ds_read_b128 v[212:215], v3 offset:59392
    v_mfma_f32_16x16x32_bf16 v[156:159], v[28:31], v[20:23], v[156:159]
    ds_read_b64_tr_b16 v[216:217], v6 offset:61440
    ds_read_b64_tr_b16 v[218:219], v6 offset:62976
    v_mfma_f32_16x16x32_bf16 v[160:163], v[32:35], v[20:23], v[160:163]
    ds_read_b64_tr_b16 v[220:221], v7 offset:61440
    ds_read_b64_tr_b16 v[222:223], v7 offset:62976
    v_mfma_f32_16x16x32_bf16 v[164:167], v[36:39], v[20:23], v[164:167]
    ds_read_b64_tr_b16 v[224:225], v8 offset:61440
    v_mfma_f32_16x16x32_bf16 v[168:171], v[40:43], v[20:23], v[168:171]
    ds_read_b64_tr_b16 v[226:227], v8 offset:62976
    v_mfma_f32_16x16x32_bf16 v[172:175], v[44:47], v[20:23], v[172:175]
    ds_read_b64_tr_b16 v[228:229], v9 offset:61440
    v_mfma_f32_16x16x32_bf16 v[128:131], v[56:59], v[48:51], v[128:131]
    ds_read_b64_tr_b16 v[230:231], v9 offset:62976
    v_mfma_f32_16x16x32_bf16 v[132:135], v[60:63], v[48:51], v[132:135]
    ds_read_b64_tr_b16 v[232:233], v10 offset:61440
    v_mfma_f32_16x16x32_bf16 v[136:139], v[64:67], v[48:51], v[136:139]
    ds_read_b64_tr_b16 v[234:235], v10 offset:62976
    v_mfma_f32_16x16x32_bf16 v[140:143], v[68:71], v[48:51], v[140:143]
    ds_read_b64_tr_b16 v[236:237], v11 offset:61440
    v_mfma_f32_16x16x32_bf16 v[144:147], v[72:75], v[48:51], v[144:147]
    ds_read_b64_tr_b16 v[238:239], v11 offset:62976
    v_mfma_f32_16x16x32_bf16 v[148:151], v[76:79], v[48:51], v[148:151]
    v_mfma_f32_16x16x32_bf16 v[152:155], v[56:59], v[52:55], v[152:155]
    v_mfma_f32_16x16x32_bf16 v[156:159], v[60:63], v[52:55], v[156:159]
    v_mfma_f32_16x16x32_bf16 v[160:163], v[64:67], v[52:55], v[160:163]
    v_mfma_f32_16x16x32_bf16 v[164:167], v[68:71], v[52:55], v[164:167]
    v_mfma_f32_16x16x32_bf16 v[168:171], v[72:75], v[52:55], v[168:171]
    v_mfma_f32_16x16x32_bf16 v[172:175], v[76:79], v[52:55], v[172:175]
    s_waitcnt lgkmcnt(0)
    s_barrier
    ds_read_b128 v[16:19], v4 offset:0
    ds_read_b128 v[20:23], v4 offset:2048
    v_mfma_f32_16x16x32_bf16 v[128:131], v[184:187], v[176:179], v[128:131]
    ds_read_b64_tr_b16 v[24:25], v6 offset:0
    ds_read_b64_tr_b16 v[26:27], v6 offset:1536
    v_mfma_f32_16x16x32_bf16 v[132:135], v[188:191], v[176:179], v[132:135]
    ds_read_b64_tr_b16 v[28:29], v7 offset:0
    ds_read_b64_tr_b16 v[30:31], v7 offset:1536
    v_mfma_f32_16x16x32_bf16 v[136:139], v[192:195], v[176:179], v[136:139]
    ds_read_b64_tr_b16 v[32:33], v8 offset:0
    ds_read_b64_tr_b16 v[34:35], v8 offset:1536
    v_mfma_f32_16x16x32_bf16 v[140:143], v[196:199], v[176:179], v[140:143]
    ds_read_b64_tr_b16 v[36:37], v9 offset:0
    ds_read_b64_tr_b16 v[38:39], v9 offset:1536
    v_mfma_f32_16x16x32_bf16 v[144:147], v[200:203], v[176:179], v[144:147]
    ds_read_b64_tr_b16 v[40:41], v10 offset:0
    ds_read_b64_tr_b16 v[42:43], v10 offset:1536
    v_mfma_f32_16x16x32_bf16 v[148:151], v[204:207], v[176:179], v[148:151]
    ds_read_b64_tr_b16 v[44:45], v11 offset:0
    ds_read_b64_tr_b16 v[46:47], v11 offset:1536
    v_mfma_f32_16x16x32_bf16 v[152:155], v[184:187], v[180:183], v[152:155]
    ds_read_b128 v[48:51], v5 offset:0
    ds_read_b128 v[52:55], v5 offset:2048
    v_mfma_f32_16x16x32_bf16 v[156:159], v[188:191], v[180:183], v[156:159]
    ds_read_b64_tr_b16 v[56:57], v6 offset:12288
    ds_read_b64_tr_b16 v[58:59], v6 offset:13824
    v_mfma_f32_16x16x32_bf16 v[160:163], v[192:195], v[180:183], v[160:163]
    ds_read_b64_tr_b16 v[60:61], v7 offset:12288
    ds_read_b64_tr_b16 v[62:63], v7 offset:13824
    v_mfma_f32_16x16x32_bf16 v[164:167], v[196:199], v[180:183], v[164:167]
    ds_read_b64_tr_b16 v[64:65], v8 offset:12288
    v_mfma_f32_16x16x32_bf16 v[168:171], v[200:203], v[180:183], v[168:171]
    ds_read_b64_tr_b16 v[66:67], v8 offset:13824
    v_mfma_f32_16x16x32_bf16 v[172:175], v[204:207], v[180:183], v[172:175]
    ds_read_b64_tr_b16 v[68:69], v9 offset:12288
    v_mfma_f32_16x16x32_bf16 v[128:131], v[216:219], v[208:211], v[128:131]
    ds_read_b64_tr_b16 v[70:71], v9 offset:13824
    v_mfma_f32_16x16x32_bf16 v[132:135], v[220:223], v[208:211], v[132:135]
    ds_read_b64_tr_b16 v[72:73], v10 offset:12288
    v_mfma_f32_16x16x32_bf16 v[136:139], v[224:227], v[208:211], v[136:139]
    ds_read_b64_tr_b16 v[74:75], v10 offset:13824
    v_mfma_f32_16x16x32_bf16 v[140:143], v[228:231], v[208:211], v[140:143]
    ds_read_b64_tr_b16 v[76:77], v11 offset:12288
    v_mfma_f32_16x16x32_bf16 v[144:147], v[232:235], v[208:211], v[144:147]
    ds_read_b64_tr_b16 v[78:79], v11 offset:13824
    v_mfma_f32_16x16x32_bf16 v[148:151], v[236:239], v[208:211], v[148:151]
    v_mfma_f32_16x16x32_bf16 v[152:155], v[216:219], v[212:215], v[152:155]
    v_mfma_f32_16x16x32_bf16 v[156:159], v[220:223], v[212:215], v[156:159]
    v_mfma_f32_16x16x32_bf16 v[160:163], v[224:227], v[212:215], v[160:163]
    v_mfma_f32_16x16x32_bf16 v[164:167], v[228:231], v[212:215], v[164:167]
    v_mfma_f32_16x16x32_bf16 v[168:171], v[232:235], v[212:215], v[168:171]
    v_mfma_f32_16x16x32_bf16 v[172:175], v[236:239], v[212:215], v[172:175]
    s_waitcnt lgkmcnt(0)
    s_barrier
    ds_read_b128 v[176:179], v4 offset:8192
    ds_read_b128 v[180:183], v4 offset:10240
    v_mfma_f32_16x16x32_bf16 v[128:131], v[24:27], v[16:19], v[128:131]
    ds_read_b64_tr_b16 v[184:185], v6 offset:24576
    ds_read_b64_tr_b16 v[186:187], v6 offset:26112
    v_mfma_f32_16x16x32_bf16 v[132:135], v[28:31], v[16:19], v[132:135]
    ds_read_b64_tr_b16 v[188:189], v7 offset:24576
    ds_read_b64_tr_b16 v[190:191], v7 offset:26112
    v_mfma_f32_16x16x32_bf16 v[136:139], v[32:35], v[16:19], v[136:139]
    ds_read_b64_tr_b16 v[192:193], v8 offset:24576
    ds_read_b64_tr_b16 v[194:195], v8 offset:26112
    v_mfma_f32_16x16x32_bf16 v[140:143], v[36:39], v[16:19], v[140:143]
    ds_read_b64_tr_b16 v[196:197], v9 offset:24576
    ds_read_b64_tr_b16 v[198:199], v9 offset:26112
    v_mfma_f32_16x16x32_bf16 v[144:147], v[40:43], v[16:19], v[144:147]
    ds_read_b64_tr_b16 v[200:201], v10 offset:24576
    ds_read_b64_tr_b16 v[202:203], v10 offset:26112
    v_mfma_f32_16x16x32_bf16 v[148:151], v[44:47], v[16:19], v[148:151]
    ds_read_b64_tr_b16 v[204:205], v11 offset:24576
    ds_read_b64_tr_b16 v[206:207], v11 offset:26112
    v_mfma_f32_16x16x32_bf16 v[152:155], v[24:27], v[20:23], v[152:155]
    ds_read_b128 v[208:211], v5 offset:8192
    ds_read_b128 v[212:215], v5 offset:10240
    v_mfma_f32_16x16x32_bf16 v[156:159], v[28:31], v[20:23], v[156:159]
    ds_read_b64_tr_b16 v[216:217], v6 offset:36864
    ds_read_b64_tr_b16 v[218:219], v6 offset:38400
    v_mfma_f32_16x16x32_bf16 v[160:163], v[32:35], v[20:23], v[160:163]
    ds_read_b64_tr_b16 v[220:221], v7 offset:36864
    ds_read_b64_tr_b16 v[222:223], v7 offset:38400
    v_mfma_f32_16x16x32_bf16 v[164:167], v[36:39], v[20:23], v[164:167]
    ds_read_b64_tr_b16 v[224:225], v8 offset:36864
    v_mfma_f32_16x16x32_bf16 v[168:171], v[40:43], v[20:23], v[168:171]
    ds_read_b64_tr_b16 v[226:227], v8 offset:38400
    v_mfma_f32_16x16x32_bf16 v[172:175], v[44:47], v[20:23], v[172:175]
    ds_read_b64_tr_b16 v[228:229], v9 offset:36864
    v_mfma_f32_16x16x32_bf16 v[128:131], v[56:59], v[48:51], v[128:131]
    ds_read_b64_tr_b16 v[230:231], v9 offset:38400
    v_mfma_f32_16x16x32_bf16 v[132:135], v[60:63], v[48:51], v[132:135]
    ds_read_b64_tr_b16 v[232:233], v10 offset:36864
    v_mfma_f32_16x16x32_bf16 v[136:139], v[64:67], v[48:51], v[136:139]
    ds_read_b64_tr_b16 v[234:235], v10 offset:38400
    v_mfma_f32_16x16x32_bf16 v[140:143], v[68:71], v[48:51], v[140:143]
    ds_read_b64_tr_b16 v[236:237], v11 offset:36864
    v_mfma_f32_16x16x32_bf16 v[144:147], v[72:75], v[48:51], v[144:147]
    ds_read_b64_tr_b16 v[238:239], v11 offset:38400
    v_mfma_f32_16x16x32_bf16 v[148:151], v[76:79], v[48:51], v[148:151]
    v_mfma_f32_16x16x32_bf16 v[152:155], v[56:59], v[52:55], v[152:155]
    v_mfma_f32_16x16x32_bf16 v[156:159], v[60:63], v[52:55], v[156:159]
    v_mfma_f32_16x16x32_bf16 v[160:163], v[64:67], v[52:55], v[160:163]
    v_mfma_f32_16x16x32_bf16 v[164:167], v[68:71], v[52:55], v[164:167]
    v_mfma_f32_16x16x32_bf16 v[168:171], v[72:75], v[52:55], v[168:171]
    v_mfma_f32_16x16x32_bf16 v[172:175], v[76:79], v[52:55], v[172:175]
    s_waitcnt lgkmcnt(0)
    s_barrier
    v_mfma_f32_16x16x32_bf16 v[128:131], v[184:187], v[176:179], v[128:131]
    v_mfma_f32_16x16x32_bf16 v[132:135], v[188:191], v[176:179], v[132:135]
    v_mfma_f32_16x16x32_bf16 v[136:139], v[192:195], v[176:179], v[136:139]
    v_mfma_f32_16x16x32_bf16 v[140:143], v[196:199], v[176:179], v[140:143]
    v_mfma_f32_16x16x32_bf16 v[144:147], v[200:203], v[176:179], v[144:147]
    v_mfma_f32_16x16x32_bf16 v[148:151], v[204:207], v[176:179], v[148:151]
    v_mfma_f32_16x16x32_bf16 v[152:155], v[184:187], v[180:183], v[152:155]
    v_mfma_f32_16x16x32_bf16 v[156:159], v[188:191], v[180:183], v[156:159]
    v_mfma_f32_16x16x32_bf16 v[160:163], v[192:195], v[180:183], v[160:163]
    v_mfma_f32_16x16x32_bf16 v[164:167], v[196:199], v[180:183], v[164:167]
    v_mfma_f32_16x16x32_bf16 v[168:171], v[200:203], v[180:183], v[168:171]
    v_mfma_f32_16x16x32_bf16 v[172:175], v[204:207], v[180:183], v[172:175]
    v_mfma_f32_16x16x32_bf16 v[128:131], v[216:219], v[208:211], v[128:131]
    v_mfma_f32_16x16x32_bf16 v[132:135], v[220:223], v[208:211], v[132:135]
    v_mfma_f32_16x16x32_bf16 v[136:139], v[224:227], v[208:211], v[136:139]
    v_mfma_f32_16x16x32_bf16 v[140:143], v[228:231], v[208:211], v[140:143]
    v_mfma_f32_16x16x32_bf16 v[144:147], v[232:235], v[208:211], v[144:147]
    v_mfma_f32_16x16x32_bf16 v[148:151], v[236:239], v[208:211], v[148:151]
    v_mfma_f32_16x16x32_bf16 v[152:155], v[216:219], v[212:215], v[152:155]
    v_mfma_f32_16x16x32_bf16 v[156:159], v[220:223], v[212:215], v[156:159]
    v_mfma_f32_16x16x32_bf16 v[160:163], v[224:227], v[212:215], v[160:163]
    v_mfma_f32_16x16x32_bf16 v[164:167], v[228:231], v[212:215], v[164:167]
    v_mfma_f32_16x16x32_bf16 v[168:171], v[232:235], v[212:215], v[168:171]
    v_mfma_f32_16x16x32_bf16 v[172:175], v[236:239], v[212:215], v[172:175]
    s_waitcnt lgkmcnt(0)
    v_mov_b32 v12, 3222493025
    v_mov_b32 v13, 3222493025
    v_pk_mul_f32 v[176:177], v[128:129], v[128:129]
    v_pk_mul_f32 v[178:179], v[130:131], v[130:131]
    v_pk_mul_f32 v[180:181], v[132:133], v[132:133]
    v_pk_mul_f32 v[182:183], v[134:135], v[134:135]
    v_pk_mul_f32 v[184:185], v[136:137], v[136:137]
    v_pk_mul_f32 v[186:187], v[138:139], v[138:139]
    v_pk_mul_f32 v[188:189], v[140:141], v[140:141]
    v_pk_mul_f32 v[190:191], v[142:143], v[142:143]
    v_pk_mul_f32 v[192:193], v[144:145], v[144:145]
    v_pk_mul_f32 v[194:195], v[146:147], v[146:147]
    v_pk_mul_f32 v[196:197], v[148:149], v[148:149]
    v_pk_mul_f32 v[198:199], v[150:151], v[150:151]
    v_pk_mul_f32 v[200:201], v[152:153], v[152:153]
    v_pk_mul_f32 v[202:203], v[154:155], v[154:155]
    v_pk_mul_f32 v[204:205], v[156:157], v[156:157]
    v_pk_mul_f32 v[206:207], v[158:159], v[158:159]
    v_pk_mul_f32 v[208:209], v[160:161], v[160:161]
    v_pk_mul_f32 v[210:211], v[162:163], v[162:163]
    v_pk_mul_f32 v[212:213], v[164:165], v[164:165]
    v_pk_mul_f32 v[214:215], v[166:167], v[166:167]
    v_pk_mul_f32 v[216:217], v[168:169], v[168:169]
    v_pk_mul_f32 v[218:219], v[170:171], v[170:171]
    v_pk_mul_f32 v[220:221], v[172:173], v[172:173]
    v_pk_mul_f32 v[222:223], v[174:175], v[174:175]
    v_pk_fma_f32 v[176:177], v[176:177], s[56:57], v[12:13]
    v_pk_fma_f32 v[178:179], v[178:179], s[56:57], v[12:13]
    v_pk_fma_f32 v[180:181], v[180:181], s[56:57], v[12:13]
    v_pk_fma_f32 v[182:183], v[182:183], s[56:57], v[12:13]
    v_pk_fma_f32 v[184:185], v[184:185], s[56:57], v[12:13]
    v_pk_fma_f32 v[186:187], v[186:187], s[56:57], v[12:13]
    v_pk_fma_f32 v[188:189], v[188:189], s[56:57], v[12:13]
    v_pk_fma_f32 v[190:191], v[190:191], s[56:57], v[12:13]
    v_pk_fma_f32 v[192:193], v[192:193], s[56:57], v[12:13]
    v_pk_fma_f32 v[194:195], v[194:195], s[56:57], v[12:13]
    v_pk_fma_f32 v[196:197], v[196:197], s[56:57], v[12:13]
    v_pk_fma_f32 v[198:199], v[198:199], s[56:57], v[12:13]
    v_pk_fma_f32 v[200:201], v[200:201], s[56:57], v[12:13]
    v_pk_fma_f32 v[202:203], v[202:203], s[56:57], v[12:13]
    v_pk_fma_f32 v[204:205], v[204:205], s[56:57], v[12:13]
    v_pk_fma_f32 v[206:207], v[206:207], s[56:57], v[12:13]
    v_pk_fma_f32 v[208:209], v[208:209], s[56:57], v[12:13]
    v_pk_fma_f32 v[210:211], v[210:211], s[56:57], v[12:13]
    v_pk_fma_f32 v[212:213], v[212:213], s[56:57], v[12:13]
    v_pk_fma_f32 v[214:215], v[214:215], s[56:57], v[12:13]
    v_pk_fma_f32 v[216:217], v[216:217], s[56:57], v[12:13]
    v_pk_fma_f32 v[218:219], v[218:219], s[56:57], v[12:13]
    v_pk_fma_f32 v[220:221], v[220:221], s[56:57], v[12:13]
    v_pk_fma_f32 v[222:223], v[222:223], s[56:57], v[12:13]
    v_pk_mul_f32 v[176:177], v[176:177], v[128:129]
    v_pk_mul_f32 v[178:179], v[178:179], v[130:131]
    v_pk_mul_f32 v[180:181], v[180:181], v[132:133]
    v_pk_mul_f32 v[182:183], v[182:183], v[134:135]
    v_pk_mul_f32 v[184:185], v[184:185], v[136:137]
    v_pk_mul_f32 v[186:187], v[186:187], v[138:139]
    v_pk_mul_f32 v[188:189], v[188:189], v[140:141]
    v_pk_mul_f32 v[190:191], v[190:191], v[142:143]
    v_pk_mul_f32 v[192:193], v[192:193], v[144:145]
    v_pk_mul_f32 v[194:195], v[194:195], v[146:147]
    v_pk_mul_f32 v[196:197], v[196:197], v[148:149]
    v_pk_mul_f32 v[198:199], v[198:199], v[150:151]
    v_pk_mul_f32 v[200:201], v[200:201], v[152:153]
    v_pk_mul_f32 v[202:203], v[202:203], v[154:155]
    v_pk_mul_f32 v[204:205], v[204:205], v[156:157]
    v_pk_mul_f32 v[206:207], v[206:207], v[158:159]
    v_pk_mul_f32 v[208:209], v[208:209], v[160:161]
    v_pk_mul_f32 v[210:211], v[210:211], v[162:163]
    v_pk_mul_f32 v[212:213], v[212:213], v[164:165]
    v_pk_mul_f32 v[214:215], v[214:215], v[166:167]
    v_pk_mul_f32 v[216:217], v[216:217], v[168:169]
    v_pk_mul_f32 v[218:219], v[218:219], v[170:171]
    v_pk_mul_f32 v[220:221], v[220:221], v[172:173]
    v_pk_mul_f32 v[222:223], v[222:223], v[174:175]
    v_exp_f32 v176, v176
    v_exp_f32 v177, v177
    v_exp_f32 v178, v178
    v_exp_f32 v179, v179
    v_exp_f32 v180, v180
    v_exp_f32 v181, v181
    v_exp_f32 v182, v182
    v_exp_f32 v183, v183
    v_exp_f32 v184, v184
    v_exp_f32 v185, v185
    v_exp_f32 v186, v186
    v_exp_f32 v187, v187
    v_exp_f32 v188, v188
    v_exp_f32 v189, v189
    v_exp_f32 v190, v190
    v_exp_f32 v191, v191
    v_exp_f32 v192, v192
    v_exp_f32 v193, v193
    v_exp_f32 v194, v194
    v_exp_f32 v195, v195
    v_exp_f32 v196, v196
    v_exp_f32 v197, v197
    v_exp_f32 v198, v198
    v_exp_f32 v199, v199
    v_exp_f32 v200, v200
    v_exp_f32 v201, v201
    v_exp_f32 v202, v202
    v_exp_f32 v203, v203
    v_exp_f32 v204, v204
    v_exp_f32 v205, v205
    v_exp_f32 v206, v206
    v_exp_f32 v207, v207
    v_exp_f32 v208, v208
    v_exp_f32 v209, v209
    v_exp_f32 v210, v210
    v_exp_f32 v211, v211
    v_exp_f32 v212, v212
    v_exp_f32 v213, v213
    v_exp_f32 v214, v214
    v_exp_f32 v215, v215
    v_exp_f32 v216, v216
    v_exp_f32 v217, v217
    v_exp_f32 v218, v218
    v_exp_f32 v219, v219
    v_exp_f32 v220, v220
    v_exp_f32 v221, v221
    v_exp_f32 v222, v222
    v_exp_f32 v223, v223
    v_pk_add_f32 v[176:177], v[176:177], 1.0 op_sel_hi:[1,0]
    v_pk_add_f32 v[178:179], v[178:179], 1.0 op_sel_hi:[1,0]
    v_pk_add_f32 v[180:181], v[180:181], 1.0 op_sel_hi:[1,0]
    v_pk_add_f32 v[182:183], v[182:183], 1.0 op_sel_hi:[1,0]
    v_pk_add_f32 v[184:185], v[184:185], 1.0 op_sel_hi:[1,0]
    v_pk_add_f32 v[186:187], v[186:187], 1.0 op_sel_hi:[1,0]
    v_pk_add_f32 v[188:189], v[188:189], 1.0 op_sel_hi:[1,0]
    v_pk_add_f32 v[190:191], v[190:191], 1.0 op_sel_hi:[1,0]
    v_pk_add_f32 v[192:193], v[192:193], 1.0 op_sel_hi:[1,0]
    v_pk_add_f32 v[194:195], v[194:195], 1.0 op_sel_hi:[1,0]
    v_pk_add_f32 v[196:197], v[196:197], 1.0 op_sel_hi:[1,0]
    v_pk_add_f32 v[198:199], v[198:199], 1.0 op_sel_hi:[1,0]
    v_pk_add_f32 v[200:201], v[200:201], 1.0 op_sel_hi:[1,0]
    v_pk_add_f32 v[202:203], v[202:203], 1.0 op_sel_hi:[1,0]
    v_pk_add_f32 v[204:205], v[204:205], 1.0 op_sel_hi:[1,0]
    v_pk_add_f32 v[206:207], v[206:207], 1.0 op_sel_hi:[1,0]
    v_pk_add_f32 v[208:209], v[208:209], 1.0 op_sel_hi:[1,0]
    v_pk_add_f32 v[210:211], v[210:211], 1.0 op_sel_hi:[1,0]
    v_pk_add_f32 v[212:213], v[212:213], 1.0 op_sel_hi:[1,0]
    v_pk_add_f32 v[214:215], v[214:215], 1.0 op_sel_hi:[1,0]
    v_pk_add_f32 v[216:217], v[216:217], 1.0 op_sel_hi:[1,0]
    v_pk_add_f32 v[218:219], v[218:219], 1.0 op_sel_hi:[1,0]
    v_pk_add_f32 v[220:221], v[220:221], 1.0 op_sel_hi:[1,0]
    v_pk_add_f32 v[222:223], v[222:223], 1.0 op_sel_hi:[1,0]
    v_rcp_f32 v176, v176
    v_rcp_f32 v177, v177
    v_rcp_f32 v178, v178
    v_rcp_f32 v179, v179
    v_rcp_f32 v180, v180
    v_rcp_f32 v181, v181
    v_rcp_f32 v182, v182
    v_rcp_f32 v183, v183
    v_rcp_f32 v184, v184
    v_rcp_f32 v185, v185
    v_rcp_f32 v186, v186
    v_rcp_f32 v187, v187
    v_rcp_f32 v188, v188
    v_rcp_f32 v189, v189
    v_rcp_f32 v190, v190
    v_rcp_f32 v191, v191
    v_rcp_f32 v192, v192
    v_rcp_f32 v193, v193
    v_rcp_f32 v194, v194
    v_rcp_f32 v195, v195
    v_rcp_f32 v196, v196
    v_rcp_f32 v197, v197
    v_rcp_f32 v198, v198
    v_rcp_f32 v199, v199
    v_rcp_f32 v200, v200
    v_rcp_f32 v201, v201
    v_rcp_f32 v202, v202
    v_rcp_f32 v203, v203
    v_rcp_f32 v204, v204
    v_rcp_f32 v205, v205
    v_rcp_f32 v206, v206
    v_rcp_f32 v207, v207
    v_rcp_f32 v208, v208
    v_rcp_f32 v209, v209
    v_rcp_f32 v210, v210
    v_rcp_f32 v211, v211
    v_rcp_f32 v212, v212
    v_rcp_f32 v213, v213
    v_rcp_f32 v214, v214
    v_rcp_f32 v215, v215
    v_rcp_f32 v216, v216
    v_rcp_f32 v217, v217
    v_rcp_f32 v218, v218
    v_rcp_f32 v219, v219
    v_rcp_f32 v220, v220
    v_rcp_f32 v221, v221
    v_rcp_f32 v222, v222
    v_rcp_f32 v223, v223
    v_pk_mul_f32 v[128:129], v[128:129], v[176:177]
    v_pk_mul_f32 v[130:131], v[130:131], v[178:179]
    v_pk_mul_f32 v[132:133], v[132:133], v[180:181]
    v_pk_mul_f32 v[134:135], v[134:135], v[182:183]
    v_pk_mul_f32 v[136:137], v[136:137], v[184:185]
    v_pk_mul_f32 v[138:139], v[138:139], v[186:187]
    v_pk_mul_f32 v[140:141], v[140:141], v[188:189]
    v_pk_mul_f32 v[142:143], v[142:143], v[190:191]
    v_pk_mul_f32 v[144:145], v[144:145], v[192:193]
    v_pk_mul_f32 v[146:147], v[146:147], v[194:195]
    v_pk_mul_f32 v[148:149], v[148:149], v[196:197]
    v_pk_mul_f32 v[150:151], v[150:151], v[198:199]
    v_pk_mul_f32 v[152:153], v[152:153], v[200:201]
    v_pk_mul_f32 v[154:155], v[154:155], v[202:203]
    v_pk_mul_f32 v[156:157], v[156:157], v[204:205]
    v_pk_mul_f32 v[158:159], v[158:159], v[206:207]
    v_pk_mul_f32 v[160:161], v[160:161], v[208:209]
    v_pk_mul_f32 v[162:163], v[162:163], v[210:211]
    v_pk_mul_f32 v[164:165], v[164:165], v[212:213]
    v_pk_mul_f32 v[166:167], v[166:167], v[214:215]
    v_pk_mul_f32 v[168:169], v[168:169], v[216:217]
    v_pk_mul_f32 v[170:171], v[170:171], v[218:219]
    v_pk_mul_f32 v[172:173], v[172:173], v[220:221]
    v_pk_mul_f32 v[174:175], v[174:175], v[222:223]
    s_add_u32 s4, s32, 9437184
    s_addc_u32 s5, s33, 0
    s_mov_b32 s6, 3145728
    s_mov_b32 s7, 0x20000
    s_lshl_b32 s22, s48, 1
    s_add_u32 s22, s22, s20
    s_mul_i32 s22, s22, 48
    s_mul_i32 s23, s49, 6
    s_add_u32 s22, s22, s23
    s_lshl_b32 s22, s22, 10
    v_lshlrev_b32 v14, 4, v0
    v_cvt_pk_bf16_f32 v16, v128, v129
    v_cvt_pk_bf16_f32 v17, v130, v131
    v_cvt_pk_bf16_f32 v18, v152, v153
    v_cvt_pk_bf16_f32 v19, v154, v155
    v_cvt_pk_bf16_f32 v20, v132, v133
    v_cvt_pk_bf16_f32 v21, v134, v135
    v_cvt_pk_bf16_f32 v22, v156, v157
    v_cvt_pk_bf16_f32 v23, v158, v159
    v_cvt_pk_bf16_f32 v24, v136, v137
    v_cvt_pk_bf16_f32 v25, v138, v139
    v_cvt_pk_bf16_f32 v26, v160, v161
    v_cvt_pk_bf16_f32 v27, v162, v163
    v_cvt_pk_bf16_f32 v28, v140, v141
    v_cvt_pk_bf16_f32 v29, v142, v143
    v_cvt_pk_bf16_f32 v30, v164, v165
    v_cvt_pk_bf16_f32 v31, v166, v167
    v_cvt_pk_bf16_f32 v32, v144, v145
    v_cvt_pk_bf16_f32 v33, v146, v147
    v_cvt_pk_bf16_f32 v34, v168, v169
    v_cvt_pk_bf16_f32 v35, v170, v171
    v_cvt_pk_bf16_f32 v36, v148, v149
    v_cvt_pk_bf16_f32 v37, v150, v151
    v_cvt_pk_bf16_f32 v38, v172, v173
    v_cvt_pk_bf16_f32 v39, v174, v175
    s_add_u32 s23, s22, 0
    buffer_store_dwordx4 v[16:19], v14, s[4:7], s23 offen sc1
    s_add_u32 s23, s22, 1024
    buffer_store_dwordx4 v[20:23], v14, s[4:7], s23 offen sc1
    s_add_u32 s23, s22, 2048
    buffer_store_dwordx4 v[24:27], v14, s[4:7], s23 offen sc1
    s_add_u32 s23, s22, 3072
    buffer_store_dwordx4 v[28:31], v14, s[4:7], s23 offen sc1
    s_add_u32 s23, s22, 4096
    buffer_store_dwordx4 v[32:35], v14, s[4:7], s23 offen sc1
    s_add_u32 s23, s22, 5120
    buffer_store_dwordx4 v[36:39], v14, s[4:7], s23 offen sc1
K1_znost:
    s_and_b32 s60, s2, 1
    s_lshl_b32 s60, s60, 2
    s_lshr_b32 s61, s2, 6
    s_add_u32 s60, s60, s61
    s_add_u32 s12, s32, 24707072
    s_addc_u32 s13, s33, 0
    s_mov_b32 s14, 2048
    s_mov_b32 s15, 0x20000
    s_lshl_b32 s60, s60, 8
    v_and_b32 v14, 31, v0
    v_lshlrev_b32 v14, 3, v14
    v_add_u32 v14, s60, v14
    s_cmp_lg_u32 s16, 4
    s_cbranch_scc1 K1_nopre_3
    buffer_load_dwordx2 v[18:19], v14, s[12:15], 0 offen sc1
K1_nopre_3:
    s_waitcnt vmcnt(0)
    s_barrier
    s_add_u32 s12, s32, 24576000
    s_addc_u32 s13, s33, 0
    s_mov_b32 s14, 1024
    s_mov_b32 s15, 0x20000
    s_lshr_b32 s20, s49, 1
    s_lshl_b32 s21, s48, 2
    s_add_u32 s20, s20, s21
    s_lshl_b32 s20, s20, 3
K1_flag:
    s_cmp_lg_u32 s16, 0
    s_cbranch_scc1 K1_done
    s_add_u32 s21, s98, 1
    v_mov_b32 v8, s21
    v_mov_b32 v9, s99
    v_mov_b32 v10, s20
    s_mov_b64 exec, 1
    buffer_store_dwordx2 v[8:9], v10, s[12:15], 0 offen sc1
    s_mov_b64 exec, -1
K1_done:
    s_load_dwordx2 s[30:31], s[0:1], 40
    s_load_dwordx2 s[34:35], s[0:1], 48
    s_load_dwordx2 s[36:37], s[0:1], 72
    s_load_dwordx2 s[38:39], s[0:1], 80
    s_and_b32 s42, s2, 7
    s_lshr_b32 s43, s2, 3
    s_lshr_b32 s40, s42, 1
    s_lshl_b32 s40, s40, 3
    s_and_b32 s44, s43, 7
    s_add_u32 s40, s40, s44
    s_and_b32 s41, s42, 1
    s_lshl_b32 s41, s41, 2
    s_lshr_b32 s44, s43, 3
    s_add_u32 s41, s41, s44
    s_waitcnt lgkmcnt(0)
    s_cmp_lt_u32 s16, 4
    s_cbranch_scc1 K34_comp
    s_mov_b32 s4, s30
    s_mov_b32 s5, s31
    s_mov_b32 s6, 8388608
    s_mov_b32 s7, 0x20000
    s_add_u32 s8, s32, 12582912
    s_addc_u32 s9, s33, 0
    s_mov_b32 s10, 3145728
    s_mov_b32 s11, 0x20000
    s_mul_i32 s17, s40, 262144
    s_mul_i32 s18, s41, 393216
    s_sub_u32 s21, s16, 4
    v_lshrrev_b32 v7, 3, v0
    v_and_b32 v2, 7, v0
    v_xor_b32 v2, v2, v7
    s_mov_b32 s20, 4096
    v_mul_lo_u32 v7, v7, s20
    v_lshl_add_u32 v2, v2, 4, v7
    v_lshlrev_b32 v3, 4, v0
    s_mul_i32 s20, s21, 65536
    s_add_u32 s23, s17, s20
    s_mul_i32 s20, s21, 3072
    s_add_u32 s24, s18, s20
    s_add_u32 s26, s20, 8192
    s_lshl_b32 s27, s21, 11
    s_mov_b32 s28, 0
    s_mov_b32 s29, 0
    s_mov_b32 s22, 0
    v_lshrrev_b32 v7, 3, v0
    v_and_b32 v4, 7, v0
    v_xor_b32 v4, v4, v7
    v_mul_u32_u24 v7, 2816, v7
    v_lshl_add_u32 v4, v4, 4, v7
    v_lshrrev_b32 v7, 3, v0
    v_and_b32 v5, 7, v0
    v_xor_b32 v5, v5, v7
    v_mul_u32_u24 v7, 384, v7
    v_lshl_add_u32 v10, v5, 4, v7
    s_add_u32 m0, s27, 0
    s_add_u32 s20, s23, 0
    s_add_u32 s25, s23, 31744
    buffer_load_dwordx4 v2, s[4:7], s20 offen lds
    buffer_load_dwordx4 v2, s[4:7], s25 offen offset:1024 lds
    s_add_u32 m0, s27, 20480
    s_add_u32 s20, s23, 128
    s_add_u32 s25, s23, 31872
    buffer_load_dwordx4 v2, s[4:7], s20 offen lds
    buffer_load_dwordx4 v2, s[4:7], s25 offen offset:1024 lds
    s_add_u32 m0, s27, 40960
    s_add_u32 s20, s23, 256
    s_add_u32 s25, s23, 32000
    buffer_load_dwordx4 v2, s[4:7], s20 offen lds
    buffer_load_dwordx4 v2, s[4:7], s25 offen offset:1024 lds
    s_add_u32 m0, s27, 61440
    s_add_u32 s20, s23, 384
    s_add_u32 s25, s23, 32128
    buffer_load_dwordx4 v2, s[4:7], s20 offen lds
    buffer_load_dwordx4 v2, s[4:7], s25 offen offset:1024 lds
    s_add_u32 m0, s27, 81920
    s_add_u32 s20, s23, 512
    s_add_u32 s25, s23, 32256
    buffer_load_dwordx4 v2, s[4:7], s20 offen lds
    buffer_load_dwordx4 v2, s[4:7], s25 offen offset:1024 lds
    s_cmp_lg_u32 s16, 4
    s_cbranch_scc1 K34_lf
    s_add_u32 s12, s32, 24707072
    s_addc_u32 s13, s33, 0
    s_mov_b32 s14, 2048
    s_mov_b32 s15, 0x20000
    s_lshl_b32 s46, s41, 8
    v_and_b32 v14, 31, v0
    v_lshlrev_b32 v14, 3, v14
    v_add_u32 v14, s46, v14
    s_add_u32 s45, s98, 1
    s_mov_b32 s47, 0
    v_mov_b32 v16, v18
    v_mov_b32 v17, v19
    s_branch K34_zpC
K34_zpL:
    buffer_load_dwordx2 v[16:17], v14, s[12:15], 0 offen sc1
    s_waitcnt vmcnt(0)
K34_zpC:
    v_xor_b32 v16, s45, v16
    v_xor_b32 v17, s99, v17
    v_or_b32 v16, v16, v17
    v_cmp_ne_u32 vcc, 0, v16
    s_add_u32 s47, s47, 1
    s_nop 3
    s_cbranch_vccz K34_lf
    s_sleep 8
    s_cmp_lt_u32 s47, 0x10000
    s_cbranch_scc1 K34_zpL
K34_lf:
    s_barrier
    s_add_u32 m0, s26, 0
    s_add_u32 s20, s24, 0
    buffer_load_dwordx4 v3, s[8:11], s20 offen offset:0 sc1 lds
    buffer_load_dwordx4 v3, s[8:11], s20 offen offset:1024 sc1 lds
    buffer_load_dwordx4 v3, s[8:11], s20 offen offset:2048 sc1 lds
    s_add_u32 m0, s26, 20480
    s_add_u32 s20, s24, 12288
    buffer_load_dwordx4 v3, s[8:11], s20 offen offset:0 sc1 lds
    buffer_load_dwordx4 v3, s[8:11], s20 offen offset:1024 sc1 lds
    buffer_load_dwordx4 v3, s[8:11], s20 offen offset:2048 sc1 lds
    s_add_u32 m0, s26, 40960
    s_add_u32 s20, s24, 24576
    buffer_load_dwordx4 v3, s[8:11], s20 offen offset:0 sc1 lds
    buffer_load_dwordx4 v3, s[8:11], s20 offen offset:1024 sc1 lds
    buffer_load_dwordx4 v3, s[8:11], s20 offen offset:2048 sc1 lds
    s_add_u32 m0, s26, 61440
    s_add_u32 s20, s24, 36864
    buffer_load_dwordx4 v3, s[8:11], s20 offen offset:0 sc1 lds
    buffer_load_dwordx4 v3, s[8:11], s20 offen offset:1024 sc1 lds
    buffer_load_dwordx4 v3, s[8:11], s20 offen offset:2048 sc1 lds
    s_add_u32 m0, s26, 81920
    s_add_u32 s20, s24, 49152
    buffer_load_dwordx4 v3, s[8:11], s20 offen offset:0 sc1 lds
    buffer_load_dwordx4 v3, s[8:11], s20 offen offset:1024 sc1 lds
    buffer_load_dwordx4 v3, s[8:11], s20 offen offset:2048 sc1 lds
    s_add_u32 s23, s23, 640
    s_add_u32 s24, s24, 61440
    s_mov_b32 s22, 102400
    s_waitcnt vmcnt(12)
    s_barrier
    s_add_u32 m0, s22, s27
    s_add_u32 s20, s23, 31744
    buffer_load_dwordx4 v2, s[4:7], s23 offen lds
    buffer_load_dwordx4 v2, s[4:7], s20 offen offset:1024 lds
    s_add_u32 m0, s22, s26
    s_nop 0
    buffer_load_dwordx4 v3, s[8:11], s24 offen sc1 lds
    buffer_load_dwordx4 v3, s[8:11], s24 offen offset:1024 sc1 lds
    buffer_load_dwordx4 v3, s[8:11], s24 offen offset:2048 sc1 lds
    s_add_u32 s23, s23, 128
    s_add_u32 s24, s24, 12288
    s_add_u32 s22, s22, 20480
    s_cmp_eq_u32 s22, 122880
    s_cselect_b32 s22, 0, s22
    s_waitcnt vmcnt(14)
    s_barrier
    s_add_u32 m0, s22, s27
    s_add_u32 s20, s23, 31744
    buffer_load_dwordx4 v2, s[4:7], s23 offen lds
    buffer_load_dwordx4 v2, s[4:7], s20 offen offset:1024 lds
    s_add_u32 m0, s22, s26
    s_nop 0
    buffer_load_dwordx4 v3, s[8:11], s24 offen sc1 lds
    buffer_load_dwordx4 v3, s[8:11], s24 offen offset:1024 sc1 lds
    buffer_load_dwordx4 v3, s[8:11], s24 offen offset:2048 sc1 lds
    s_add_u32 s23, s23, 128
    s_add_u32 s24, s24, 12288
    s_add_u32 s22, s22, 20480
    s_cmp_eq_u32 s22, 122880
    s_cselect_b32 s22, 0, s22
    s_waitcnt vmcnt(16)
    s_barrier
    s_add_u32 m0, s22, s27
    s_add_u32 s20, s23, 31744
    buffer_load_dwordx4 v2, s[4:7], s23 offen lds
    buffer_load_dwordx4 v2, s[4:7], s20 offen offset:1024 lds
    s_add_u32 m0, s22, s26
    s_nop 0
    buffer_load_dwordx4 v3, s[8:11], s24 offen sc1 lds
    buffer_load_dwordx4 v3, s[8:11], s24 offen offset:1024 sc1 lds
    buffer_load_dwordx4 v3, s[8:11], s24 offen offset:2048 sc1 lds
    s_add_u32 s23, s23, 128
    s_add_u32 s24, s24, 12288
    s_add_u32 s22, s22, 20480
    s_cmp_eq_u32 s22, 122880
    s_cselect_b32 s22, 0, s22
    s_waitcnt vmcnt(18)
    s_barrier
    s_add_u32 m0, s22, s27
    s_add_u32 s20, s23, 31744
    buffer_load_dwordx4 v2, s[4:7], s23 offen lds
    buffer_load_dwordx4 v2, s[4:7], s20 offen offset:1024 lds
    s_add_u32 m0, s22, s26
    s_nop 0
    buffer_load_dwordx4 v3, s[8:11], s24 offen sc1 lds
    buffer_load_dwordx4 v3, s[8:11], s24 offen offset:1024 sc1 lds
    buffer_load_dwordx4 v3, s[8:11], s24 offen offset:2048 sc1 lds
    s_add_u32 s23, s23, 128
    s_add_u32 s24, s24, 12288
    s_add_u32 s22, s22, 20480
    s_cmp_eq_u32 s22, 122880
    s_cselect_b32 s22, 0, s22
    s_waitcnt vmcnt(20)
    s_barrier
    s_add_u32 m0, s22, s27
    s_add_u32 s20, s23, 31744
    buffer_load_dwordx4 v2, s[4:7], s23 offen lds
    buffer_load_dwordx4 v2, s[4:7], s20 offen offset:1024 lds
    s_add_u32 m0, s22, s26
    s_nop 0
    buffer_load_dwordx4 v3, s[8:11], s24 offen sc1 lds
    buffer_load_dwordx4 v3, s[8:11], s24 offen offset:1024 sc1 lds
    buffer_load_dwordx4 v3, s[8:11], s24 offen offset:2048 sc1 lds
    s_add_u32 s23, s23, 128
    s_add_u32 s24, s24, 12288
    s_add_u32 s22, s22, 20480
    s_cmp_eq_u32 s22, 122880
    s_cselect_b32 s22, 0, s22
    s_waitcnt vmcnt(20)
    s_barrier
    s_add_u32 m0, s27, 81920
    s_add_u32 s20, s23, 31744
    buffer_load_dwordx4 v2, s[4:7], s23 offen lds
    buffer_load_dwordx4 v2, s[4:7], s20 offen offset:1024 lds
    s_add_u32 m0, s26, 81920
    s_add_u32 s23, s23, 128
    buffer_load_dwordx4 v3, s[8:11], s24 offen offset:0 sc1 lds
    buffer_load_dwordx4 v3, s[8:11], s24 offen offset:1024 sc1 lds
    buffer_load_dwordx4 v3, s[8:11], s24 offen offset:2048 sc1 lds
    s_add_u32 s24, s24, 12288
    s_waitcnt vmcnt(20)
    s_barrier
    s_add_u32 m0, s27, 102400
    s_add_u32 s20, s23, 31744
    buffer_load_dwordx4 v2, s[4:7], s23 offen lds
    buffer_load_dwordx4 v2, s[4:7], s20 offen offset:1024 lds
    s_add_u32 m0, s26, 102400
    s_add_u32 s23, s23, 128
    buffer_load_dwordx4 v3, s[8:11], s24 offen offset:0 sc1 lds
    buffer_load_dwordx4 v3, s[8:11], s24 offen offset:1024 sc1 lds
    buffer_load_dwordx4 v3, s[8:11], s24 offen offset:2048 sc1 lds
    s_add_u32 s24, s24, 12288
    s_mov_b32 s14, 0
K34_lloop:
    s_waitcnt vmcnt(20)
    s_barrier
    s_add_u32 m0, s27, 0
    s_add_u32 s20, s23, 31744
    buffer_load_dwordx4 v2, s[4:7], s23 offen lds
    buffer_load_dwordx4 v2, s[4:7], s20 offen offset:1024 lds
    s_add_u32 m0, s26, 0
    s_add_u32 s23, s23, 128
    buffer_load_dwordx4 v3, s[8:11], s24 offen offset:0 sc1 lds
    buffer_load_dwordx4 v3, s[8:11], s24 offen offset:1024 sc1 lds
    buffer_load_dwordx4 v3, s[8:11], s24 offen offset:2048 sc1 lds
    s_add_u32 s24, s24, 12288
    s_waitcnt vmcnt(20)
    s_barrier
    s_add_u32 m0, s27, 20480
    s_add_u32 s20, s23, 31744
    buffer_load_dwordx4 v2, s[4:7], s23 offen lds
    buffer_load_dwordx4 v2, s[4:7], s20 offen offset:1024 lds
    s_add_u32 m0, s26, 20480
    s_add_u32 s23, s23, 128
    buffer_load_dwordx4 v3, s[8:11], s24 offen offset:0 sc1 lds
    buffer_load_dwordx4 v3, s[8:11], s24 offen offset:1024 sc1 lds
    buffer_load_dwordx4 v3, s[8:11], s24 offen offset:2048 sc1 lds
    s_add_u32 s24, s24, 12288
    s_waitcnt vmcnt(20)
    s_barrier
    s_add_u32 m0, s27, 40960
    s_add_u32 s20, s23, 31744
    buffer_load_dwordx4 v2, s[4:7], s23 offen lds
    buffer_load_dwordx4 v2, s[4:7], s20 offen offset:1024 lds
    s_add_u32 m0, s26, 40960
    s_add_u32 s23, s23, 128
    buffer_load_dwordx4 v3, s[8:11], s24 offen offset:0 sc1 lds
    buffer_load_dwordx4 v3, s[8:11], s24 offen offset:1024 sc1 lds
    buffer_load_dwordx4 v3, s[8:11], s24 offen offset:2048 sc1 lds
    s_add_u32 s24, s24, 12288
    s_waitcnt vmcnt(20)
    s_barrier
    s_add_u32 m0, s27, 61440
    s_add_u32 s20, s23, 31744
    buffer_load_dwordx4 v2, s[4:7], s23 offen lds
    buffer_load_dwordx4 v2, s[4:7], s20 offen offset:1024 lds
    s_add_u32 m0, s26, 61440
    s_add_u32 s23, s23, 128
    buffer_load_dwordx4 v3, s[8:11], s24 offen offset:0 sc1 lds
    buffer_load_dwordx4 v3, s[8:11], s24 offen offset:1024 sc1 lds
    buffer_load_dwordx4 v3, s[8:11], s24 offen offset:2048 sc1 lds
    s_add_u32 s24, s24, 12288
    s_waitcnt vmcnt(20)
    s_barrier
    s_add_u32 m0, s27, 81920
    s_add_u32 s20, s23, 31744
    buffer_load_dwordx4 v2, s[4:7], s23 offen lds
    buffer_load_dwordx4 v2, s[4:7], s20 offen offset:1024 lds
    s_add_u32 m0, s26, 81920
    s_add_u32 s23, s23, 128
    buffer_load_dwordx4 v3, s[8:11], s24 offen offset:0 sc1 lds
    buffer_load_dwordx4 v3, s[8:11], s24 offen offset:1024 sc1 lds
    buffer_load_dwordx4 v3, s[8:11], s24 offen offset:2048 sc1 lds
    s_add_u32 s24, s24, 12288
    s_waitcnt vmcnt(20)
    s_barrier
    s_add_u32 m0, s27, 102400
    s_add_u32 s20, s23, 31744
    buffer_load_dwordx4 v2, s[4:7], s23 offen lds
    buffer_load_dwordx4 v2, s[4:7], s20 offen offset:1024 lds
    s_add_u32 m0, s26, 102400
    s_add_u32 s23, s23, 128
    buffer_load_dwordx4 v3, s[8:11], s24 offen offset:0 sc1 lds
    buffer_load_dwordx4 v3, s[8:11], s24 offen offset:1024 sc1 lds
    buffer_load_dwordx4 v3, s[8:11], s24 offen offset:2048 sc1 lds
    s_add_u32 s24, s24, 12288
    s_add_u32 s14, s14, 1
    s_cmp_lt_u32 s14, 3
    s_cbranch_scc1 K34_lloop
    s_waitcnt vmcnt(20)
    s_barrier
    s_add_u32 m0, s27, 0
    s_add_u32 s20, s23, 31744
    buffer_load_dwordx4 v2, s[4:7], s23 offen lds
    buffer_load_dwordx4 v2, s[4:7], s20 offen offset:1024 lds
    s_add_u32 m0, s26, 0
    s_add_u32 s23, s23, 128
    buffer_load_dwordx4 v3, s[8:11], s24 offen offset:0 sc1 lds
    buffer_load_dwordx4 v3, s[8:11], s24 offen offset:1024 sc1 lds
    buffer_load_dwordx4 v3, s[8:11], s24 offen offset:2048 sc1 lds
    s_add_u32 s24, s24, 12288
    s_waitcnt vmcnt(20)
    s_barrier
    s_add_u32 m0, s27, 20480
    s_add_u32 s20, s23, 31744
    buffer_load_dwordx4 v2, s[4:7], s23 offen lds
    buffer_load_dwordx4 v2, s[4:7], s20 offen offset:1024 lds
    s_add_u32 m0, s26, 20480
    s_add_u32 s23, s23, 128
    buffer_load_dwordx4 v3, s[8:11], s24 offen offset:0 sc1 lds
    buffer_load_dwordx4 v3, s[8:11], s24 offen offset:1024 sc1 lds
    buffer_load_dwordx4 v3, s[8:11], s24 offen offset:2048 sc1 lds
    s_add_u32 s24, s24, 12288
    s_add_u32 s4, s32, 15728640
    s_addc_u32 s5, s33, 0
    s_mov_b32 s6, 5767168
    s_mov_b32 s7, 0x20000
    s_add_u32 s8, s32, 22020096
    s_addc_u32 s9, s33, 0
    s_mov_b32 s10, 1802240
    s_mov_b32 s11, 0x20000
    s_add_u32 s12, s32, 24444928
    s_addc_u32 s13, s33, 0
    s_mov_b32 s14, 4096
    s_mov_b32 s15, 0x20000
    s_mul_i32 s17, s40, 180224
    s_mul_i32 s20, s21, 45056
    s_add_u32 s23, s17, s20
    s_mul_i32 s18, s41, 225280
    s_mul_i32 s20, s21, 3072
    s_add_u32 s24, s18, s20
    s_mul_i32 s20, s21, 3
    s_cmp_ge_u32 s20, 9
    s_cselect_b32 s28, 1073741824, 0
    s_cmp_ge_u32 s20, 8
    s_cselect_b32 s29, 1073741824, 0
    s_lshl_b32 s44, s40, 7
    v_and_b32 v8, 7, v0
    v_lshlrev_b32 v8, 3, v8
    v_add_u32 v8, s44, v8
    s_add_u32 s53, s98, 1
    s_add_u32 s48, s32, 25165824
    s_addc_u32 s49, s33, 0
    s_mov_b32 s50, 3145728
    s_mov_b32 s51, 0x20000
    s_mul_i32 s52, s40, 98304
    s_mul_i32 s20, s21, 6144
    s_add_u32 s52, s52, s20
    s_waitcnt vmcnt(20)
    s_barrier
    s_add_u32 m0, s26, 40960
    s_add_u32 s20, s24, 0
    s_add_u32 s25, s20, s28
    s_add_u32 s45, s20, s29
    buffer_load_dwordx4 v3, s[8:11], s20 offen sc1 lds
    buffer_load_dwordx4 v3, s[8:11], s25 offen offset:1024 sc1 lds
    buffer_load_dwordx4 v3, s[8:11], s45 offen offset:2048 sc1 lds
    s_add_u32 m0, s27, 40960
    s_add_u32 s20, s23, 0
    s_add_u32 s25, s23, 21504
    buffer_load_dwordx4 v4, s[4:7], s20 offen sc1 lds
    buffer_load_dwordx4 v4, s[4:7], s25 offen offset:1024 sc1 lds
    s_waitcnt vmcnt(20)
    s_barrier
    s_add_u32 m0, s26, 61440
    s_add_u32 s20, s24, 10240
    s_add_u32 s25, s20, s28
    s_add_u32 s45, s20, s29
    buffer_load_dwordx4 v3, s[8:11], s20 offen sc1 lds
    buffer_load_dwordx4 v3, s[8:11], s25 offen offset:1024 sc1 lds
    buffer_load_dwordx4 v3, s[8:11], s45 offen offset:2048 sc1 lds
    s_add_u32 m0, s27, 61440
    s_add_u32 s20, s23, 128
    s_add_u32 s25, s23, 21632
    buffer_load_dwordx4 v4, s[4:7], s20 offen sc1 lds
    buffer_load_dwordx4 v4, s[4:7], s25 offen offset:1024 sc1 lds
    s_waitcnt vmcnt(20)
    s_barrier
    s_add_u32 m0, s26, 81920
    s_add_u32 s20, s24, 20480
    s_add_u32 s25, s20, s28
    s_add_u32 s45, s20, s29
    buffer_load_dwordx4 v3, s[8:11], s20 offen sc1 lds
    buffer_load_dwordx4 v3, s[8:11], s25 offen offset:1024 sc1 lds
    buffer_load_dwordx4 v3, s[8:11], s45 offen offset:2048 sc1 lds
    s_add_u32 m0, s27, 81920
    s_add_u32 s20, s23, 256
    s_add_u32 s25, s23, 21760
    buffer_load_dwordx4 v4, s[4:7], s20 offen sc1 lds
    buffer_load_dwordx4 v4, s[4:7], s25 offen offset:1024 sc1 lds
    s_waitcnt vmcnt(20)
    s_barrier
    s_add_u32 m0, s26, 102400
    s_add_u32 s20, s24, 30720
    s_add_u32 s25, s20, s28
    s_add_u32 s45, s20, s29
    buffer_load_dwordx4 v3, s[8:11], s20 offen sc1 lds
    buffer_load_dwordx4 v3, s[8:11], s25 offen offset:1024 sc1 lds
    buffer_load_dwordx4 v3, s[8:11], s45 offen offset:2048 sc1 lds
    s_add_u32 m0, s27, 102400
    s_add_u32 s20, s23, 384
    s_add_u32 s25, s23, 21888
    buffer_load_dwordx4 v4, s[4:7], s20 offen sc1 lds
    buffer_load_dwordx4 v4, s[4:7], s25 offen offset:1024 sc1 lds
    s_waitcnt vmcnt(20)
    s_barrier
    s_add_u32 m0, s26, 0
    s_add_u32 s20, s24, 40960
    s_add_u32 s25, s20, s28
    s_add_u32 s45, s20, s29
    buffer_load_dwordx4 v3, s[8:11], s20 offen sc1 lds
    buffer_load_dwordx4 v3, s[8:11], s25 offen offset:1024 sc1 lds
    buffer_load_dwordx4 v3, s[8:11], s45 offen offset:2048 sc1 lds
    s_add_u32 m0, s27, 0
    s_add_u32 s20, s23, 512
    s_add_u32 s25, s23, 22016
    buffer_load_dwordx4 v4, s[4:7], s20 offen sc1 lds
    buffer_load_dwordx4 v4, s[4:7], s25 offen offset:1024 sc1 lds
    s_waitcnt vmcnt(20)
    s_barrier
    s_add_u32 m0, s26, 20480
    s_add_u32 s20, s24, 51200
    s_add_u32 s25, s20, s28
    s_add_u32 s45, s20, s29
    buffer_load_dwordx4 v3, s[8:11], s20 offen sc1 lds
    buffer_load_dwordx4 v3, s[8:11], s25 offen offset:1024 sc1 lds
    buffer_load_dwordx4 v3, s[8:11], s45 offen offset:2048 sc1 lds
    s_add_u32 m0, s27, 20480
    s_add_u32 s20, s23, 640
    s_add_u32 s25, s23, 22144
    buffer_load_dwordx4 v4, s[4:7], s20 offen sc1 lds
    buffer_load_dwordx4 v4, s[4:7], s25 offen offset:1024 sc1 lds
    s_waitcnt vmcnt(20)
    s_barrier
    s_add_u32 m0, s26, 40960
    s_add_u32 s20, s24, 61440
    s_add_u32 s25, s20, s28
    s_add_u32 s45, s20, s29
    buffer_load_dwordx4 v3, s[8:11], s20 offen sc1 lds
    buffer_load_dwordx4 v3, s[8:11], s25 offen offset:1024 sc1 lds
    buffer_load_dwordx4 v3, s[8:11], s45 offen offset:2048 sc1 lds
    s_add_u32 m0, s27, 40960
    s_add_u32 s20, s23, 768
    s_add_u32 s25, s23, 22272
    buffer_load_dwordx4 v4, s[4:7], s20 offen sc1 lds
    buffer_load_dwordx4 v4, s[4:7], s25 offen offset:1024 sc1 lds
    s_waitcnt vmcnt(20)
    s_barrier
    s_add_u32 m0, s26, 61440
    s_add_u32 s20, s24, 71680
    s_add_u32 s25, s20, s28
    s_add_u32 s45, s20, s29
    buffer_load_dwordx4 v3, s[8:11], s20 offen sc1 lds
    buffer_load_dwordx4 v3, s[8:11], s25 offen offset:1024 sc1 lds
    buffer_load_dwordx4 v3, s[8:11], s45 offen offset:2048 sc1 lds
    s_add_u32 m0, s27, 61440
    s_add_u32 s20, s23, 896
    s_add_u32 s25, s23, 22400
    buffer_load_dwordx4 v4, s[4:7], s20 offen sc1 lds
    buffer_load_dwordx4 v4, s[4:7], s25 offen offset:1024 sc1 lds
    s_waitcnt vmcnt(20)
    s_barrier
    s_add_u32 m0, s26, 81920
    s_add_u32 s20, s24, 81920
    s_add_u32 s25, s20, s28
    s_add_u32 s45, s20, s29
    buffer_load_dwordx4 v3, s[8:11], s20 offen sc1 lds
    buffer_load_dwordx4 v3, s[8:11], s25 offen offset:1024 sc1 lds
    buffer_load_dwordx4 v3, s[8:11], s45 offen offset:2048 sc1 lds
    s_add_u32 m0, s27, 81920
    s_add_u32 s20, s23, 1024
    s_add_u32 s25, s23, 22528
    buffer_load_dwordx4 v4, s[4:7], s20 offen sc1 lds
    buffer_load_dwordx4 v4, s[4:7], s25 offen offset:1024 sc1 lds
    s_waitcnt vmcnt(20)
    s_barrier
    s_add_u32 m0, s26, 102400
    s_add_u32 s20, s24, 92160
    s_add_u32 s25, s20, s28
    s_add_u32 s45, s20, s29
    buffer_load_dwordx4 v3, s[8:11], s20 offen sc1 lds
    buffer_load_dwordx4 v3, s[8:11], s25 offen offset:1024 sc1 lds
    buffer_load_dwordx4 v3, s[8:11], s45 offen offset:2048 sc1 lds
    s_add_u32 m0, s27, 102400
    s_add_u32 s20, s23, 1152
    s_add_u32 s25, s23, 22656
    buffer_load_dwordx4 v4, s[4:7], s20 offen sc1 lds
    buffer_load_dwordx4 v4, s[4:7], s25 offen offset:1024 sc1 lds
    s_waitcnt vmcnt(20)
    s_barrier
    s_add_u32 m0, s26, 0
    s_add_u32 s20, s24, 102400
    s_add_u32 s25, s20, s28
    s_add_u32 s45, s20, s29
    buffer_load_dwordx4 v3, s[8:11], s20 offen sc1 lds
    buffer_load_dwordx4 v3, s[8:11], s25 offen offset:1024 sc1 lds
    buffer_load_dwordx4 v3, s[8:11], s45 offen offset:2048 sc1 lds
    s_waitcnt vmcnt(18)
    s_barrier
    s_add_u32 m0, s26, 20480
    s_add_u32 s20, s24, 112640
    s_add_u32 s25, s20, s28
    s_add_u32 s45, s20, s29
    buffer_load_dwordx4 v3, s[8:11], s20 offen sc1 lds
    buffer_load_dwordx4 v3, s[8:11], s25 offen offset:1024 sc1 lds
    buffer_load_dwordx4 v3, s[8:11], s45 offen offset:2048 sc1 lds
    s_waitcnt vmcnt(16)
    s_barrier
    s_add_u32 m0, s26, 40960
    s_add_u32 s20, s24, 122880
    s_add_u32 s25, s20, s28
    s_add_u32 s45, s20, s29
    buffer_load_dwordx4 v3, s[8:11], s20 offen sc1 lds
    buffer_load_dwordx4 v3, s[8:11], s25 offen offset:1024 sc1 lds
    buffer_load_dwordx4 v3, s[8:11], s45 offen offset:2048 sc1 lds
    buffer_load_dwordx2 v[12:13], v8, s[12:15], 0 offen sc1
    s_waitcnt vmcnt(15)
    s_barrier
    s_waitcnt vmcnt(0)
    v_xor_b32 v12, s53, v12
    v_xor_b32 v13, s99, v13
    v_or_b32 v12, v12, v13
    v_cmp_ne_u32 vcc, 0, v12
    s_nop 4
    s_cbranch_vccz K34_ready
    s_mov_b32 s47, 0
K34_poll:
    s_sleep 8
    buffer_load_dwordx2 v[12:13], v8, s[12:15], 0 offen sc1
    s_waitcnt vmcnt(0)
    v_xor_b32 v12, s53, v12
    v_xor_b32 v13, s99, v13
    v_or_b32 v12, v12, v13
    v_cmp_ne_u32 vcc, 0, v12
    s_add_u32 s47, s47, 1
    s_nop 3
    s_cbranch_vccz K34_ready
    s_cmp_lt_u32 s47, 0x40000
    s_cbranch_scc1 K34_poll
K34_ready:
    s_add_u32 m0, s27, 0
    s_add_u32 s20, s52, 0
    s_add_u32 s25, s52, 2048
    buffer_load_dwordx4 v10, s[48:51], s20 offen sc1 lds
    buffer_load_dwordx4 v10, s[48:51], s25 offen offset:1024 sc1 lds
    s_add_u32 m0, s27, 20480
    s_add_u32 s20, s52, 128
    s_add_u32 s25, s52, 2176
    buffer_load_dwordx4 v10, s[48:51], s20 offen sc1 lds
    buffer_load_dwordx4 v10, s[48:51], s25 offen offset:1024 sc1 lds
    s_add_u32 m0, s27, 40960
    s_add_u32 s20, s52, 256
    s_add_u32 s25, s52, 2304
    buffer_load_dwordx4 v10, s[48:51], s20 offen sc1 lds
    buffer_load_dwordx4 v10, s[48:51], s25 offen offset:1024 sc1 lds
    s_add_u32 m0, s26, 61440
    s_add_u32 s20, s24, 133120
    s_add_u32 s25, s20, s28
    s_add_u32 s45, s20, s29
    buffer_load_dwordx4 v3, s[8:11], s20 offen sc1 lds
    buffer_load_dwordx4 v3, s[8:11], s25 offen offset:1024 sc1 lds
    buffer_load_dwordx4 v3, s[8:11], s45 offen offset:2048 sc1 lds
    s_add_u32 m0, s27, 61440
    s_add_u32 s20, s52, 24576
    s_add_u32 s25, s52, 26624
    buffer_load_dwordx4 v10, s[48:51], s20 offen sc1 lds
    buffer_load_dwordx4 v10, s[48:51], s25 offen offset:1024 sc1 lds
    s_waitcnt vmcnt(21)
    s_barrier
    s_add_u32 m0, s26, 81920
    s_add_u32 s20, s24, 143360
    s_add_u32 s25, s20, s28
    s_add_u32 s45, s20, s29
    buffer_load_dwordx4 v3, s[8:11], s20 offen sc1 lds
    buffer_load_dwordx4 v3, s[8:11], s25 offen offset:1024 sc1 lds
    buffer_load_dwordx4 v3, s[8:11], s45 offen offset:2048 sc1 lds
    s_add_u32 m0, s27, 81920
    s_add_u32 s20, s52, 24704
    s_add_u32 s25, s52, 26752
    buffer_load_dwordx4 v10, s[48:51], s20 offen sc1 lds
    buffer_load_dwordx4 v10, s[48:51], s25 offen offset:1024 sc1 lds
    s_waitcnt vmcnt(14)
    s_barrier
    s_add_u32 m0, s26, 102400
    s_add_u32 s20, s24, 153600
    s_add_u32 s25, s20, s28
    s_add_u32 s45, s20, s29
    buffer_load_dwordx4 v3, s[8:11], s20 offen sc1 lds
    buffer_load_dwordx4 v3, s[8:11], s25 offen offset:1024 sc1 lds
    buffer_load_dwordx4 v3, s[8:11], s45 offen offset:2048 sc1 lds
    s_add_u32 m0, s27, 102400
    s_add_u32 s20, s52, 24832
    s_add_u32 s25, s52, 26880
    buffer_load_dwordx4 v10, s[48:51], s20 offen sc1 lds
    buffer_load_dwordx4 v10, s[48:51], s25 offen offset:1024 sc1 lds
    s_waitcnt vmcnt(17)
    s_barrier
    s_add_u32 m0, s26, 0
    s_add_u32 s20, s24, 163840
    s_add_u32 s25, s20, s28
    s_add_u32 s45, s20, s29
    buffer_load_dwordx4 v3, s[8:11], s20 offen sc1 lds
    buffer_load_dwordx4 v3, s[8:11], s25 offen offset:1024 sc1 lds
    buffer_load_dwordx4 v3, s[8:11], s45 offen offset:2048 sc1 lds
    s_add_u32 m0, s27, 0
    s_add_u32 s20, s52, 49152
    s_add_u32 s25, s52, 51200
    buffer_load_dwordx4 v10, s[48:51], s20 offen sc1 lds
    buffer_load_dwordx4 v10, s[48:51], s25 offen offset:1024 sc1 lds
    s_waitcnt vmcnt(20)
    s_barrier
    s_add_u32 m0, s26, 20480
    s_add_u32 s20, s24, 174080
    s_add_u32 s25, s20, s28
    s_add_u32 s45, s20, s29
    buffer_load_dwordx4 v3, s[8:11], s20 offen sc1 lds
    buffer_load_dwordx4 v3, s[8:11], s25 offen offset:1024 sc1 lds
    buffer_load_dwordx4 v3, s[8:11], s45 offen offset:2048 sc1 lds
    s_add_u32 m0, s27, 20480
    s_add_u32 s20, s52, 49280
    s_add_u32 s25, s52, 51328
    buffer_load_dwordx4 v10, s[48:51], s20 offen sc1 lds
    buffer_load_dwordx4 v10, s[48:51], s25 offen offset:1024 sc1 lds
    s_waitcnt vmcnt(20)
    s_barrier
    s_add_u32 m0, s26, 40960
    s_add_u32 s20, s24, 184320
    s_add_u32 s25, s20, s28
    s_add_u32 s45, s20, s29
    buffer_load_dwordx4 v3, s[8:11], s20 offen sc1 lds
    buffer_load_dwordx4 v3, s[8:11], s25 offen offset:1024 sc1 lds
    buffer_load_dwordx4 v3, s[8:11], s45 offen offset:2048 sc1 lds
    s_add_u32 m0, s27, 40960
    s_add_u32 s20, s52, 49408
    s_add_u32 s25, s52, 51456
    buffer_load_dwordx4 v10, s[48:51], s20 offen sc1 lds
    buffer_load_dwordx4 v10, s[48:51], s25 offen offset:1024 sc1 lds
    s_waitcnt vmcnt(20)
    s_barrier
    s_add_u32 m0, s26, 61440
    s_add_u32 s20, s24, 194560
    s_add_u32 s25, s20, s28
    s_add_u32 s45, s20, s29
    buffer_load_dwordx4 v3, s[8:11], s20 offen sc1 lds
    buffer_load_dwordx4 v3, s[8:11], s25 offen offset:1024 sc1 lds
    buffer_load_dwordx4 v3, s[8:11], s45 offen offset:2048 sc1 lds
    s_add_u32 m0, s27, 61440
    s_add_u32 s20, s52, 73728
    s_add_u32 s25, s52, 75776
    buffer_load_dwordx4 v10, s[48:51], s20 offen sc1 lds
    buffer_load_dwordx4 v10, s[48:51], s25 offen offset:1024 sc1 lds
    s_waitcnt vmcnt(20)
    s_barrier
    s_add_u32 m0, s26, 81920
    s_add_u32 s20, s24, 204800
    s_add_u32 s25, s20, s28
    s_add_u32 s45, s20, s29
    buffer_load_dwordx4 v3, s[8:11], s20 offen sc1 lds
    buffer_load_dwordx4 v3, s[8:11], s25 offen offset:1024 sc1 lds
    buffer_load_dwordx4 v3, s[8:11], s45 offen offset:2048 sc1 lds
    s_add_u32 m0, s27, 81920
    s_add_u32 s20, s52, 73856
    s_add_u32 s25, s52, 75904
    buffer_load_dwordx4 v10, s[48:51], s20 offen sc1 lds
    buffer_load_dwordx4 v10, s[48:51], s25 offen offset:1024 sc1 lds
    s_waitcnt vmcnt(20)
    s_barrier
    s_add_u32 m0, s26, 102400
    s_add_u32 s20, s24, 215040
    s_add_u32 s25, s20, s28
    s_add_u32 s45, s20, s29
    buffer_load_dwordx4 v3, s[8:11], s20 offen sc1 lds
    buffer_load_dwordx4 v3, s[8:11], s25 offen offset:1024 sc1 lds
    buffer_load_dwordx4 v3, s[8:11], s45 offen offset:2048 sc1 lds
    s_add_u32 m0, s27, 102400
    s_add_u32 s20, s52, 73984
    s_add_u32 s25, s52, 76032
    buffer_load_dwordx4 v10, s[48:51], s20 offen sc1 lds
    buffer_load_dwordx4 v10, s[48:51], s25 offen offset:1024 sc1 lds
    s_waitcnt vmcnt(20)
    s_barrier
    s_waitcnt vmcnt(15)
    s_barrier
    s_waitcnt vmcnt(10)
    s_barrier
    s_waitcnt vmcnt(5)
    s_barrier
    s_waitcnt vmcnt(0)
    s_barrier
    s_barrier
    s_branch K34_end
K34_comp:
    s_and_b32 s46, s16, 1
    s_lshl_b32 s46, s46, 5
    s_lshr_b32 s47, s16, 1
    s_mul_i32 s47, s47, 3
    s_and_b32 s46, s16, 1
    s_lshl_b32 s46, s46, 5
    s_lshr_b32 s47, s16, 1
    s_mul_i32 s47, s47, 3
    s_mov_b32 s53, 122880
    v_mov_b32 v138, 136192
    v_mov_b32 v139, 0
    ds_write_b32 v138, v139
    v_and_b32 v4, 15, v0
    v_lshrrev_b32 v5, 4, v0
    v_and_b32 v6, 7, v4
    v_xor_b32 v5, v5, v6
    v_lshlrev_b32 v4, 7, v4
    v_lshl_add_u32 v4, v5, 4, v4
    s_lshl_b32 s20, s46, 7
    v_add_u32 v2, s20, v4
    v_xor_b32 v3, 64, v2
    v_and_b32 v6, 15, v0
    v_lshlrev_b32 v6, 3, v6
    v_and_b32 v7, 16, v0
    v_lshl_add_u32 v6, v7, 3, v6
    v_and_b32 v7, 32, v0
    v_lshl_add_u32 v6, v7, 4, v6
    s_lshl_b32 s20, s47, 11
    s_add_u32 s20, s20, 8192
    v_add_u32 v4, s20, v6
    v_add_u32 v5, 61440, v2
    v_add_u32 v6, 61440, v3
    v_add_u32 v7, 61440, v4
    v_mov_b32 v88, 0
    v_mov_b32 v89, 0
    v_mov_b32 v90, 0
    v_mov_b32 v91, 0
    v_mov_b32 v92, 0
    v_mov_b32 v93, 0
    v_mov_b32 v94, 0
    v_mov_b32 v95, 0
    v_mov_b32 v96, 0
    v_mov_b32 v97, 0
    v_mov_b32 v98, 0
    v_mov_b32 v99, 0
    v_mov_b32 v100, 0
    v_mov_b32 v101, 0
    v_mov_b32 v102, 0
    v_mov_b32 v103, 0
    v_mov_b32 v104, 0
    v_mov_b32 v105, 0
    v_mov_b32 v106, 0
    v_mov_b32 v107, 0
    v_mov_b32 v108, 0
    v_mov_b32 v109, 0
    v_mov_b32 v110, 0
    v_mov_b32 v111, 0
    s_barrier
    s_barrier
    ds_read_b128 v[8:11], v2 offset:0
    ds_read_b128 v[12:15], v2 offset:2048
    ds_read_b64_tr_b16 v[16:17], v4 offset:0
    ds_read_b64_tr_b16 v[18:19], v4 offset:256
    ds_read_b64_tr_b16 v[20:21], v4 offset:2048
    ds_read_b64_tr_b16 v[22:23], v4 offset:2304
    ds_read_b64_tr_b16 v[24:25], v4 offset:4096
    ds_read_b64_tr_b16 v[26:27], v4 offset:4352
    ds_read_b128 v[28:31], v3 offset:0
    ds_read_b128 v[32:35], v3 offset:2048
    ds_read_b64_tr_b16 v[36:37], v4 offset:1024
    ds_read_b64_tr_b16 v[38:39], v4 offset:1280
    ds_read_b64_tr_b16 v[40:41], v4 offset:3072
    ds_read_b64_tr_b16 v[42:43], v4 offset:3328
    ds_read_b64_tr_b16 v[44:45], v4 offset:5120
    ds_read_b64_tr_b16 v[46:47], v4 offset:5376
    s_waitcnt lgkmcnt(0)
    s_mov_b32 s19, 0
K34_cloop:
    s_barrier
    ds_read_b128 v[48:51], v2 offset:20480
    ds_read_b128 v[52:55], v2 offset:22528
    v_mfma_f32_16x16x32_bf16 v[88:91], v[16:19], v[8:11], v[88:91]
    ds_read_b64_tr_b16 v[56:57], v4 offset:20480
    ds_read_b64_tr_b16 v[58:59], v4 offset:20736
    v_mfma_f32_16x16x32_bf16 v[92:95], v[20:23], v[8:11], v[92:95]
    ds_read_b64_tr_b16 v[60:61], v4 offset:22528
    ds_read_b64_tr_b16 v[62:63], v4 offset:22784
    v_mfma_f32_16x16x32_bf16 v[96:99], v[24:27], v[8:11], v[96:99]
    ds_read_b64_tr_b16 v[64:65], v4 offset:24576
    ds_read_b64_tr_b16 v[66:67], v4 offset:24832
    v_mfma_f32_16x16x32_bf16 v[100:103], v[16:19], v[12:15], v[100:103]
    ds_read_b128 v[68:71], v3 offset:20480
    ds_read_b128 v[72:75], v3 offset:22528
    v_mfma_f32_16x16x32_bf16 v[104:107], v[20:23], v[12:15], v[104:107]
    ds_read_b64_tr_b16 v[76:77], v4 offset:21504
    ds_read_b64_tr_b16 v[78:79], v4 offset:21760
    v_mfma_f32_16x16x32_bf16 v[108:111], v[24:27], v[12:15], v[108:111]
    ds_read_b64_tr_b16 v[80:81], v4 offset:23552
    ds_read_b64_tr_b16 v[82:83], v4 offset:23808
    v_mfma_f32_16x16x32_bf16 v[88:91], v[36:39], v[28:31], v[88:91]
    ds_read_b64_tr_b16 v[84:85], v4 offset:25600
    ds_read_b64_tr_b16 v[86:87], v4 offset:25856
    v_mfma_f32_16x16x32_bf16 v[92:95], v[40:43], v[28:31], v[92:95]
    v_mfma_f32_16x16x32_bf16 v[96:99], v[44:47], v[28:31], v[96:99]
    v_mfma_f32_16x16x32_bf16 v[100:103], v[36:39], v[32:35], v[100:103]
    v_mfma_f32_16x16x32_bf16 v[104:107], v[40:43], v[32:35], v[104:107]
    v_mfma_f32_16x16x32_bf16 v[108:111], v[44:47], v[32:35], v[108:111]
    s_waitcnt lgkmcnt(0)
    s_barrier
    ds_read_b128 v[8:11], v2 offset:40960
    ds_read_b128 v[12:15], v2 offset:43008
    v_mfma_f32_16x16x32_bf16 v[88:91], v[56:59], v[48:51], v[88:91]
    ds_read_b64_tr_b16 v[16:17], v4 offset:40960
    ds_read_b64_tr_b16 v[18:19], v4 offset:41216
    v_mfma_f32_16x16x32_bf16 v[92:95], v[60:63], v[48:51], v[92:95]
    ds_read_b64_tr_b16 v[20:21], v4 offset:43008
    ds_read_b64_tr_b16 v[22:23], v4 offset:43264
    v_mfma_f32_16x16x32_bf16 v[96:99], v[64:67], v[48:51], v[96:99]
    ds_read_b64_tr_b16 v[24:25], v4 offset:45056
    ds_read_b64_tr_b16 v[26:27], v4 offset:45312
    v_mfma_f32_16x16x32_bf16 v[100:103], v[56:59], v[52:55], v[100:103]
    ds_read_b128 v[28:31], v3 offset:40960
    ds_read_b128 v[32:35], v3 offset:43008
    v_mfma_f32_16x16x32_bf16 v[104:107], v[60:63], v[52:55], v[104:107]
    ds_read_b64_tr_b16 v[36:37], v4 offset:41984
    ds_read_b64_tr_b16 v[38:39], v4 offset:42240
    v_mfma_f32_16x16x32_bf16 v[108:111], v[64:67], v[52:55], v[108:111]
    ds_read_b64_tr_b16 v[40:41], v4 offset:44032
    ds_read_b64_tr_b16 v[42:43], v4 offset:44288
    v_mfma_f32_16x16x32_bf16 v[88:91], v[76:79], v[68:71], v[88:91]
    ds_read_b64_tr_b16 v[44:45], v4 offset:46080
    ds_read_b64_tr_b16 v[46:47], v4 offset:46336
    v_mfma_f32_16x16x32_bf16 v[92:95], v[80:83], v[68:71], v[92:95]
    v_mfma_f32_16x16x32_bf16 v[96:99], v[84:87], v[68:71], v[96:99]
    v_mfma_f32_16x16x32_bf16 v[100:103], v[76:79], v[72:75], v[100:103]
    v_mfma_f32_16x16x32_bf16 v[104:107], v[80:83], v[72:75], v[104:107]
    v_mfma_f32_16x16x32_bf16 v[108:111], v[84:87], v[72:75], v[108:111]
    s_waitcnt lgkmcnt(0)
    s_barrier
    ds_read_b128 v[48:51], v5 offset:0
    ds_read_b128 v[52:55], v5 offset:2048
    v_mfma_f32_16x16x32_bf16 v[88:91], v[16:19], v[8:11], v[88:91]
    ds_read_b64_tr_b16 v[56:57], v7 offset:0
    ds_read_b64_tr_b16 v[58:59], v7 offset:256
    v_mfma_f32_16x16x32_bf16 v[92:95], v[20:23], v[8:11], v[92:95]
    ds_read_b64_tr_b16 v[60:61], v7 offset:2048
    ds_read_b64_tr_b16 v[62:63], v7 offset:2304
    v_mfma_f32_16x16x32_bf16 v[96:99], v[24:27], v[8:11], v[96:99]
    ds_read_b64_tr_b16 v[64:65], v7 offset:4096
    ds_read_b64_tr_b16 v[66:67], v7 offset:4352
    v_mfma_f32_16x16x32_bf16 v[100:103], v[16:19], v[12:15], v[100:103]
    ds_read_b128 v[68:71], v6 offset:0
    ds_read_b128 v[72:75], v6 offset:2048
    v_mfma_f32_16x16x32_bf16 v[104:107], v[20:23], v[12:15], v[104:107]
    ds_read_b64_tr_b16 v[76:77], v7 offset:1024
    ds_read_b64_tr_b16 v[78:79], v7 offset:1280
    v_mfma_f32_16x16x32_bf16 v[108:111], v[24:27], v[12:15], v[108:111]
    ds_read_b64_tr_b16 v[80:81], v7 offset:3072
    ds_read_b64_tr_b16 v[82:83], v7 offset:3328
    v_mfma_f32_16x16x32_bf16 v[88:91], v[36:39], v[28:31], v[88:91]
    ds_read_b64_tr_b16 v[84:85], v7 offset:5120
    ds_read_b64_tr_b16 v[86:87], v7 offset:5376
    v_mfma_f32_16x16x32_bf16 v[92:95], v[40:43], v[28:31], v[92:95]
    v_mfma_f32_16x16x32_bf16 v[96:99], v[44:47], v[28:31], v[96:99]
    v_mfma_f32_16x16x32_bf16 v[100:103], v[36:39], v[32:35], v[100:103]
    v_mfma_f32_16x16x32_bf16 v[104:107], v[40:43], v[32:35], v[104:107]
    v_mfma_f32_16x16x32_bf16 v[108:111], v[44:47], v[32:35], v[108:111]
    s_waitcnt lgkmcnt(0)
    s_barrier
    ds_read_b128 v[8:11], v5 offset:20480
    ds_read_b128 v[12:15], v5 offset:22528
    v_mfma_f32_16x16x32_bf16 v[88:91], v[56:59], v[48:51], v[88:91]
    ds_read_b64_tr_b16 v[16:17], v7 offset:20480
    ds_read_b64_tr_b16 v[18:19], v7 offset:20736
    v_mfma_f32_16x16x32_bf16 v[92:95], v[60:63], v[48:51], v[92:95]
    ds_read_b64_tr_b16 v[20:21], v7 offset:22528
    ds_read_b64_tr_b16 v[22:23], v7 offset:22784
    v_mfma_f32_16x16x32_bf16 v[96:99], v[64:67], v[48:51], v[96:99]
    ds_read_b64_tr_b16 v[24:25], v7 offset:24576
    ds_read_b64_tr_b16 v[26:27], v7 offset:24832
    v_mfma_f32_16x16x32_bf16 v[100:103], v[56:59], v[52:55], v[100:103]
    ds_read_b128 v[28:31], v6 offset:20480
    ds_read_b128 v[32:35], v6 offset:22528
    v_mfma_f32_16x16x32_bf16 v[104:107], v[60:63], v[52:55], v[104:107]
    ds_read_b64_tr_b16 v[36:37], v7 offset:21504
    ds_read_b64_tr_b16 v[38:39], v7 offset:21760
    v_mfma_f32_16x16x32_bf16 v[108:111], v[64:67], v[52:55], v[108:111]
    ds_read_b64_tr_b16 v[40:41], v7 offset:23552
    ds_read_b64_tr_b16 v[42:43], v7 offset:23808
    v_mfma_f32_16x16x32_bf16 v[88:91], v[76:79], v[68:71], v[88:91]
    ds_read_b64_tr_b16 v[44:45], v7 offset:25600
    ds_read_b64_tr_b16 v[46:47], v7 offset:25856
    v_mfma_f32_16x16x32_bf16 v[92:95], v[80:83], v[68:71], v[92:95]
    v_mfma_f32_16x16x32_bf16 v[96:99], v[84:87], v[68:71], v[96:99]
    v_mfma_f32_16x16x32_bf16 v[100:103], v[76:79], v[72:75], v[100:103]
    v_mfma_f32_16x16x32_bf16 v[104:107], v[80:83], v[72:75], v[104:107]
    v_mfma_f32_16x16x32_bf16 v[108:111], v[84:87], v[72:75], v[108:111]
    s_waitcnt lgkmcnt(0)
    s_barrier
    ds_read_b128 v[48:51], v5 offset:40960
    ds_read_b128 v[52:55], v5 offset:43008
    v_mfma_f32_16x16x32_bf16 v[88:91], v[16:19], v[8:11], v[88:91]
    ds_read_b64_tr_b16 v[56:57], v7 offset:40960
    ds_read_b64_tr_b16 v[58:59], v7 offset:41216
    v_mfma_f32_16x16x32_bf16 v[92:95], v[20:23], v[8:11], v[92:95]
    ds_read_b64_tr_b16 v[60:61], v7 offset:43008
    ds_read_b64_tr_b16 v[62:63], v7 offset:43264
    v_mfma_f32_16x16x32_bf16 v[96:99], v[24:27], v[8:11], v[96:99]
    ds_read_b64_tr_b16 v[64:65], v7 offset:45056
    ds_read_b64_tr_b16 v[66:67], v7 offset:45312
    v_mfma_f32_16x16x32_bf16 v[100:103], v[16:19], v[12:15], v[100:103]
    ds_read_b128 v[68:71], v6 offset:40960
    ds_read_b128 v[72:75], v6 offset:43008
    v_mfma_f32_16x16x32_bf16 v[104:107], v[20:23], v[12:15], v[104:107]
    ds_read_b64_tr_b16 v[76:77], v7 offset:41984
    ds_read_b64_tr_b16 v[78:79], v7 offset:42240
    v_mfma_f32_16x16x32_bf16 v[108:111], v[24:27], v[12:15], v[108:111]
    ds_read_b64_tr_b16 v[80:81], v7 offset:44032
    ds_read_b64_tr_b16 v[82:83], v7 offset:44288
    v_mfma_f32_16x16x32_bf16 v[88:91], v[36:39], v[28:31], v[88:91]
    ds_read_b64_tr_b16 v[84:85], v7 offset:46080
    ds_read_b64_tr_b16 v[86:87], v7 offset:46336
    v_mfma_f32_16x16x32_bf16 v[92:95], v[40:43], v[28:31], v[92:95]
    v_mfma_f32_16x16x32_bf16 v[96:99], v[44:47], v[28:31], v[96:99]
    v_mfma_f32_16x16x32_bf16 v[100:103], v[36:39], v[32:35], v[100:103]
    v_mfma_f32_16x16x32_bf16 v[104:107], v[40:43], v[32:35], v[104:107]
    v_mfma_f32_16x16x32_bf16 v[108:111], v[44:47], v[32:35], v[108:111]
    s_waitcnt lgkmcnt(0)
    s_barrier
    ds_read_b128 v[8:11], v2 offset:0
    ds_read_b128 v[12:15], v2 offset:2048
    v_mfma_f32_16x16x32_bf16 v[88:91], v[56:59], v[48:51], v[88:91]
    ds_read_b64_tr_b16 v[16:17], v4 offset:0
    ds_read_b64_tr_b16 v[18:19], v4 offset:256
    v_mfma_f32_16x16x32_bf16 v[92:95], v[60:63], v[48:51], v[92:95]
    ds_read_b64_tr_b16 v[20:21], v4 offset:2048
    ds_read_b64_tr_b16 v[22:23], v4 offset:2304
    v_mfma_f32_16x16x32_bf16 v[96:99], v[64:67], v[48:51], v[96:99]
    ds_read_b64_tr_b16 v[24:25], v4 offset:4096
    ds_read_b64_tr_b16 v[26:27], v4 offset:4352
    v_mfma_f32_16x16x32_bf16 v[100:103], v[56:59], v[52:55], v[100:103]
    ds_read_b128 v[28:31], v3 offset:0
    ds_read_b128 v[32:35], v3 offset:2048
    v_mfma_f32_16x16x32_bf16 v[104:107], v[60:63], v[52:55], v[104:107]
    ds_read_b64_tr_b16 v[36:37], v4 offset:1024
    ds_read_b64_tr_b16 v[38:39], v4 offset:1280
    v_mfma_f32_16x16x32_bf16 v[108:111], v[64:67], v[52:55], v[108:111]
    ds_read_b64_tr_b16 v[40:41], v4 offset:3072
    ds_read_b64_tr_b16 v[42:43], v4 offset:3328
    v_mfma_f32_16x16x32_bf16 v[88:91], v[76:79], v[68:71], v[88:91]
    ds_read_b64_tr_b16 v[44:45], v4 offset:5120
    ds_read_b64_tr_b16 v[46:47], v4 offset:5376
    v_mfma_f32_16x16x32_bf16 v[92:95], v[80:83], v[68:71], v[92:95]
    v_mfma_f32_16x16x32_bf16 v[96:99], v[84:87], v[68:71], v[96:99]
    v_mfma_f32_16x16x32_bf16 v[100:103], v[76:79], v[72:75], v[100:103]
    v_mfma_f32_16x16x32_bf16 v[104:107], v[80:83], v[72:75], v[104:107]
    v_mfma_f32_16x16x32_bf16 v[108:111], v[84:87], v[72:75], v[108:111]
    s_waitcnt lgkmcnt(0)
    s_add_u32 s19, s19, 1
    s_cmp_lt_u32 s19, 3
    s_cbranch_scc1 K34_cloop
    s_add_u32 s12, s32, 24576000
    s_addc_u32 s13, s33, 0
    s_mov_b32 s14, 1024
    s_mov_b32 s15, 0x20000
    s_add_u32 s4, s32, 24641536
    s_addc_u32 s5, s33, 0
    s_mov_b32 s6, 1024
    s_mov_b32 s7, 0x20000
    v_lshlrev_b32 v112, 4, v0
    s_lshr_b32 s48, s40, 1
    s_lshl_b32 s48, s48, 6
    v_and_b32 v113, 7, v0
    v_lshlrev_b32 v113, 3, v113
    v_add_u32 v113, s48, v113
    s_cmp_lg_u32 s16, 0
    s_cbranch_scc1 K34_nf1
    buffer_load_dwordx4 v[116:119], v112, s[12:15], 0 offen sc1
    buffer_load_dwordx2 v[120:121], v113, s[4:7], 0 offen sc1
K34_nf1:
    s_barrier
    ds_read_b128 v[48:51], v2 offset:20480
    ds_read_b128 v[52:55], v2 offset:22528
    v_mfma_f32_16x16x32_bf16 v[88:91], v[16:19], v[8:11], v[88:91]
    ds_read_b64_tr_b16 v[56:57], v4 offset:20480
    ds_read_b64_tr_b16 v[58:59], v4 offset:20736
    v_mfma_f32_16x16x32_bf16 v[92:95], v[20:23], v[8:11], v[92:95]
    ds_read_b64_tr_b16 v[60:61], v4 offset:22528
    ds_read_b64_tr_b16 v[62:63], v4 offset:22784
    v_mfma_f32_16x16x32_bf16 v[96:99], v[24:27], v[8:11], v[96:99]
    ds_read_b64_tr_b16 v[64:65], v4 offset:24576
    ds_read_b64_tr_b16 v[66:67], v4 offset:24832
    v_mfma_f32_16x16x32_bf16 v[100:103], v[16:19], v[12:15], v[100:103]
    ds_read_b128 v[68:71], v3 offset:20480
    ds_read_b128 v[72:75], v3 offset:22528
    v_mfma_f32_16x16x32_bf16 v[104:107], v[20:23], v[12:15], v[104:107]
    ds_read_b64_tr_b16 v[76:77], v4 offset:21504
    ds_read_b64_tr_b16 v[78:79], v4 offset:21760
    v_mfma_f32_16x16x32_bf16 v[108:111], v[24:27], v[12:15], v[108:111]
    ds_read_b64_tr_b16 v[80:81], v4 offset:23552
    ds_read_b64_tr_b16 v[82:83], v4 offset:23808
    v_mfma_f32_16x16x32_bf16 v[88:91], v[36:39], v[28:31], v[88:91]
    ds_read_b64_tr_b16 v[84:85], v4 offset:25600
    ds_read_b64_tr_b16 v[86:87], v4 offset:25856
    v_mfma_f32_16x16x32_bf16 v[92:95], v[40:43], v[28:31], v[92:95]
    v_mfma_f32_16x16x32_bf16 v[96:99], v[44:47], v[28:31], v[96:99]
    v_mfma_f32_16x16x32_bf16 v[100:103], v[36:39], v[32:35], v[100:103]
    v_mfma_f32_16x16x32_bf16 v[104:107], v[40:43], v[32:35], v[104:107]
    v_mfma_f32_16x16x32_bf16 v[108:111], v[44:47], v[32:35], v[108:111]
    s_waitcnt lgkmcnt(0)
    s_barrier
    ds_read_b128 v[8:11], v2 offset:40960
    ds_read_b128 v[12:15], v2 offset:43008
    v_mfma_f32_16x16x32_bf16 v[88:91], v[56:59], v[48:51], v[88:91]
    ds_read_b64_tr_b16 v[16:17], v4 offset:40960
    ds_read_b64_tr_b16 v[18:19], v4 offset:41216
    v_mfma_f32_16x16x32_bf16 v[92:95], v[60:63], v[48:51], v[92:95]
    ds_read_b64_tr_b16 v[20:21], v4 offset:43008
    ds_read_b64_tr_b16 v[22:23], v4 offset:43264
    v_mfma_f32_16x16x32_bf16 v[96:99], v[64:67], v[48:51], v[96:99]
    ds_read_b64_tr_b16 v[24:25], v4 offset:45056
    ds_read_b64_tr_b16 v[26:27], v4 offset:45312
    v_mfma_f32_16x16x32_bf16 v[100:103], v[56:59], v[52:55], v[100:103]
    ds_read_b128 v[28:31], v3 offset:40960
    ds_read_b128 v[32:35], v3 offset:43008
    v_mfma_f32_16x16x32_bf16 v[104:107], v[60:63], v[52:55], v[104:107]
    ds_read_b64_tr_b16 v[36:37], v4 offset:41984
    ds_read_b64_tr_b16 v[38:39], v4 offset:42240
    v_mfma_f32_16x16x32_bf16 v[108:111], v[64:67], v[52:55], v[108:111]
    ds_read_b64_tr_b16 v[40:41], v4 offset:44032
    ds_read_b64_tr_b16 v[42:43], v4 offset:44288
    v_mfma_f32_16x16x32_bf16 v[88:91], v[76:79], v[68:71], v[88:91]
    ds_read_b64_tr_b16 v[44:45], v4 offset:46080
    ds_read_b64_tr_b16 v[46:47], v4 offset:46336
    v_mfma_f32_16x16x32_bf16 v[92:95], v[80:83], v[68:71], v[92:95]
    v_mfma_f32_16x16x32_bf16 v[96:99], v[84:87], v[68:71], v[96:99]
    v_mfma_f32_16x16x32_bf16 v[100:103], v[76:79], v[72:75], v[100:103]
    v_mfma_f32_16x16x32_bf16 v[104:107], v[80:83], v[72:75], v[104:107]
    v_mfma_f32_16x16x32_bf16 v[108:111], v[84:87], v[72:75], v[108:111]
    s_waitcnt lgkmcnt(0)
    s_cmp_lg_u32 s16, 0
    s_cbranch_scc1 K34_nf2
    s_add_u32 s45, s98, 1
    s_mov_b32 s49, 0
K34_lc:
    s_waitcnt vmcnt(0)
    v_xor_b32 v116, s45, v116
    v_xor_b32 v117, s99, v117
    v_xor_b32 v118, s45, v118
    v_xor_b32 v119, s99, v119
    v_xor_b32 v120, s45, v120
    v_xor_b32 v121, s99, v121
    v_or3_b32 v116, v116, v117, v118
    v_or3_b32 v116, v116, v119, v120
    v_or_b32 v116, v116, v121
    v_cmp_ne_u32 vcc, 0, v116
    s_add_u32 s49, s49, 1
    s_nop 3
    s_cbranch_vccz K34_lcok
    s_cmp_ge_u32 s49, 0x10000
    s_cbranch_scc1 K34_lcok
    buffer_load_dwordx4 v[116:119], v112, s[12:15], 0 offen sc1
    buffer_load_dwordx2 v[120:121], v113, s[4:7], 0 offen sc1
    s_branch K34_lc
K34_lcok:
K34_nf2:
    s_barrier
    ds_read_b128 v[48:51], v5 offset:0
    ds_read_b128 v[52:55], v5 offset:2048
    v_mfma_f32_16x16x32_bf16 v[88:91], v[16:19], v[8:11], v[88:91]
    ds_read_b64_tr_b16 v[56:57], v7 offset:0
    ds_read_b64_tr_b16 v[58:59], v7 offset:256
    v_mfma_f32_16x16x32_bf16 v[92:95], v[20:23], v[8:11], v[92:95]
    ds_read_b64_tr_b16 v[60:61], v7 offset:2048
    ds_read_b64_tr_b16 v[62:63], v7 offset:2304
    v_mfma_f32_16x16x32_bf16 v[96:99], v[24:27], v[8:11], v[96:99]
    ds_read_b64_tr_b16 v[64:65], v7 offset:4096
    ds_read_b64_tr_b16 v[66:67], v7 offset:4352
    v_mfma_f32_16x16x32_bf16 v[100:103], v[16:19], v[12:15], v[100:103]
    ds_read_b128 v[68:71], v6 offset:0
    ds_read_b128 v[72:75], v6 offset:2048
    v_mfma_f32_16x16x32_bf16 v[104:107], v[20:23], v[12:15], v[104:107]
    ds_read_b64_tr_b16 v[76:77], v7 offset:1024
    ds_read_b64_tr_b16 v[78:79], v7 offset:1280
    v_mfma_f32_16x16x32_bf16 v[108:111], v[24:27], v[12:15], v[108:111]
    ds_read_b64_tr_b16 v[80:81], v7 offset:3072
    ds_read_b64_tr_b16 v[82:83], v7 offset:3328
    v_mfma_f32_16x16x32_bf16 v[88:91], v[36:39], v[28:31], v[88:91]
    ds_read_b64_tr_b16 v[84:85], v7 offset:5120
    ds_read_b64_tr_b16 v[86:87], v7 offset:5376
    v_mfma_f32_16x16x32_bf16 v[92:95], v[40:43], v[28:31], v[92:95]
    v_mfma_f32_16x16x32_bf16 v[96:99], v[44:47], v[28:31], v[96:99]
    v_mfma_f32_16x16x32_bf16 v[100:103], v[36:39], v[32:35], v[100:103]
    v_mfma_f32_16x16x32_bf16 v[104:107], v[40:43], v[32:35], v[104:107]
    v_mfma_f32_16x16x32_bf16 v[108:111], v[44:47], v[32:35], v[108:111]
    s_waitcnt lgkmcnt(0)
    s_add_u32 s4, s32, 9437184
    s_addc_u32 s5, s33, 0
    s_mov_b32 s6, 3145728
    s_mov_b32 s7, 0x20000
    s_add_u32 s8, s32, 24379392
    s_addc_u32 s9, s33, 0
    s_mov_b32 s10, 8192
    s_mov_b32 s11, 0x20000
    s_mov_b32 s12, s34
    s_mov_b32 s13, s35
    s_mov_b32 s14, 4096
    s_mov_b32 s15, 0x20000
    s_lshl_b32 s43, s40, 6
    s_add_u32 s43, s43, s46
    v_and_b32 v112, 15, v0
    v_add_u32 v112, s43, v112
    v_lshrrev_b32 v113, 4, v0
    s_lshr_b32 s48, s43, 5
    s_mul_i32 s48, s48, 48
    s_mul_i32 s49, s41, 6
    s_add_u32 s48, s48, s49
    s_add_u32 s48, s48, s47
    s_lshl_b32 s48, s48, 10
    v_lshlrev_b32 v114, 4, v0
    buffer_load_dwordx4 v[116:119], v114, s[4:7], s48 offen offset:0 sc1
    buffer_load_dwordx4 v[120:123], v114, s[4:7], s48 offen offset:1024 sc1
    s_barrier
    ds_read_b128 v[8:11], v5 offset:20480
    ds_read_b128 v[12:15], v5 offset:22528
    v_mfma_f32_16x16x32_bf16 v[88:91], v[56:59], v[48:51], v[88:91]
    ds_read_b64_tr_b16 v[16:17], v7 offset:20480
    ds_read_b64_tr_b16 v[18:19], v7 offset:20736
    v_mfma_f32_16x16x32_bf16 v[92:95], v[60:63], v[48:51], v[92:95]
    ds_read_b64_tr_b16 v[20:21], v7 offset:22528
    ds_read_b64_tr_b16 v[22:23], v7 offset:22784
    v_mfma_f32_16x16x32_bf16 v[96:99], v[64:67], v[48:51], v[96:99]
    ds_read_b64_tr_b16 v[24:25], v7 offset:24576
    ds_read_b64_tr_b16 v[26:27], v7 offset:24832
    v_mfma_f32_16x16x32_bf16 v[100:103], v[56:59], v[52:55], v[100:103]
    ds_read_b128 v[28:31], v6 offset:20480
    ds_read_b128 v[32:35], v6 offset:22528
    v_mfma_f32_16x16x32_bf16 v[104:107], v[60:63], v[52:55], v[104:107]
    ds_read_b64_tr_b16 v[36:37], v7 offset:21504
    ds_read_b64_tr_b16 v[38:39], v7 offset:21760
    v_mfma_f32_16x16x32_bf16 v[108:111], v[64:67], v[52:55], v[108:111]
    ds_read_b64_tr_b16 v[40:41], v7 offset:23552
    ds_read_b64_tr_b16 v[42:43], v7 offset:23808
    v_mfma_f32_16x16x32_bf16 v[88:91], v[76:79], v[68:71], v[88:91]
    ds_read_b64_tr_b16 v[44:45], v7 offset:25600
    ds_read_b64_tr_b16 v[46:47], v7 offset:25856
    v_mfma_f32_16x16x32_bf16 v[92:95], v[80:83], v[68:71], v[92:95]
    v_mfma_f32_16x16x32_bf16 v[96:99], v[84:87], v[68:71], v[96:99]
    v_mfma_f32_16x16x32_bf16 v[100:103], v[76:79], v[72:75], v[100:103]
    v_mfma_f32_16x16x32_bf16 v[104:107], v[80:83], v[72:75], v[104:107]
    v_mfma_f32_16x16x32_bf16 v[108:111], v[84:87], v[72:75], v[108:111]
    s_waitcnt lgkmcnt(0)
    buffer_load_dwordx4 v[124:127], v114, s[4:7], s48 offen offset:2048 sc1
    v_lshlrev_b32 v115, 2, v112
    buffer_load_dword v128, v115, s[8:11], 0 offen sc1
    s_barrier
    ds_read_b128 v[48:51], v5 offset:40960
    ds_read_b128 v[52:55], v5 offset:43008
    v_mfma_f32_16x16x32_bf16 v[88:91], v[16:19], v[8:11], v[88:91]
    ds_read_b64_tr_b16 v[56:57], v7 offset:40960
    ds_read_b64_tr_b16 v[58:59], v7 offset:41216
    v_mfma_f32_16x16x32_bf16 v[92:95], v[20:23], v[8:11], v[92:95]
    ds_read_b64_tr_b16 v[60:61], v7 offset:43008
    ds_read_b64_tr_b16 v[62:63], v7 offset:43264
    v_mfma_f32_16x16x32_bf16 v[96:99], v[24:27], v[8:11], v[96:99]
    ds_read_b64_tr_b16 v[64:65], v7 offset:45056
    ds_read_b64_tr_b16 v[66:67], v7 offset:45312
    v_mfma_f32_16x16x32_bf16 v[100:103], v[16:19], v[12:15], v[100:103]
    ds_read_b128 v[68:71], v6 offset:40960
    ds_read_b128 v[72:75], v6 offset:43008
    v_mfma_f32_16x16x32_bf16 v[104:107], v[20:23], v[12:15], v[104:107]
    ds_read_b64_tr_b16 v[76:77], v7 offset:41984
    ds_read_b64_tr_b16 v[78:79], v7 offset:42240
    v_mfma_f32_16x16x32_bf16 v[108:111], v[24:27], v[12:15], v[108:111]
    ds_read_b64_tr_b16 v[80:81], v7 offset:44032
    ds_read_b64_tr_b16 v[82:83], v7 offset:44288
    v_mfma_f32_16x16x32_bf16 v[88:91], v[36:39], v[28:31], v[88:91]
    ds_read_b64_tr_b16 v[84:85], v7 offset:46080
    ds_read_b64_tr_b16 v[86:87], v7 offset:46336
    v_mfma_f32_16x16x32_bf16 v[92:95], v[40:43], v[28:31], v[92:95]
    v_mfma_f32_16x16x32_bf16 v[96:99], v[44:47], v[28:31], v[96:99]
    v_mfma_f32_16x16x32_bf16 v[100:103], v[36:39], v[32:35], v[100:103]
    v_mfma_f32_16x16x32_bf16 v[104:107], v[40:43], v[32:35], v[104:107]
    v_mfma_f32_16x16x32_bf16 v[108:111], v[44:47], v[32:35], v[108:111]
    s_waitcnt lgkmcnt(0)
    buffer_load_dword v129, v115, s[8:11], 0 offen offset:64 sc1
    v_lshlrev_b32 v115, 1, v112
    buffer_load_ushort v130, v115, s[12:15], 0 offen
    s_barrier
    ds_read_b128 v[8:11], v2 offset:0
    ds_read_b128 v[12:15], v2 offset:2048
    v_mfma_f32_16x16x32_bf16 v[88:91], v[56:59], v[48:51], v[88:91]
    ds_read_b64_tr_b16 v[16:17], v4 offset:0
    ds_read_b64_tr_b16 v[18:19], v4 offset:256
    v_mfma_f32_16x16x32_bf16 v[92:95], v[60:63], v[48:51], v[92:95]
    ds_read_b64_tr_b16 v[20:21], v4 offset:2048
    ds_read_b64_tr_b16 v[22:23], v4 offset:2304
    v_mfma_f32_16x16x32_bf16 v[96:99], v[64:67], v[48:51], v[96:99]
    ds_read_b64_tr_b16 v[24:25], v4 offset:4096
    ds_read_b64_tr_b16 v[26:27], v4 offset:4352
    v_mfma_f32_16x16x32_bf16 v[100:103], v[56:59], v[52:55], v[100:103]
    ds_read_b128 v[28:31], v3 offset:0
    ds_read_b128 v[32:35], v3 offset:2048
    v_mfma_f32_16x16x32_bf16 v[104:107], v[60:63], v[52:55], v[104:107]
    ds_read_b64_tr_b16 v[36:37], v4 offset:1024
    ds_read_b64_tr_b16 v[38:39], v4 offset:1280
    v_mfma_f32_16x16x32_bf16 v[108:111], v[64:67], v[52:55], v[108:111]
    ds_read_b64_tr_b16 v[40:41], v4 offset:3072
    ds_read_b64_tr_b16 v[42:43], v4 offset:3328
    v_mfma_f32_16x16x32_bf16 v[88:91], v[76:79], v[68:71], v[88:91]
    ds_read_b64_tr_b16 v[44:45], v4 offset:5120
    ds_read_b64_tr_b16 v[46:47], v4 offset:5376
    v_mfma_f32_16x16x32_bf16 v[92:95], v[80:83], v[68:71], v[92:95]
    v_mfma_f32_16x16x32_bf16 v[96:99], v[84:87], v[68:71], v[96:99]
    v_mfma_f32_16x16x32_bf16 v[100:103], v[76:79], v[72:75], v[100:103]
    v_mfma_f32_16x16x32_bf16 v[104:107], v[80:83], v[72:75], v[104:107]
    v_mfma_f32_16x16x32_bf16 v[108:111], v[84:87], v[72:75], v[108:111]
    s_waitcnt lgkmcnt(0)
    buffer_load_ushort v131, v115, s[12:15], 0 offen offset:32
    s_lshl_b32 s50, s40, 6
    s_lshl_b32 s51, s16, 4
    s_add_u32 s50, s50, s51
    v_and_b32 v137, 15, v0
    v_add_u32 v137, s50, v137
    v_lshlrev_b32 v138, 2, v137
    buffer_load_dword v136, v138, s[8:11], 0 offen sc1
    s_barrier
    ds_read_b128 v[48:51], v2 offset:20480
    ds_read_b128 v[52:55], v2 offset:22528
    v_mfma_f32_16x16x32_bf16 v[88:91], v[16:19], v[8:11], v[88:91]
    ds_read_b64_tr_b16 v[56:57], v4 offset:20480
    ds_read_b64_tr_b16 v[58:59], v4 offset:20736
    v_mfma_f32_16x16x32_bf16 v[92:95], v[20:23], v[8:11], v[92:95]
    ds_read_b64_tr_b16 v[60:61], v4 offset:22528
    ds_read_b64_tr_b16 v[62:63], v4 offset:22784
    v_mfma_f32_16x16x32_bf16 v[96:99], v[24:27], v[8:11], v[96:99]
    ds_read_b64_tr_b16 v[64:65], v4 offset:24576
    ds_read_b64_tr_b16 v[66:67], v4 offset:24832
    v_mfma_f32_16x16x32_bf16 v[100:103], v[16:19], v[12:15], v[100:103]
    ds_read_b128 v[68:71], v3 offset:20480
    ds_read_b128 v[72:75], v3 offset:22528
    v_mfma_f32_16x16x32_bf16 v[104:107], v[20:23], v[12:15], v[104:107]
    ds_read_b64_tr_b16 v[76:77], v4 offset:21504
    ds_read_b64_tr_b16 v[78:79], v4 offset:21760
    v_mfma_f32_16x16x32_bf16 v[108:111], v[24:27], v[12:15], v[108:111]
    ds_read_b64_tr_b16 v[80:81], v4 offset:23552
    ds_read_b64_tr_b16 v[82:83], v4 offset:23808
    v_mfma_f32_16x16x32_bf16 v[88:91], v[36:39], v[28:31], v[88:91]
    ds_read_b64_tr_b16 v[84:85], v4 offset:25600
    ds_read_b64_tr_b16 v[86:87], v4 offset:25856
    v_mfma_f32_16x16x32_bf16 v[92:95], v[40:43], v[28:31], v[92:95]
    v_mfma_f32_16x16x32_bf16 v[96:99], v[44:47], v[28:31], v[96:99]
    v_mfma_f32_16x16x32_bf16 v[100:103], v[36:39], v[32:35], v[100:103]
    v_mfma_f32_16x16x32_bf16 v[104:107], v[40:43], v[32:35], v[104:107]
    v_mfma_f32_16x16x32_bf16 v[108:111], v[44:47], v[32:35], v[108:111]
    s_waitcnt lgkmcnt(0)
    s_barrier
    ds_read_b128 v[8:11], v2 offset:40960
    ds_read_b128 v[12:15], v2 offset:43008
    v_mfma_f32_16x16x32_bf16 v[88:91], v[56:59], v[48:51], v[88:91]
    ds_read_b64_tr_b16 v[16:17], v4 offset:40960
    ds_read_b64_tr_b16 v[18:19], v4 offset:41216
    v_mfma_f32_16x16x32_bf16 v[92:95], v[60:63], v[48:51], v[92:95]
    ds_read_b64_tr_b16 v[20:21], v4 offset:43008
    ds_read_b64_tr_b16 v[22:23], v4 offset:43264
    v_mfma_f32_16x16x32_bf16 v[96:99], v[64:67], v[48:51], v[96:99]
    ds_read_b64_tr_b16 v[24:25], v4 offset:45056
    ds_read_b64_tr_b16 v[26:27], v4 offset:45312
    v_mfma_f32_16x16x32_bf16 v[100:103], v[56:59], v[52:55], v[100:103]
    ds_read_b128 v[28:31], v3 offset:40960
    ds_read_b128 v[32:35], v3 offset:43008
    v_mfma_f32_16x16x32_bf16 v[104:107], v[60:63], v[52:55], v[104:107]
    ds_read_b64_tr_b16 v[36:37], v4 offset:41984
    ds_read_b64_tr_b16 v[38:39], v4 offset:42240
    v_mfma_f32_16x16x32_bf16 v[108:111], v[64:67], v[52:55], v[108:111]
    ds_read_b64_tr_b16 v[40:41], v4 offset:44032
    ds_read_b64_tr_b16 v[42:43], v4 offset:44288
    v_mfma_f32_16x16x32_bf16 v[88:91], v[76:79], v[68:71], v[88:91]
    ds_read_b64_tr_b16 v[44:45], v4 offset:46080
    ds_read_b64_tr_b16 v[46:47], v4 offset:46336
    v_mfma_f32_16x16x32_bf16 v[92:95], v[80:83], v[68:71], v[92:95]
    v_mfma_f32_16x16x32_bf16 v[96:99], v[84:87], v[68:71], v[96:99]
    v_mfma_f32_16x16x32_bf16 v[100:103], v[76:79], v[72:75], v[100:103]
    v_mfma_f32_16x16x32_bf16 v[104:107], v[80:83], v[72:75], v[104:107]
    v_mfma_f32_16x16x32_bf16 v[108:111], v[84:87], v[72:75], v[108:111]
    s_waitcnt lgkmcnt(0)
    s_barrier
    ds_read_b128 v[48:51], v5 offset:0
    ds_read_b128 v[52:55], v5 offset:2048
    v_mfma_f32_16x16x32_bf16 v[88:91], v[16:19], v[8:11], v[88:91]
    ds_read_b64_tr_b16 v[56:57], v7 offset:0
    ds_read_b64_tr_b16 v[58:59], v7 offset:256
    v_mfma_f32_16x16x32_bf16 v[92:95], v[20:23], v[8:11], v[92:95]
    ds_read_b64_tr_b16 v[60:61], v7 offset:2048
    ds_read_b64_tr_b16 v[62:63], v7 offset:2304
    v_mfma_f32_16x16x32_bf16 v[96:99], v[24:27], v[8:11], v[96:99]
    ds_read_b64_tr_b16 v[64:65], v7 offset:4096
    ds_read_b64_tr_b16 v[66:67], v7 offset:4352
    v_mfma_f32_16x16x32_bf16 v[100:103], v[16:19], v[12:15], v[100:103]
    ds_read_b128 v[68:71], v6 offset:0
    ds_read_b128 v[72:75], v6 offset:2048
    v_mfma_f32_16x16x32_bf16 v[104:107], v[20:23], v[12:15], v[104:107]
    ds_read_b64_tr_b16 v[76:77], v7 offset:1024
    ds_read_b64_tr_b16 v[78:79], v7 offset:1280
    v_mfma_f32_16x16x32_bf16 v[108:111], v[24:27], v[12:15], v[108:111]
    ds_read_b64_tr_b16 v[80:81], v7 offset:3072
    ds_read_b64_tr_b16 v[82:83], v7 offset:3328
    v_mfma_f32_16x16x32_bf16 v[88:91], v[36:39], v[28:31], v[88:91]
    ds_read_b64_tr_b16 v[84:85], v7 offset:5120
    ds_read_b64_tr_b16 v[86:87], v7 offset:5376
    v_mfma_f32_16x16x32_bf16 v[92:95], v[40:43], v[28:31], v[92:95]
    v_mfma_f32_16x16x32_bf16 v[96:99], v[44:47], v[28:31], v[96:99]
    v_mfma_f32_16x16x32_bf16 v[100:103], v[36:39], v[32:35], v[100:103]
    v_mfma_f32_16x16x32_bf16 v[104:107], v[40:43], v[32:35], v[104:107]
    v_mfma_f32_16x16x32_bf16 v[108:111], v[44:47], v[32:35], v[108:111]
    s_waitcnt lgkmcnt(0)
    s_waitcnt vmcnt(0)
    v_lshlrev_b32 v132, 16, v130
    v_mov_b32 v133, v132
    v_sub_f32 v128, 1.0, v128
    v_lshlrev_b32 v134, 16, v131
    v_mov_b32 v135, v134
    v_sub_f32 v129, 1.0, v129
    v_lshlrev_b32 v188, 16, v116
    v_and_b32 v189, 0xffff0000, v116
    v_lshlrev_b32 v190, 16, v117
    v_and_b32 v191, 0xffff0000, v117
    v_lshlrev_b32 v192, 16, v120
    v_and_b32 v193, 0xffff0000, v120
    v_lshlrev_b32 v194, 16, v121
    v_and_b32 v195, 0xffff0000, v121
    v_lshlrev_b32 v196, 16, v124
    v_and_b32 v197, 0xffff0000, v124
    v_lshlrev_b32 v198, 16, v125
    v_and_b32 v199, 0xffff0000, v125
    v_lshlrev_b32 v200, 16, v118
    v_and_b32 v201, 0xffff0000, v118
    v_lshlrev_b32 v202, 16, v119
    v_and_b32 v203, 0xffff0000, v119
    v_lshlrev_b32 v204, 16, v122
    v_and_b32 v205, 0xffff0000, v122
    s_barrier
    ds_read_b128 v[8:11], v5 offset:20480
    ds_read_b128 v[12:15], v5 offset:22528
    v_mfma_f32_16x16x32_bf16 v[88:91], v[56:59], v[48:51], v[88:91]
    ds_read_b64_tr_b16 v[16:17], v7 offset:20480
    ds_read_b64_tr_b16 v[18:19], v7 offset:20736
    v_mfma_f32_16x16x32_bf16 v[92:95], v[60:63], v[48:51], v[92:95]
    ds_read_b64_tr_b16 v[20:21], v7 offset:22528
    ds_read_b64_tr_b16 v[22:23], v7 offset:22784
    v_mfma_f32_16x16x32_bf16 v[96:99], v[64:67], v[48:51], v[96:99]
    ds_read_b64_tr_b16 v[24:25], v7 offset:24576
    ds_read_b64_tr_b16 v[26:27], v7 offset:24832
    v_mfma_f32_16x16x32_bf16 v[100:103], v[56:59], v[52:55], v[100:103]
    ds_read_b128 v[28:31], v6 offset:20480
    ds_read_b128 v[32:35], v6 offset:22528
    v_mfma_f32_16x16x32_bf16 v[104:107], v[60:63], v[52:55], v[104:107]
    ds_read_b64_tr_b16 v[36:37], v7 offset:21504
    ds_read_b64_tr_b16 v[38:39], v7 offset:21760
    v_mfma_f32_16x16x32_bf16 v[108:111], v[64:67], v[52:55], v[108:111]
    ds_read_b64_tr_b16 v[40:41], v7 offset:23552
    ds_read_b64_tr_b16 v[42:43], v7 offset:23808
    v_mfma_f32_16x16x32_bf16 v[88:91], v[76:79], v[68:71], v[88:91]
    ds_read_b64_tr_b16 v[44:45], v7 offset:25600
    ds_read_b64_tr_b16 v[46:47], v7 offset:25856
    v_mfma_f32_16x16x32_bf16 v[92:95], v[80:83], v[68:71], v[92:95]
    v_mfma_f32_16x16x32_bf16 v[96:99], v[84:87], v[68:71], v[96:99]
    v_mfma_f32_16x16x32_bf16 v[100:103], v[76:79], v[72:75], v[100:103]
    v_mfma_f32_16x16x32_bf16 v[104:107], v[80:83], v[72:75], v[104:107]
    v_mfma_f32_16x16x32_bf16 v[108:111], v[84:87], v[72:75], v[108:111]
    s_waitcnt lgkmcnt(0)
    v_lshlrev_b32 v206, 16, v123
    v_and_b32 v207, 0xffff0000, v123
    v_lshlrev_b32 v208, 16, v126
    v_and_b32 v209, 0xffff0000, v126
    v_lshlrev_b32 v210, 16, v127
    v_and_b32 v211, 0xffff0000, v127
    v_mul_f32 v188, v188, v128
    v_mul_f32 v189, v189, v128
    v_mul_f32 v190, v190, v128
    v_mul_f32 v191, v191, v128
    v_mul_f32 v192, v192, v128
    v_mul_f32 v193, v193, v128
    v_mul_f32 v194, v194, v128
    v_mul_f32 v195, v195, v128
    v_mul_f32 v196, v196, v128
    v_mul_f32 v197, v197, v128
    v_mul_f32 v198, v198, v128
    v_mul_f32 v199, v199, v128
    v_mul_f32 v200, v200, v129
    v_mul_f32 v201, v201, v129
    v_mul_f32 v202, v202, v129
    v_mul_f32 v203, v203, v129
    v_mul_f32 v204, v204, v129
    v_mul_f32 v205, v205, v129
    v_mul_f32 v206, v206, v129
    v_mul_f32 v207, v207, v129
    s_barrier
    ds_read_b128 v[48:51], v5 offset:40960
    ds_read_b128 v[52:55], v5 offset:43008
    v_mfma_f32_16x16x32_bf16 v[88:91], v[16:19], v[8:11], v[88:91]
    ds_read_b64_tr_b16 v[56:57], v7 offset:40960
    ds_read_b64_tr_b16 v[58:59], v7 offset:41216
    v_mfma_f32_16x16x32_bf16 v[92:95], v[20:23], v[8:11], v[92:95]
    ds_read_b64_tr_b16 v[60:61], v7 offset:43008
    ds_read_b64_tr_b16 v[62:63], v7 offset:43264
    v_mfma_f32_16x16x32_bf16 v[96:99], v[24:27], v[8:11], v[96:99]
    ds_read_b64_tr_b16 v[64:65], v7 offset:45056
    ds_read_b64_tr_b16 v[66:67], v7 offset:45312
    v_mfma_f32_16x16x32_bf16 v[100:103], v[16:19], v[12:15], v[100:103]
    ds_read_b128 v[68:71], v6 offset:40960
    ds_read_b128 v[72:75], v6 offset:43008
    v_mfma_f32_16x16x32_bf16 v[104:107], v[20:23], v[12:15], v[104:107]
    ds_read_b64_tr_b16 v[76:77], v7 offset:41984
    ds_read_b64_tr_b16 v[78:79], v7 offset:42240
    v_mfma_f32_16x16x32_bf16 v[108:111], v[24:27], v[12:15], v[108:111]
    ds_read_b64_tr_b16 v[80:81], v7 offset:44032
    ds_read_b64_tr_b16 v[82:83], v7 offset:44288
    v_mfma_f32_16x16x32_bf16 v[88:91], v[36:39], v[28:31], v[88:91]
    ds_read_b64_tr_b16 v[84:85], v7 offset:46080
    ds_read_b64_tr_b16 v[86:87], v7 offset:46336
    v_mfma_f32_16x16x32_bf16 v[92:95], v[40:43], v[28:31], v[92:95]
    v_mfma_f32_16x16x32_bf16 v[96:99], v[44:47], v[28:31], v[96:99]
    v_mfma_f32_16x16x32_bf16 v[100:103], v[36:39], v[32:35], v[100:103]
    v_mfma_f32_16x16x32_bf16 v[104:107], v[40:43], v[32:35], v[104:107]
    v_mfma_f32_16x16x32_bf16 v[108:111], v[44:47], v[32:35], v[108:111]
    s_waitcnt lgkmcnt(0)
    v_mul_f32 v208, v208, v129
    v_mul_f32 v209, v209, v129
    v_mul_f32 v210, v210, v129
    v_mul_f32 v211, v211, v129
    s_mul_i32 s20, s16, 192
    v_add_u32 v112, s20, v0
    v_add_u32 v115, 0, v112
    v_mul_u32_u24 v114, 5462, v115
    v_lshrrev_b32 v114, 16, v114
    v_mul_u32_u24 v128, 12, v114
    v_sub_u32 v115, v115, v128
    v_lshlrev_b32 v115, 4, v115
    v_mul_u32_u24 v128, 208, v114
    v_add3_u32 v128, v128, v115, s53
    v_mul_u32_u24 v131, 384, v114
    v_add_u32 v131, v131, v115
    v_add_u32 v115, 64, v112
    v_mul_u32_u24 v114, 5462, v115
    v_lshrrev_b32 v114, 16, v114
    v_mul_u32_u24 v129, 12, v114
    v_sub_u32 v115, v115, v129
    v_lshlrev_b32 v115, 4, v115
    v_mul_u32_u24 v129, 208, v114
    v_add3_u32 v129, v129, v115, s53
    v_mul_u32_u24 v138, 384, v114
    s_barrier
    ds_read_b128 v[8:11], v2 offset:0
    ds_read_b128 v[12:15], v2 offset:2048
    v_mfma_f32_16x16x32_bf16 v[88:91], v[56:59], v[48:51], v[88:91]
    ds_read_b64_tr_b16 v[16:17], v4 offset:0
    ds_read_b64_tr_b16 v[18:19], v4 offset:256
    v_mfma_f32_16x16x32_bf16 v[92:95], v[60:63], v[48:51], v[92:95]
    ds_read_b64_tr_b16 v[20:21], v4 offset:2048
    ds_read_b64_tr_b16 v[22:23], v4 offset:2304
    v_mfma_f32_16x16x32_bf16 v[96:99], v[64:67], v[48:51], v[96:99]
    ds_read_b64_tr_b16 v[24:25], v4 offset:4096
    ds_read_b64_tr_b16 v[26:27], v4 offset:4352
    v_mfma_f32_16x16x32_bf16 v[100:103], v[56:59], v[52:55], v[100:103]
    ds_read_b128 v[28:31], v3 offset:0
    ds_read_b128 v[32:35], v3 offset:2048
    v_mfma_f32_16x16x32_bf16 v[104:107], v[60:63], v[52:55], v[104:107]
    ds_read_b64_tr_b16 v[36:37], v4 offset:1024
    ds_read_b64_tr_b16 v[38:39], v4 offset:1280
    v_mfma_f32_16x16x32_bf16 v[108:111], v[64:67], v[52:55], v[108:111]
    ds_read_b64_tr_b16 v[40:41], v4 offset:3072
    ds_read_b64_tr_b16 v[42:43], v4 offset:3328
    v_mfma_f32_16x16x32_bf16 v[88:91], v[76:79], v[68:71], v[88:91]
    ds_read_b64_tr_b16 v[44:45], v4 offset:5120
    ds_read_b64_tr_b16 v[46:47], v4 offset:5376
    v_mfma_f32_16x16x32_bf16 v[92:95], v[80:83], v[68:71], v[92:95]
    v_mfma_f32_16x16x32_bf16 v[96:99], v[84:87], v[68:71], v[96:99]
    v_mfma_f32_16x16x32_bf16 v[100:103], v[76:79], v[72:75], v[100:103]
    v_mfma_f32_16x16x32_bf16 v[104:107], v[80:83], v[72:75], v[104:107]
    v_mfma_f32_16x16x32_bf16 v[108:111], v[84:87], v[72:75], v[108:111]
    s_waitcnt lgkmcnt(0)
    v_add_u32 v138, v138, v115
    v_add_u32 v115, 128, v112
    v_mul_u32_u24 v114, 5462, v115
    v_lshrrev_b32 v114, 16, v114
    v_mul_u32_u24 v130, 12, v114
    v_sub_u32 v115, v115, v130
    v_lshlrev_b32 v115, 4, v115
    v_mul_u32_u24 v130, 208, v114
    v_add3_u32 v130, v130, v115, s53
    v_mul_u32_u24 v139, 384, v114
    v_add_u32 v139, v139, v115
    v_and_b32 v114, 15, v0
    v_add_u32 v114, s46, v114
    v_mul_u32_u24 v114, 208, v114
    v_lshl_add_u32 v114, v113, 3, v114
    s_lshl_b32 s48, s47, 5
    s_add_u32 s48, s48, 122880
    v_add_u32 v114, s48, v114
    v_and_b32 v115, 15, v0
    v_add_u32 v115, s46, v115
    v_and_b32 v112, 1, v113
    v_lshl_add_u32 v115, v112, 4, v115
    v_mul_u32_u24 v115, 208, v115
    v_lshrrev_b32 v112, 1, v113
    v_lshl_add_u32 v115, v112, 4, v115
    v_add_u32 v115, s48, v115
    s_barrier
    ds_read_b128 v[48:51], v2 offset:20480
    ds_read_b128 v[52:55], v2 offset:22528
    v_mfma_f32_16x16x32_bf16 v[88:91], v[16:19], v[8:11], v[88:91]
    ds_read_b64_tr_b16 v[56:57], v4 offset:20480
    ds_read_b64_tr_b16 v[58:59], v4 offset:20736
    v_mfma_f32_16x16x32_bf16 v[92:95], v[20:23], v[8:11], v[92:95]
    ds_read_b64_tr_b16 v[60:61], v4 offset:22528
    ds_read_b64_tr_b16 v[62:63], v4 offset:22784
    v_mfma_f32_16x16x32_bf16 v[96:99], v[24:27], v[8:11], v[96:99]
    ds_read_b64_tr_b16 v[64:65], v4 offset:24576
    ds_read_b64_tr_b16 v[66:67], v4 offset:24832
    v_mfma_f32_16x16x32_bf16 v[100:103], v[16:19], v[12:15], v[100:103]
    ds_read_b128 v[68:71], v3 offset:20480
    ds_read_b128 v[72:75], v3 offset:22528
    v_mfma_f32_16x16x32_bf16 v[104:107], v[20:23], v[12:15], v[104:107]
    ds_read_b64_tr_b16 v[76:77], v4 offset:21504
    ds_read_b64_tr_b16 v[78:79], v4 offset:21760
    v_mfma_f32_16x16x32_bf16 v[108:111], v[24:27], v[12:15], v[108:111]
    ds_read_b64_tr_b16 v[80:81], v4 offset:23552
    ds_read_b64_tr_b16 v[82:83], v4 offset:23808
    v_mfma_f32_16x16x32_bf16 v[88:91], v[36:39], v[28:31], v[88:91]
    ds_read_b64_tr_b16 v[84:85], v4 offset:25600
    ds_read_b64_tr_b16 v[86:87], v4 offset:25856
    v_mfma_f32_16x16x32_bf16 v[92:95], v[40:43], v[28:31], v[92:95]
    v_mfma_f32_16x16x32_bf16 v[96:99], v[44:47], v[28:31], v[96:99]
    v_mfma_f32_16x16x32_bf16 v[100:103], v[36:39], v[32:35], v[100:103]
    v_mfma_f32_16x16x32_bf16 v[104:107], v[40:43], v[32:35], v[104:107]
    v_mfma_f32_16x16x32_bf16 v[108:111], v[44:47], v[32:35], v[108:111]
    s_waitcnt lgkmcnt(0)
    v_and_b32 v4, 15, v0
    v_lshrrev_b32 v5, 4, v0
    v_and_b32 v6, 7, v4
    v_xor_b32 v5, v5, v6
    v_lshlrev_b32 v4, 7, v4
    v_lshl_add_u32 v4, v5, 4, v4
    s_lshl_b32 s20, s16, 11
    v_add_u32 v2, s20, v4
    v_xor_b32 v3, 64, v2
    v_and_b32 v6, 15, v0
    v_lshlrev_b32 v6, 3, v6
    v_and_b32 v7, 16, v0
    v_lshl_add_u32 v6, v7, 3, v6
    v_and_b32 v7, 32, v0
    v_lshl_add_u32 v6, v7, 4, v6
    v_add_u32 v4, 8192, v6
    v_add_u32 v5, 61440, v2
    v_add_u32 v6, 61440, v3
    v_add_u32 v7, 61440, v4
    v_mov_b32 v236, 0
    v_mov_b32 v237, 0
    v_mov_b32 v238, 0
    v_mov_b32 v239, 0
    v_mov_b32 v240, 0
    v_mov_b32 v241, 0
    v_mov_b32 v242, 0
    v_mov_b32 v243, 0
    v_mov_b32 v244, 0
    v_mov_b32 v245, 0
    v_mov_b32 v246, 0
    v_mov_b32 v247, 0
    v_mov_b32 v248, 0
    v_mov_b32 v249, 0
    v_mov_b32 v250, 0
    v_mov_b32 v251, 0
    v_mov_b32 v252, 0
    v_mov_b32 v253, 0
    v_mov_b32 v254, 0
    v_mov_b32 v255, 0
    s_barrier
    ds_read_b128 v[140:143], v2 offset:40960
    ds_read_b64_tr_b16 v[144:145], v4 offset:40960
    v_mfma_f32_16x16x32_bf16 v[88:91], v[56:59], v[48:51], v[88:91]
    ds_read_b64_tr_b16 v[146:147], v4 offset:41216
    ds_read_b64_tr_b16 v[148:149], v4 offset:43008
    v_mfma_f32_16x16x32_bf16 v[92:95], v[60:63], v[48:51], v[92:95]
    ds_read_b64_tr_b16 v[150:151], v4 offset:43264
    ds_read_b64_tr_b16 v[152:153], v4 offset:45056
    v_mfma_f32_16x16x32_bf16 v[96:99], v[64:67], v[48:51], v[96:99]
    ds_read_b64_tr_b16 v[154:155], v4 offset:45312
    ds_read_b64_tr_b16 v[156:157], v4 offset:47104
    v_mfma_f32_16x16x32_bf16 v[100:103], v[56:59], v[52:55], v[100:103]
    ds_read_b64_tr_b16 v[158:159], v4 offset:47360
    ds_read_b64_tr_b16 v[160:161], v4 offset:49152
    v_mfma_f32_16x16x32_bf16 v[104:107], v[60:63], v[52:55], v[104:107]
    ds_read_b64_tr_b16 v[162:163], v4 offset:49408
    ds_read_b128 v[164:167], v3 offset:40960
    v_mfma_f32_16x16x32_bf16 v[108:111], v[64:67], v[52:55], v[108:111]
    ds_read_b64_tr_b16 v[168:169], v4 offset:41984
    ds_read_b64_tr_b16 v[170:171], v4 offset:42240
    v_mfma_f32_16x16x32_bf16 v[88:91], v[76:79], v[68:71], v[88:91]
    ds_read_b64_tr_b16 v[172:173], v4 offset:44032
    ds_read_b64_tr_b16 v[174:175], v4 offset:44288
    v_mfma_f32_16x16x32_bf16 v[92:95], v[80:83], v[68:71], v[92:95]
    ds_read_b64_tr_b16 v[176:177], v4 offset:46080
    ds_read_b64_tr_b16 v[178:179], v4 offset:46336
    v_mfma_f32_16x16x32_bf16 v[96:99], v[84:87], v[68:71], v[96:99]
    ds_read_b64_tr_b16 v[180:181], v4 offset:48128
    ds_read_b64_tr_b16 v[182:183], v4 offset:48384
    v_mfma_f32_16x16x32_bf16 v[100:103], v[76:79], v[72:75], v[100:103]
    ds_read_b64_tr_b16 v[184:185], v4 offset:50176
    ds_read_b64_tr_b16 v[186:187], v4 offset:50432
    v_mfma_f32_16x16x32_bf16 v[104:107], v[80:83], v[72:75], v[104:107]
    v_mfma_f32_16x16x32_bf16 v[108:111], v[84:87], v[72:75], v[108:111]
    s_waitcnt lgkmcnt(0)
    v_pk_add_f32 v[88:89], v[88:89], v[132:133]
    v_pk_add_f32 v[90:91], v[90:91], v[132:133]
    v_pk_add_f32 v[92:93], v[92:93], v[132:133]
    v_pk_add_f32 v[94:95], v[94:95], v[132:133]
    v_pk_add_f32 v[96:97], v[96:97], v[132:133]
    v_pk_add_f32 v[98:99], v[98:99], v[132:133]
    v_pk_add_f32 v[100:101], v[100:101], v[134:135]
    v_pk_add_f32 v[102:103], v[102:103], v[134:135]
    v_pk_add_f32 v[104:105], v[104:105], v[134:135]
    v_pk_add_f32 v[106:107], v[106:107], v[134:135]
    v_pk_add_f32 v[108:109], v[108:109], v[134:135]
    v_pk_add_f32 v[110:111], v[110:111], v[134:135]
    v_pk_mul_f32 v[88:89], v[88:89], v[188:189]
    v_pk_mul_f32 v[90:91], v[90:91], v[190:191]
    v_pk_mul_f32 v[92:93], v[92:93], v[192:193]
    v_pk_mul_f32 v[94:95], v[94:95], v[194:195]
    v_pk_mul_f32 v[96:97], v[96:97], v[196:197]
    v_pk_mul_f32 v[98:99], v[98:99], v[198:199]
    v_pk_mul_f32 v[100:101], v[100:101], v[200:201]
    v_pk_mul_f32 v[102:103], v[102:103], v[202:203]
    v_pk_mul_f32 v[104:105], v[104:105], v[204:205]
    v_pk_mul_f32 v[106:107], v[106:107], v[206:207]
    v_pk_mul_f32 v[108:109], v[108:109], v[208:209]
    v_pk_mul_f32 v[110:111], v[110:111], v[210:211]
    v_cvt_pk_bf16_f32 v116, v88, v89
    v_cvt_pk_bf16_f32 v117, v90, v91
    v_cvt_pk_bf16_f32 v120, v92, v93
    v_cvt_pk_bf16_f32 v121, v94, v95
    v_cvt_pk_bf16_f32 v124, v96, v97
    v_cvt_pk_bf16_f32 v125, v98, v99
    v_cvt_pk_bf16_f32 v118, v100, v101
    v_cvt_pk_bf16_f32 v119, v102, v103
    v_cvt_pk_bf16_f32 v122, v104, v105
    v_cvt_pk_bf16_f32 v123, v106, v107
    v_cvt_pk_bf16_f32 v126, v108, v109
    v_cvt_pk_bf16_f32 v127, v110, v111
    v_permlane16_swap_b32 v116, v118
    v_permlane16_swap_b32 v117, v119
    v_permlane16_swap_b32 v120, v122
    v_permlane16_swap_b32 v121, v123
    v_permlane16_swap_b32 v124, v126
    v_permlane16_swap_b32 v125, v127
    ds_write_b128 v115, v[116:119] offset:0
    ds_write_b128 v115, v[120:123] offset:32
    ds_write_b128 v115, v[124:127] offset:64
    s_waitcnt lgkmcnt(0)
    s_barrier
    s_add_u32 s12, s32, 25165824
    s_addc_u32 s13, s33, 0
    s_mov_b32 s14, 3145728
    s_mov_b32 s15, 0x20000
    ds_read_b128 v[116:119], v128
    ds_read_b128 v[120:123], v129
    ds_read_b128 v[124:127], v130
    s_lshl_b32 s48, s40, 2
    s_lshr_b32 s49, s41, 1
    s_add_u32 s48, s48, s49
    s_mul_i32 s48, s48, 24576
    s_and_b32 s49, s41, 1
    s_mul_i32 s49, s49, 192
    s_add_u32 s48, s48, s49
    s_waitcnt lgkmcnt(0)
    buffer_store_dwordx4 v[116:119], v131, s[12:15], s48 offen sc1
    buffer_store_dwordx4 v[120:123], v138, s[12:15], s48 offen sc1
    buffer_store_dwordx4 v[124:127], v139, s[12:15], s48 offen sc1
    ds_read_b128 v[188:191], v5 offset:0
    ds_read_b64_tr_b16 v[192:193], v7 offset:0
    ds_read_b64_tr_b16 v[194:195], v7 offset:256
    v_mfma_f32_16x16x32_bf16 v[236:239], v[144:147], v[140:143], v[236:239]
    ds_read_b64_tr_b16 v[196:197], v7 offset:2048
    ds_read_b64_tr_b16 v[198:199], v7 offset:2304
    ds_read_b64_tr_b16 v[200:201], v7 offset:4096
    v_mfma_f32_16x16x32_bf16 v[240:243], v[148:151], v[140:143], v[240:243]
    ds_read_b64_tr_b16 v[202:203], v7 offset:4352
    ds_read_b64_tr_b16 v[204:205], v7 offset:6144
    ds_read_b64_tr_b16 v[206:207], v7 offset:6400
    v_mfma_f32_16x16x32_bf16 v[244:247], v[152:155], v[140:143], v[244:247]
    ds_read_b64_tr_b16 v[208:209], v7 offset:8192
    ds_read_b64_tr_b16 v[210:211], v7 offset:8448
    ds_read_b128 v[212:215], v6 offset:0
    v_mfma_f32_16x16x32_bf16 v[248:251], v[156:159], v[140:143], v[248:251]
    ds_read_b64_tr_b16 v[216:217], v7 offset:1024
    ds_read_b64_tr_b16 v[218:219], v7 offset:1280
    ds_read_b64_tr_b16 v[220:221], v7 offset:3072
    v_mfma_f32_16x16x32_bf16 v[252:255], v[160:163], v[140:143], v[252:255]
    ds_read_b64_tr_b16 v[222:223], v7 offset:3328
    ds_read_b64_tr_b16 v[224:225], v7 offset:5120
    ds_read_b64_tr_b16 v[226:227], v7 offset:5376
    v_mfma_f32_16x16x32_bf16 v[236:239], v[168:171], v[164:167], v[236:239]
    ds_read_b64_tr_b16 v[228:229], v7 offset:7168
    ds_read_b64_tr_b16 v[230:231], v7 offset:7424
    ds_read_b64_tr_b16 v[232:233], v7 offset:9216
    v_mfma_f32_16x16x32_bf16 v[240:243], v[172:175], v[164:167], v[240:243]
    ds_read_b64_tr_b16 v[234:235], v7 offset:9472
    v_mfma_f32_16x16x32_bf16 v[244:247], v[176:179], v[164:167], v[244:247]
    v_mfma_f32_16x16x32_bf16 v[248:251], v[180:183], v[164:167], v[248:251]
    v_mfma_f32_16x16x32_bf16 v[252:255], v[184:187], v[164:167], v[252:255]
    s_waitcnt lgkmcnt(0)
    s_barrier
    ds_read_b128 v[140:143], v5 offset:20480
    ds_read_b64_tr_b16 v[144:145], v7 offset:20480
    ds_read_b64_tr_b16 v[146:147], v7 offset:20736
    v_mfma_f32_16x16x32_bf16 v[236:239], v[192:195], v[188:191], v[236:239]
    ds_read_b64_tr_b16 v[148:149], v7 offset:22528
    ds_read_b64_tr_b16 v[150:151], v7 offset:22784
    ds_read_b64_tr_b16 v[152:153], v7 offset:24576
    v_mfma_f32_16x16x32_bf16 v[240:243], v[196:199], v[188:191], v[240:243]
    ds_read_b64_tr_b16 v[154:155], v7 offset:24832
    ds_read_b64_tr_b16 v[156:157], v7 offset:26624
    ds_read_b64_tr_b16 v[158:159], v7 offset:26880
    v_mfma_f32_16x16x32_bf16 v[244:247], v[200:203], v[188:191], v[244:247]
    ds_read_b64_tr_b16 v[160:161], v7 offset:28672
    ds_read_b64_tr_b16 v[162:163], v7 offset:28928
    ds_read_b128 v[164:167], v6 offset:20480
    v_mfma_f32_16x16x32_bf16 v[248:251], v[204:207], v[188:191], v[248:251]
    ds_read_b64_tr_b16 v[168:169], v7 offset:21504
    ds_read_b64_tr_b16 v[170:171], v7 offset:21760
    ds_read_b64_tr_b16 v[172:173], v7 offset:23552
    v_mfma_f32_16x16x32_bf16 v[252:255], v[208:211], v[188:191], v[252:255]
    ds_read_b64_tr_b16 v[174:175], v7 offset:23808
    ds_read_b64_tr_b16 v[176:177], v7 offset:25600
    ds_read_b64_tr_b16 v[178:179], v7 offset:25856
    v_mfma_f32_16x16x32_bf16 v[236:239], v[216:219], v[212:215], v[236:239]
    ds_read_b64_tr_b16 v[180:181], v7 offset:27648
    ds_read_b64_tr_b16 v[182:183], v7 offset:27904
    ds_read_b64_tr_b16 v[184:185], v7 offset:29696
    v_mfma_f32_16x16x32_bf16 v[240:243], v[220:223], v[212:215], v[240:243]
    ds_read_b64_tr_b16 v[186:187], v7 offset:29952
    v_mfma_f32_16x16x32_bf16 v[244:247], v[224:227], v[212:215], v[244:247]
    v_mfma_f32_16x16x32_bf16 v[248:251], v[228:231], v[212:215], v[248:251]
    v_mfma_f32_16x16x32_bf16 v[252:255], v[232:235], v[212:215], v[252:255]
    s_waitcnt lgkmcnt(0)
    s_barrier
    ds_read_b128 v[188:191], v5 offset:40960
    ds_read_b64_tr_b16 v[192:193], v7 offset:40960
    ds_read_b64_tr_b16 v[194:195], v7 offset:41216
    v_mfma_f32_16x16x32_bf16 v[236:239], v[144:147], v[140:143], v[236:239]
    ds_read_b64_tr_b16 v[196:197], v7 offset:43008
    ds_read_b64_tr_b16 v[198:199], v7 offset:43264
    ds_read_b64_tr_b16 v[200:201], v7 offset:45056
    v_mfma_f32_16x16x32_bf16 v[240:243], v[148:151], v[140:143], v[240:243]
    ds_read_b64_tr_b16 v[202:203], v7 offset:45312
    ds_read_b64_tr_b16 v[204:205], v7 offset:47104
    ds_read_b64_tr_b16 v[206:207], v7 offset:47360
    v_mfma_f32_16x16x32_bf16 v[244:247], v[152:155], v[140:143], v[244:247]
    ds_read_b64_tr_b16 v[208:209], v7 offset:49152
    ds_read_b64_tr_b16 v[210:211], v7 offset:49408
    ds_read_b128 v[212:215], v6 offset:40960
    v_mfma_f32_16x16x32_bf16 v[248:251], v[156:159], v[140:143], v[248:251]
    ds_read_b64_tr_b16 v[216:217], v7 offset:41984
    ds_read_b64_tr_b16 v[218:219], v7 offset:42240
    ds_read_b64_tr_b16 v[220:221], v7 offset:44032
    v_mfma_f32_16x16x32_bf16 v[252:255], v[160:163], v[140:143], v[252:255]
    ds_read_b64_tr_b16 v[222:223], v7 offset:44288
    ds_read_b64_tr_b16 v[224:225], v7 offset:46080
    ds_read_b64_tr_b16 v[226:227], v7 offset:46336
    v_mfma_f32_16x16x32_bf16 v[236:239], v[168:171], v[164:167], v[236:239]
    ds_read_b64_tr_b16 v[228:229], v7 offset:48128
    ds_read_b64_tr_b16 v[230:231], v7 offset:48384
    ds_read_b64_tr_b16 v[232:233], v7 offset:50176
    v_mfma_f32_16x16x32_bf16 v[240:243], v[172:175], v[164:167], v[240:243]
    ds_read_b64_tr_b16 v[234:235], v7 offset:50432
    v_mfma_f32_16x16x32_bf16 v[244:247], v[176:179], v[164:167], v[244:247]
    v_mfma_f32_16x16x32_bf16 v[248:251], v[180:183], v[164:167], v[248:251]
    v_mfma_f32_16x16x32_bf16 v[252:255], v[184:187], v[164:167], v[252:255]
    s_waitcnt lgkmcnt(0)
    s_waitcnt vmcnt(0)
    v_mov_b32 v138, 136192
    v_mov_b32 v139, 1
    s_mov_b64 exec, 1
    ds_add_rtn_u32 v139, v138, v139
    s_waitcnt lgkmcnt(0)
    v_readfirstlane_b32 s20, v139
    s_nop 0
    s_cmp_lg_u32 s20, 3
    s_cbranch_scc1 K34_nosig
    s_add_u32 s12, s32, 24444928
    s_addc_u32 s13, s33, 0
    s_mov_b32 s14, 4096
    s_mov_b32 s15, 0x20000
    s_lshl_b32 s20, s40, 7
    s_lshl_b32 s21, s41, 3
    s_add_u32 s20, s20, s21
    v_mov_b32 v112, s20
    s_add_u32 s21, s98, 1
    v_mov_b32 v138, s21
    v_mov_b32 v139, s99
    buffer_store_dwordx2 v[138:139], v112, s[12:15], 0 offen sc1
K34_nosig:
    s_mov_b64 exec, -1
    s_barrier
    ds_read_b128 v[140:143], v2 offset:0
    ds_read_b64_tr_b16 v[144:145], v4 offset:0
    ds_read_b64_tr_b16 v[146:147], v4 offset:256
    v_mfma_f32_16x16x32_bf16 v[236:239], v[192:195], v[188:191], v[236:239]
    ds_read_b64_tr_b16 v[148:149], v4 offset:2048
    ds_read_b64_tr_b16 v[150:151], v4 offset:2304
    ds_read_b64_tr_b16 v[152:153], v4 offset:4096
    v_mfma_f32_16x16x32_bf16 v[240:243], v[196:199], v[188:191], v[240:243]
    ds_read_b64_tr_b16 v[154:155], v4 offset:4352
    ds_read_b64_tr_b16 v[156:157], v4 offset:6144
    ds_read_b64_tr_b16 v[158:159], v4 offset:6400
    v_mfma_f32_16x16x32_bf16 v[244:247], v[200:203], v[188:191], v[244:247]
    ds_read_b64_tr_b16 v[160:161], v4 offset:8192
    ds_read_b64_tr_b16 v[162:163], v4 offset:8448
    ds_read_b128 v[164:167], v3 offset:0
    v_mfma_f32_16x16x32_bf16 v[248:251], v[204:207], v[188:191], v[248:251]
    ds_read_b64_tr_b16 v[168:169], v4 offset:1024
    ds_read_b64_tr_b16 v[170:171], v4 offset:1280
    ds_read_b64_tr_b16 v[172:173], v4 offset:3072
    v_mfma_f32_16x16x32_bf16 v[252:255], v[208:211], v[188:191], v[252:255]
    ds_read_b64_tr_b16 v[174:175], v4 offset:3328
    ds_read_b64_tr_b16 v[176:177], v4 offset:5120
    ds_read_b64_tr_b16 v[178:179], v4 offset:5376
    v_mfma_f32_16x16x32_bf16 v[236:239], v[216:219], v[212:215], v[236:239]
    ds_read_b64_tr_b16 v[180:181], v4 offset:7168
    ds_read_b64_tr_b16 v[182:183], v4 offset:7424
    ds_read_b64_tr_b16 v[184:185], v4 offset:9216
    v_mfma_f32_16x16x32_bf16 v[240:243], v[220:223], v[212:215], v[240:243]
    ds_read_b64_tr_b16 v[186:187], v4 offset:9472
    v_mfma_f32_16x16x32_bf16 v[244:247], v[224:227], v[212:215], v[244:247]
    v_mfma_f32_16x16x32_bf16 v[248:251], v[228:231], v[212:215], v[248:251]
    v_mfma_f32_16x16x32_bf16 v[252:255], v[232:235], v[212:215], v[252:255]
    s_waitcnt lgkmcnt(0)
    s_barrier
    ds_read_b128 v[188:191], v2 offset:20480
    ds_read_b64_tr_b16 v[192:193], v4 offset:20480
    ds_read_b64_tr_b16 v[194:195], v4 offset:20736
    v_mfma_f32_16x16x32_bf16 v[236:239], v[144:147], v[140:143], v[236:239]
    ds_read_b64_tr_b16 v[196:197], v4 offset:22528
    ds_read_b64_tr_b16 v[198:199], v4 offset:22784
    ds_read_b64_tr_b16 v[200:201], v4 offset:24576
    v_mfma_f32_16x16x32_bf16 v[240:243], v[148:151], v[140:143], v[240:243]
    ds_read_b64_tr_b16 v[202:203], v4 offset:24832
    ds_read_b64_tr_b16 v[204:205], v4 offset:26624
    ds_read_b64_tr_b16 v[206:207], v4 offset:26880
    v_mfma_f32_16x16x32_bf16 v[244:247], v[152:155], v[140:143], v[244:247]
    ds_read_b64_tr_b16 v[208:209], v4 offset:28672
    ds_read_b64_tr_b16 v[210:211], v4 offset:28928
    ds_read_b128 v[212:215], v3 offset:20480
    v_mfma_f32_16x16x32_bf16 v[248:251], v[156:159], v[140:143], v[248:251]
    ds_read_b64_tr_b16 v[216:217], v4 offset:21504
    ds_read_b64_tr_b16 v[218:219], v4 offset:21760
    ds_read_b64_tr_b16 v[220:221], v4 offset:23552
    v_mfma_f32_16x16x32_bf16 v[252:255], v[160:163], v[140:143], v[252:255]
    ds_read_b64_tr_b16 v[222:223], v4 offset:23808
    ds_read_b64_tr_b16 v[224:225], v4 offset:25600
    ds_read_b64_tr_b16 v[226:227], v4 offset:25856
    v_mfma_f32_16x16x32_bf16 v[236:239], v[168:171], v[164:167], v[236:239]
    ds_read_b64_tr_b16 v[228:229], v4 offset:27648
    ds_read_b64_tr_b16 v[230:231], v4 offset:27904
    ds_read_b64_tr_b16 v[232:233], v4 offset:29696
    v_mfma_f32_16x16x32_bf16 v[240:243], v[172:175], v[164:167], v[240:243]
    ds_read_b64_tr_b16 v[234:235], v4 offset:29952
    v_mfma_f32_16x16x32_bf16 v[244:247], v[176:179], v[164:167], v[244:247]
    v_mfma_f32_16x16x32_bf16 v[248:251], v[180:183], v[164:167], v[248:251]
    v_mfma_f32_16x16x32_bf16 v[252:255], v[184:187], v[164:167], v[252:255]
    s_waitcnt lgkmcnt(0)
    s_barrier
    ds_read_b128 v[140:143], v2 offset:40960
    ds_read_b64_tr_b16 v[144:145], v4 offset:40960
    ds_read_b64_tr_b16 v[146:147], v4 offset:41216
    v_mfma_f32_16x16x32_bf16 v[236:239], v[192:195], v[188:191], v[236:239]
    ds_read_b64_tr_b16 v[148:149], v4 offset:43008
    ds_read_b64_tr_b16 v[150:151], v4 offset:43264
    ds_read_b64_tr_b16 v[152:153], v4 offset:45056
    v_mfma_f32_16x16x32_bf16 v[240:243], v[196:199], v[188:191], v[240:243]
    ds_read_b64_tr_b16 v[154:155], v4 offset:45312
    ds_read_b64_tr_b16 v[156:157], v4 offset:47104
    ds_read_b64_tr_b16 v[158:159], v4 offset:47360
    v_mfma_f32_16x16x32_bf16 v[244:247], v[200:203], v[188:191], v[244:247]
    ds_read_b64_tr_b16 v[160:161], v4 offset:49152
    ds_read_b64_tr_b16 v[162:163], v4 offset:49408
    ds_read_b128 v[164:167], v3 offset:40960
    v_mfma_f32_16x16x32_bf16 v[248:251], v[204:207], v[188:191], v[248:251]
    ds_read_b64_tr_b16 v[168:169], v4 offset:41984
    ds_read_b64_tr_b16 v[170:171], v4 offset:42240
    ds_read_b64_tr_b16 v[172:173], v4 offset:44032
    v_mfma_f32_16x16x32_bf16 v[252:255], v[208:211], v[188:191], v[252:255]
    ds_read_b64_tr_b16 v[174:175], v4 offset:44288
    ds_read_b64_tr_b16 v[176:177], v4 offset:46080
    ds_read_b64_tr_b16 v[178:179], v4 offset:46336
    v_mfma_f32_16x16x32_bf16 v[236:239], v[216:219], v[212:215], v[236:239]
    ds_read_b64_tr_b16 v[180:181], v4 offset:48128
    ds_read_b64_tr_b16 v[182:183], v4 offset:48384
    ds_read_b64_tr_b16 v[184:185], v4 offset:50176
    v_mfma_f32_16x16x32_bf16 v[240:243], v[220:223], v[212:215], v[240:243]
    ds_read_b64_tr_b16 v[186:187], v4 offset:50432
    v_mfma_f32_16x16x32_bf16 v[244:247], v[224:227], v[212:215], v[244:247]
    v_mfma_f32_16x16x32_bf16 v[248:251], v[228:231], v[212:215], v[248:251]
    v_mfma_f32_16x16x32_bf16 v[252:255], v[232:235], v[212:215], v[252:255]
    s_waitcnt lgkmcnt(0)
    s_barrier
    ds_read_b128 v[188:191], v5 offset:0
    ds_read_b64_tr_b16 v[192:193], v7 offset:0
    ds_read_b64_tr_b16 v[194:195], v7 offset:256
    v_mfma_f32_16x16x32_bf16 v[236:239], v[144:147], v[140:143], v[236:239]
    ds_read_b64_tr_b16 v[196:197], v7 offset:2048
    ds_read_b64_tr_b16 v[198:199], v7 offset:2304
    ds_read_b64_tr_b16 v[200:201], v7 offset:4096
    v_mfma_f32_16x16x32_bf16 v[240:243], v[148:151], v[140:143], v[240:243]
    ds_read_b64_tr_b16 v[202:203], v7 offset:4352
    ds_read_b64_tr_b16 v[204:205], v7 offset:6144
    ds_read_b64_tr_b16 v[206:207], v7 offset:6400
    v_mfma_f32_16x16x32_bf16 v[244:247], v[152:155], v[140:143], v[244:247]
    ds_read_b64_tr_b16 v[208:209], v7 offset:8192
    ds_read_b64_tr_b16 v[210:211], v7 offset:8448
    ds_read_b128 v[212:215], v6 offset:0
    v_mfma_f32_16x16x32_bf16 v[248:251], v[156:159], v[140:143], v[248:251]
    ds_read_b64_tr_b16 v[216:217], v7 offset:1024
    ds_read_b64_tr_b16 v[218:219], v7 offset:1280
    ds_read_b64_tr_b16 v[220:221], v7 offset:3072
    v_mfma_f32_16x16x32_bf16 v[252:255], v[160:163], v[140:143], v[252:255]
    ds_read_b64_tr_b16 v[222:223], v7 offset:3328
    ds_read_b64_tr_b16 v[224:225], v7 offset:5120
    ds_read_b64_tr_b16 v[226:227], v7 offset:5376
    v_mfma_f32_16x16x32_bf16 v[236:239], v[168:171], v[164:167], v[236:239]
    ds_read_b64_tr_b16 v[228:229], v7 offset:7168
    ds_read_b64_tr_b16 v[230:231], v7 offset:7424
    ds_read_b64_tr_b16 v[232:233], v7 offset:9216
    v_mfma_f32_16x16x32_bf16 v[240:243], v[172:175], v[164:167], v[240:243]
    ds_read_b64_tr_b16 v[234:235], v7 offset:9472
    v_mfma_f32_16x16x32_bf16 v[244:247], v[176:179], v[164:167], v[244:247]
    v_mfma_f32_16x16x32_bf16 v[248:251], v[180:183], v[164:167], v[248:251]
    v_mfma_f32_16x16x32_bf16 v[252:255], v[184:187], v[164:167], v[252:255]
    s_waitcnt lgkmcnt(0)
    s_barrier
    ds_read_b128 v[140:143], v5 offset:20480
    ds_read_b64_tr_b16 v[144:145], v7 offset:20480
    ds_read_b64_tr_b16 v[146:147], v7 offset:20736
    v_mfma_f32_16x16x32_bf16 v[236:239], v[192:195], v[188:191], v[236:239]
    ds_read_b64_tr_b16 v[148:149], v7 offset:22528
    ds_read_b64_tr_b16 v[150:151], v7 offset:22784
    ds_read_b64_tr_b16 v[152:153], v7 offset:24576
    v_mfma_f32_16x16x32_bf16 v[240:243], v[196:199], v[188:191], v[240:243]
    ds_read_b64_tr_b16 v[154:155], v7 offset:24832
    ds_read_b64_tr_b16 v[156:157], v7 offset:26624
    ds_read_b64_tr_b16 v[158:159], v7 offset:26880
    v_mfma_f32_16x16x32_bf16 v[244:247], v[200:203], v[188:191], v[244:247]
    ds_read_b64_tr_b16 v[160:161], v7 offset:28672
    ds_read_b64_tr_b16 v[162:163], v7 offset:28928
    ds_read_b128 v[164:167], v6 offset:20480
    v_mfma_f32_16x16x32_bf16 v[248:251], v[204:207], v[188:191], v[248:251]
    ds_read_b64_tr_b16 v[168:169], v7 offset:21504
    ds_read_b64_tr_b16 v[170:171], v7 offset:21760
    ds_read_b64_tr_b16 v[172:173], v7 offset:23552
    v_mfma_f32_16x16x32_bf16 v[252:255], v[208:211], v[188:191], v[252:255]
    ds_read_b64_tr_b16 v[174:175], v7 offset:23808
    ds_read_b64_tr_b16 v[176:177], v7 offset:25600
    ds_read_b64_tr_b16 v[178:179], v7 offset:25856
    v_mfma_f32_16x16x32_bf16 v[236:239], v[216:219], v[212:215], v[236:239]
    ds_read_b64_tr_b16 v[180:181], v7 offset:27648
    ds_read_b64_tr_b16 v[182:183], v7 offset:27904
    ds_read_b64_tr_b16 v[184:185], v7 offset:29696
    v_mfma_f32_16x16x32_bf16 v[240:243], v[220:223], v[212:215], v[240:243]
    ds_read_b64_tr_b16 v[186:187], v7 offset:29952
    v_mfma_f32_16x16x32_bf16 v[244:247], v[224:227], v[212:215], v[244:247]
    v_mfma_f32_16x16x32_bf16 v[248:251], v[228:231], v[212:215], v[248:251]
    v_mfma_f32_16x16x32_bf16 v[252:255], v[232:235], v[212:215], v[252:255]
    s_waitcnt lgkmcnt(0)
    s_barrier
    ds_read_b128 v[188:191], v5 offset:40960
    ds_read_b64_tr_b16 v[192:193], v7 offset:40960
    ds_read_b64_tr_b16 v[194:195], v7 offset:41216
    v_mfma_f32_16x16x32_bf16 v[236:239], v[144:147], v[140:143], v[236:239]
    ds_read_b64_tr_b16 v[196:197], v7 offset:43008
    ds_read_b64_tr_b16 v[198:199], v7 offset:43264
    ds_read_b64_tr_b16 v[200:201], v7 offset:45056
    v_mfma_f32_16x16x32_bf16 v[240:243], v[148:151], v[140:143], v[240:243]
    ds_read_b64_tr_b16 v[202:203], v7 offset:45312
    ds_read_b64_tr_b16 v[204:205], v7 offset:47104
    ds_read_b64_tr_b16 v[206:207], v7 offset:47360
    v_mfma_f32_16x16x32_bf16 v[244:247], v[152:155], v[140:143], v[244:247]
    ds_read_b64_tr_b16 v[208:209], v7 offset:49152
    ds_read_b64_tr_b16 v[210:211], v7 offset:49408
    ds_read_b128 v[212:215], v6 offset:40960
    v_mfma_f32_16x16x32_bf16 v[248:251], v[156:159], v[140:143], v[248:251]
    ds_read_b64_tr_b16 v[216:217], v7 offset:41984
    ds_read_b64_tr_b16 v[218:219], v7 offset:42240
    ds_read_b64_tr_b16 v[220:221], v7 offset:44032
    v_mfma_f32_16x16x32_bf16 v[252:255], v[160:163], v[140:143], v[252:255]
    ds_read_b64_tr_b16 v[222:223], v7 offset:44288
    ds_read_b64_tr_b16 v[224:225], v7 offset:46080
    ds_read_b64_tr_b16 v[226:227], v7 offset:46336
    v_mfma_f32_16x16x32_bf16 v[236:239], v[168:171], v[164:167], v[236:239]
    ds_read_b64_tr_b16 v[228:229], v7 offset:48128
    ds_read_b64_tr_b16 v[230:231], v7 offset:48384
    ds_read_b64_tr_b16 v[232:233], v7 offset:50176
    v_mfma_f32_16x16x32_bf16 v[240:243], v[172:175], v[164:167], v[240:243]
    ds_read_b64_tr_b16 v[234:235], v7 offset:50432
    v_mfma_f32_16x16x32_bf16 v[244:247], v[176:179], v[164:167], v[244:247]
    v_mfma_f32_16x16x32_bf16 v[248:251], v[180:183], v[164:167], v[248:251]
    v_mfma_f32_16x16x32_bf16 v[252:255], v[184:187], v[164:167], v[252:255]
    s_waitcnt lgkmcnt(0)
    s_barrier
    ds_read_b128 v[140:143], v2 offset:0
    ds_read_b64_tr_b16 v[144:145], v4 offset:0
    ds_read_b64_tr_b16 v[146:147], v4 offset:256
    v_mfma_f32_16x16x32_bf16 v[236:239], v[192:195], v[188:191], v[236:239]
    ds_read_b64_tr_b16 v[148:149], v4 offset:2048
    ds_read_b64_tr_b16 v[150:151], v4 offset:2304
    ds_read_b64_tr_b16 v[152:153], v4 offset:4096
    v_mfma_f32_16x16x32_bf16 v[240:243], v[196:199], v[188:191], v[240:243]
    ds_read_b64_tr_b16 v[154:155], v4 offset:4352
    ds_read_b64_tr_b16 v[156:157], v4 offset:6144
    ds_read_b64_tr_b16 v[158:159], v4 offset:6400
    v_mfma_f32_16x16x32_bf16 v[244:247], v[200:203], v[188:191], v[244:247]
    ds_read_b64_tr_b16 v[160:161], v4 offset:8192
    ds_read_b64_tr_b16 v[162:163], v4 offset:8448
    ds_read_b128 v[164:167], v3 offset:0
    v_mfma_f32_16x16x32_bf16 v[248:251], v[204:207], v[188:191], v[248:251]
    ds_read_b64_tr_b16 v[168:169], v4 offset:1024
    ds_read_b64_tr_b16 v[170:171], v4 offset:1280
    ds_read_b64_tr_b16 v[172:173], v4 offset:3072
    v_mfma_f32_16x16x32_bf16 v[252:255], v[208:211], v[188:191], v[252:255]
    ds_read_b64_tr_b16 v[174:175], v4 offset:3328
    ds_read_b64_tr_b16 v[176:177], v4 offset:5120
    ds_read_b64_tr_b16 v[178:179], v4 offset:5376
    v_mfma_f32_16x16x32_bf16 v[236:239], v[216:219], v[212:215], v[236:239]
    ds_read_b64_tr_b16 v[180:181], v4 offset:7168
    ds_read_b64_tr_b16 v[182:183], v4 offset:7424
    ds_read_b64_tr_b16 v[184:185], v4 offset:9216
    v_mfma_f32_16x16x32_bf16 v[240:243], v[220:223], v[212:215], v[240:243]
    ds_read_b64_tr_b16 v[186:187], v4 offset:9472
    v_mfma_f32_16x16x32_bf16 v[244:247], v[224:227], v[212:215], v[244:247]
    v_mfma_f32_16x16x32_bf16 v[248:251], v[228:231], v[212:215], v[248:251]
    v_mfma_f32_16x16x32_bf16 v[252:255], v[232:235], v[212:215], v[252:255]
    s_waitcnt lgkmcnt(0)
    v_mul_f32 v236, v236, v136
    v_mul_f32 v237, v237, v136
    v_mul_f32 v238, v238, v136
    v_mul_f32 v239, v239, v136
    v_mul_f32 v240, v240, v136
    v_mul_f32 v241, v241, v136
    v_mul_f32 v242, v242, v136
    v_mul_f32 v243, v243, v136
    v_mul_f32 v244, v244, v136
    v_mul_f32 v245, v245, v136
    v_mul_f32 v246, v246, v136
    v_mul_f32 v247, v247, v136
    v_mul_f32 v248, v248, v136
    v_mul_f32 v249, v249, v136
    v_mul_f32 v250, v250, v136
    v_mul_f32 v251, v251, v136
    v_mul_f32 v252, v252, v136
    v_mul_f32 v253, v253, v136
    v_mul_f32 v254, v254, v136
    v_mul_f32 v255, v255, v136
    s_barrier
    ds_read_b128 v[188:191], v2 offset:20480
    ds_read_b64_tr_b16 v[192:193], v4 offset:20480
    ds_read_b64_tr_b16 v[194:195], v4 offset:20736
    v_mfma_f32_16x16x32_bf16 v[236:239], v[144:147], v[140:143], v[236:239]
    ds_read_b64_tr_b16 v[196:197], v4 offset:22528
    ds_read_b64_tr_b16 v[198:199], v4 offset:22784
    ds_read_b64_tr_b16 v[200:201], v4 offset:24576
    v_mfma_f32_16x16x32_bf16 v[240:243], v[148:151], v[140:143], v[240:243]
    ds_read_b64_tr_b16 v[202:203], v4 offset:24832
    ds_read_b64_tr_b16 v[204:205], v4 offset:26624
    ds_read_b64_tr_b16 v[206:207], v4 offset:26880
    v_mfma_f32_16x16x32_bf16 v[244:247], v[152:155], v[140:143], v[244:247]
    ds_read_b64_tr_b16 v[208:209], v4 offset:28672
    ds_read_b64_tr_b16 v[210:211], v4 offset:28928
    ds_read_b128 v[212:215], v3 offset:20480
    v_mfma_f32_16x16x32_bf16 v[248:251], v[156:159], v[140:143], v[248:251]
    ds_read_b64_tr_b16 v[216:217], v4 offset:21504
    ds_read_b64_tr_b16 v[218:219], v4 offset:21760
    ds_read_b64_tr_b16 v[220:221], v4 offset:23552
    v_mfma_f32_16x16x32_bf16 v[252:255], v[160:163], v[140:143], v[252:255]
    ds_read_b64_tr_b16 v[222:223], v4 offset:23808
    ds_read_b64_tr_b16 v[224:225], v4 offset:25600
    ds_read_b64_tr_b16 v[226:227], v4 offset:25856
    v_mfma_f32_16x16x32_bf16 v[236:239], v[168:171], v[164:167], v[236:239]
    ds_read_b64_tr_b16 v[228:229], v4 offset:27648
    ds_read_b64_tr_b16 v[230:231], v4 offset:27904
    ds_read_b64_tr_b16 v[232:233], v4 offset:29696
    v_mfma_f32_16x16x32_bf16 v[240:243], v[172:175], v[164:167], v[240:243]
    ds_read_b64_tr_b16 v[234:235], v4 offset:29952
    v_mfma_f32_16x16x32_bf16 v[244:247], v[176:179], v[164:167], v[244:247]
    v_mfma_f32_16x16x32_bf16 v[248:251], v[180:183], v[164:167], v[248:251]
    v_mfma_f32_16x16x32_bf16 v[252:255], v[184:187], v[164:167], v[252:255]
    s_waitcnt lgkmcnt(0)
    s_barrier
    ds_read_b128 v[140:143], v2 offset:40960
    ds_read_b64_tr_b16 v[144:145], v4 offset:40960
    ds_read_b64_tr_b16 v[146:147], v4 offset:41216
    v_mfma_f32_16x16x32_bf16 v[236:239], v[192:195], v[188:191], v[236:239]
    ds_read_b64_tr_b16 v[148:149], v4 offset:43008
    ds_read_b64_tr_b16 v[150:151], v4 offset:43264
    ds_read_b64_tr_b16 v[152:153], v4 offset:45056
    v_mfma_f32_16x16x32_bf16 v[240:243], v[196:199], v[188:191], v[240:243]
    ds_read_b64_tr_b16 v[154:155], v4 offset:45312
    ds_read_b64_tr_b16 v[156:157], v4 offset:47104
    ds_read_b64_tr_b16 v[158:159], v4 offset:47360
    v_mfma_f32_16x16x32_bf16 v[244:247], v[200:203], v[188:191], v[244:247]
    ds_read_b64_tr_b16 v[160:161], v4 offset:49152
    ds_read_b64_tr_b16 v[162:163], v4 offset:49408
    ds_read_b128 v[164:167], v3 offset:40960
    v_mfma_f32_16x16x32_bf16 v[248:251], v[204:207], v[188:191], v[248:251]
    ds_read_b64_tr_b16 v[168:169], v4 offset:41984
    ds_read_b64_tr_b16 v[170:171], v4 offset:42240
    ds_read_b64_tr_b16 v[172:173], v4 offset:44032
    v_mfma_f32_16x16x32_bf16 v[252:255], v[208:211], v[188:191], v[252:255]
    ds_read_b64_tr_b16 v[174:175], v4 offset:44288
    ds_read_b64_tr_b16 v[176:177], v4 offset:46080
    ds_read_b64_tr_b16 v[178:179], v4 offset:46336
    v_mfma_f32_16x16x32_bf16 v[236:239], v[216:219], v[212:215], v[236:239]
    ds_read_b64_tr_b16 v[180:181], v4 offset:48128
    ds_read_b64_tr_b16 v[182:183], v4 offset:48384
    ds_read_b64_tr_b16 v[184:185], v4 offset:50176
    v_mfma_f32_16x16x32_bf16 v[240:243], v[220:223], v[212:215], v[240:243]
    ds_read_b64_tr_b16 v[186:187], v4 offset:50432
    v_mfma_f32_16x16x32_bf16 v[244:247], v[224:227], v[212:215], v[244:247]
    v_mfma_f32_16x16x32_bf16 v[248:251], v[228:231], v[212:215], v[248:251]
    v_mfma_f32_16x16x32_bf16 v[252:255], v[232:235], v[212:215], v[252:255]
    s_waitcnt lgkmcnt(0)
    s_barrier
    ds_read_b128 v[188:191], v5 offset:0
    ds_read_b64_tr_b16 v[192:193], v7 offset:0
    ds_read_b64_tr_b16 v[194:195], v7 offset:256
    v_mfma_f32_16x16x32_bf16 v[236:239], v[144:147], v[140:143], v[236:239]
    ds_read_b64_tr_b16 v[196:197], v7 offset:2048
    ds_read_b64_tr_b16 v[198:199], v7 offset:2304
    ds_read_b64_tr_b16 v[200:201], v7 offset:4096
    v_mfma_f32_16x16x32_bf16 v[240:243], v[148:151], v[140:143], v[240:243]
    ds_read_b64_tr_b16 v[202:203], v7 offset:4352
    ds_read_b64_tr_b16 v[204:205], v7 offset:6144
    ds_read_b64_tr_b16 v[206:207], v7 offset:6400
    v_mfma_f32_16x16x32_bf16 v[244:247], v[152:155], v[140:143], v[244:247]
    ds_read_b64_tr_b16 v[208:209], v7 offset:8192
    ds_read_b64_tr_b16 v[210:211], v7 offset:8448
    ds_read_b128 v[212:215], v6 offset:0
    v_mfma_f32_16x16x32_bf16 v[248:251], v[156:159], v[140:143], v[248:251]
    ds_read_b64_tr_b16 v[216:217], v7 offset:1024
    ds_read_b64_tr_b16 v[218:219], v7 offset:1280
    ds_read_b64_tr_b16 v[220:221], v7 offset:3072
    v_mfma_f32_16x16x32_bf16 v[252:255], v[160:163], v[140:143], v[252:255]
    ds_read_b64_tr_b16 v[222:223], v7 offset:3328
    ds_read_b64_tr_b16 v[224:225], v7 offset:5120
    ds_read_b64_tr_b16 v[226:227], v7 offset:5376
    v_mfma_f32_16x16x32_bf16 v[236:239], v[168:171], v[164:167], v[236:239]
    ds_read_b64_tr_b16 v[228:229], v7 offset:7168
    ds_read_b64_tr_b16 v[230:231], v7 offset:7424
    ds_read_b64_tr_b16 v[232:233], v7 offset:9216
    v_mfma_f32_16x16x32_bf16 v[240:243], v[172:175], v[164:167], v[240:243]
    ds_read_b64_tr_b16 v[234:235], v7 offset:9472
    v_mfma_f32_16x16x32_bf16 v[244:247], v[176:179], v[164:167], v[244:247]
    v_mfma_f32_16x16x32_bf16 v[248:251], v[180:183], v[164:167], v[248:251]
    v_mfma_f32_16x16x32_bf16 v[252:255], v[184:187], v[164:167], v[252:255]
    s_waitcnt lgkmcnt(0)
    s_barrier
    ds_read_b128 v[140:143], v5 offset:20480
    ds_read_b64_tr_b16 v[144:145], v7 offset:20480
    ds_read_b64_tr_b16 v[146:147], v7 offset:20736
    v_mfma_f32_16x16x32_bf16 v[236:239], v[192:195], v[188:191], v[236:239]
    ds_read_b64_tr_b16 v[148:149], v7 offset:22528
    ds_read_b64_tr_b16 v[150:151], v7 offset:22784
    ds_read_b64_tr_b16 v[152:153], v7 offset:24576
    v_mfma_f32_16x16x32_bf16 v[240:243], v[196:199], v[188:191], v[240:243]
    ds_read_b64_tr_b16 v[154:155], v7 offset:24832
    ds_read_b64_tr_b16 v[156:157], v7 offset:26624
    ds_read_b64_tr_b16 v[158:159], v7 offset:26880
    v_mfma_f32_16x16x32_bf16 v[244:247], v[200:203], v[188:191], v[244:247]
    ds_read_b64_tr_b16 v[160:161], v7 offset:28672
    ds_read_b64_tr_b16 v[162:163], v7 offset:28928
    ds_read_b128 v[164:167], v6 offset:20480
    v_mfma_f32_16x16x32_bf16 v[248:251], v[204:207], v[188:191], v[248:251]
    ds_read_b64_tr_b16 v[168:169], v7 offset:21504
    ds_read_b64_tr_b16 v[170:171], v7 offset:21760
    ds_read_b64_tr_b16 v[172:173], v7 offset:23552
    v_mfma_f32_16x16x32_bf16 v[252:255], v[208:211], v[188:191], v[252:255]
    ds_read_b64_tr_b16 v[174:175], v7 offset:23808
    ds_read_b64_tr_b16 v[176:177], v7 offset:25600
    ds_read_b64_tr_b16 v[178:179], v7 offset:25856
    v_mfma_f32_16x16x32_bf16 v[236:239], v[216:219], v[212:215], v[236:239]
    ds_read_b64_tr_b16 v[180:181], v7 offset:27648
    ds_read_b64_tr_b16 v[182:183], v7 offset:27904
    ds_read_b64_tr_b16 v[184:185], v7 offset:29696
    v_mfma_f32_16x16x32_bf16 v[240:243], v[220:223], v[212:215], v[240:243]
    ds_read_b64_tr_b16 v[186:187], v7 offset:29952
    v_mfma_f32_16x16x32_bf16 v[244:247], v[224:227], v[212:215], v[244:247]
    v_mfma_f32_16x16x32_bf16 v[248:251], v[228:231], v[212:215], v[248:251]
    v_mfma_f32_16x16x32_bf16 v[252:255], v[232:235], v[212:215], v[252:255]
    s_waitcnt lgkmcnt(0)
    s_barrier
    ds_read_b128 v[188:191], v5 offset:40960
    ds_read_b64_tr_b16 v[192:193], v7 offset:40960
    ds_read_b64_tr_b16 v[194:195], v7 offset:41216
    v_mfma_f32_16x16x32_bf16 v[236:239], v[144:147], v[140:143], v[236:239]
    ds_read_b64_tr_b16 v[196:197], v7 offset:43008
    ds_read_b64_tr_b16 v[198:199], v7 offset:43264
    ds_read_b64_tr_b16 v[200:201], v7 offset:45056
    v_mfma_f32_16x16x32_bf16 v[240:243], v[148:151], v[140:143], v[240:243]
    ds_read_b64_tr_b16 v[202:203], v7 offset:45312
    ds_read_b64_tr_b16 v[204:205], v7 offset:47104
    ds_read_b64_tr_b16 v[206:207], v7 offset:47360
    v_mfma_f32_16x16x32_bf16 v[244:247], v[152:155], v[140:143], v[244:247]
    ds_read_b64_tr_b16 v[208:209], v7 offset:49152
    ds_read_b64_tr_b16 v[210:211], v7 offset:49408
    ds_read_b128 v[212:215], v6 offset:40960
    v_mfma_f32_16x16x32_bf16 v[248:251], v[156:159], v[140:143], v[248:251]
    ds_read_b64_tr_b16 v[216:217], v7 offset:41984
    ds_read_b64_tr_b16 v[218:219], v7 offset:42240
    ds_read_b64_tr_b16 v[220:221], v7 offset:44032
    v_mfma_f32_16x16x32_bf16 v[252:255], v[160:163], v[140:143], v[252:255]
    ds_read_b64_tr_b16 v[222:223], v7 offset:44288
    ds_read_b64_tr_b16 v[224:225], v7 offset:46080
    ds_read_b64_tr_b16 v[226:227], v7 offset:46336
    v_mfma_f32_16x16x32_bf16 v[236:239], v[168:171], v[164:167], v[236:239]
    ds_read_b64_tr_b16 v[228:229], v7 offset:48128
    ds_read_b64_tr_b16 v[230:231], v7 offset:48384
    ds_read_b64_tr_b16 v[232:233], v7 offset:50176
    v_mfma_f32_16x16x32_bf16 v[240:243], v[172:175], v[164:167], v[240:243]
    ds_read_b64_tr_b16 v[234:235], v7 offset:50432
    v_mfma_f32_16x16x32_bf16 v[244:247], v[176:179], v[164:167], v[244:247]
    v_mfma_f32_16x16x32_bf16 v[248:251], v[180:183], v[164:167], v[248:251]
    v_mfma_f32_16x16x32_bf16 v[252:255], v[184:187], v[164:167], v[252:255]
    s_waitcnt lgkmcnt(0)
    s_barrier
    ds_read_b128 v[140:143], v2 offset:0
    ds_read_b64_tr_b16 v[144:145], v4 offset:0
    ds_read_b64_tr_b16 v[146:147], v4 offset:256
    v_mfma_f32_16x16x32_bf16 v[236:239], v[192:195], v[188:191], v[236:239]
    ds_read_b64_tr_b16 v[148:149], v4 offset:2048
    ds_read_b64_tr_b16 v[150:151], v4 offset:2304
    ds_read_b64_tr_b16 v[152:153], v4 offset:4096
    v_mfma_f32_16x16x32_bf16 v[240:243], v[196:199], v[188:191], v[240:243]
    ds_read_b64_tr_b16 v[154:155], v4 offset:4352
    ds_read_b64_tr_b16 v[156:157], v4 offset:6144
    ds_read_b64_tr_b16 v[158:159], v4 offset:6400
    v_mfma_f32_16x16x32_bf16 v[244:247], v[200:203], v[188:191], v[244:247]
    ds_read_b64_tr_b16 v[160:161], v4 offset:8192
    ds_read_b64_tr_b16 v[162:163], v4 offset:8448
    ds_read_b128 v[164:167], v3 offset:0
    v_mfma_f32_16x16x32_bf16 v[248:251], v[204:207], v[188:191], v[248:251]
    ds_read_b64_tr_b16 v[168:169], v4 offset:1024
    ds_read_b64_tr_b16 v[170:171], v4 offset:1280
    ds_read_b64_tr_b16 v[172:173], v4 offset:3072
    v_mfma_f32_16x16x32_bf16 v[252:255], v[208:211], v[188:191], v[252:255]
    ds_read_b64_tr_b16 v[174:175], v4 offset:3328
    ds_read_b64_tr_b16 v[176:177], v4 offset:5120
    ds_read_b64_tr_b16 v[178:179], v4 offset:5376
    v_mfma_f32_16x16x32_bf16 v[236:239], v[216:219], v[212:215], v[236:239]
    ds_read_b64_tr_b16 v[180:181], v4 offset:7168
    ds_read_b64_tr_b16 v[182:183], v4 offset:7424
    ds_read_b64_tr_b16 v[184:185], v4 offset:9216
    v_mfma_f32_16x16x32_bf16 v[240:243], v[220:223], v[212:215], v[240:243]
    ds_read_b64_tr_b16 v[186:187], v4 offset:9472
    v_mfma_f32_16x16x32_bf16 v[244:247], v[224:227], v[212:215], v[244:247]
    v_mfma_f32_16x16x32_bf16 v[248:251], v[228:231], v[212:215], v[248:251]
    v_mfma_f32_16x16x32_bf16 v[252:255], v[232:235], v[212:215], v[252:255]
    s_waitcnt lgkmcnt(0)
    s_barrier
    ds_read_b128 v[188:191], v2 offset:20480
    ds_read_b64_tr_b16 v[192:193], v4 offset:20480
    ds_read_b64_tr_b16 v[194:195], v4 offset:20736
    v_mfma_f32_16x16x32_bf16 v[236:239], v[144:147], v[140:143], v[236:239]
    ds_read_b64_tr_b16 v[196:197], v4 offset:22528
    ds_read_b64_tr_b16 v[198:199], v4 offset:22784
    ds_read_b64_tr_b16 v[200:201], v4 offset:24576
    v_mfma_f32_16x16x32_bf16 v[240:243], v[148:151], v[140:143], v[240:243]
    ds_read_b64_tr_b16 v[202:203], v4 offset:24832
    ds_read_b64_tr_b16 v[204:205], v4 offset:26624
    ds_read_b64_tr_b16 v[206:207], v4 offset:26880
    v_mfma_f32_16x16x32_bf16 v[244:247], v[152:155], v[140:143], v[244:247]
    ds_read_b64_tr_b16 v[208:209], v4 offset:28672
    ds_read_b64_tr_b16 v[210:211], v4 offset:28928
    ds_read_b128 v[212:215], v3 offset:20480
    v_mfma_f32_16x16x32_bf16 v[248:251], v[156:159], v[140:143], v[248:251]
    ds_read_b64_tr_b16 v[216:217], v4 offset:21504
    ds_read_b64_tr_b16 v[218:219], v4 offset:21760
    ds_read_b64_tr_b16 v[220:221], v4 offset:23552
    v_mfma_f32_16x16x32_bf16 v[252:255], v[160:163], v[140:143], v[252:255]
    ds_read_b64_tr_b16 v[222:223], v4 offset:23808
    ds_read_b64_tr_b16 v[224:225], v4 offset:25600
    ds_read_b64_tr_b16 v[226:227], v4 offset:25856
    v_mfma_f32_16x16x32_bf16 v[236:239], v[168:171], v[164:167], v[236:239]
    ds_read_b64_tr_b16 v[228:229], v4 offset:27648
    ds_read_b64_tr_b16 v[230:231], v4 offset:27904
    ds_read_b64_tr_b16 v[232:233], v4 offset:29696
    v_mfma_f32_16x16x32_bf16 v[240:243], v[172:175], v[164:167], v[240:243]
    ds_read_b64_tr_b16 v[234:235], v4 offset:29952
    v_mfma_f32_16x16x32_bf16 v[244:247], v[176:179], v[164:167], v[244:247]
    v_mfma_f32_16x16x32_bf16 v[248:251], v[180:183], v[164:167], v[248:251]
    v_mfma_f32_16x16x32_bf16 v[252:255], v[184:187], v[164:167], v[252:255]
    s_waitcnt lgkmcnt(0)
    s_barrier
    ds_read_b128 v[140:143], v2 offset:40960
    ds_read_b64_tr_b16 v[144:145], v4 offset:40960
    ds_read_b64_tr_b16 v[146:147], v4 offset:41216
    v_mfma_f32_16x16x32_bf16 v[236:239], v[192:195], v[188:191], v[236:239]
    ds_read_b64_tr_b16 v[148:149], v4 offset:43008
    ds_read_b64_tr_b16 v[150:151], v4 offset:43264
    ds_read_b64_tr_b16 v[152:153], v4 offset:45056
    v_mfma_f32_16x16x32_bf16 v[240:243], v[196:199], v[188:191], v[240:243]
    ds_read_b64_tr_b16 v[154:155], v4 offset:45312
    ds_read_b64_tr_b16 v[156:157], v4 offset:47104
    ds_read_b64_tr_b16 v[158:159], v4 offset:47360
    v_mfma_f32_16x16x32_bf16 v[244:247], v[200:203], v[188:191], v[244:247]
    ds_read_b64_tr_b16 v[160:161], v4 offset:49152
    ds_read_b64_tr_b16 v[162:163], v4 offset:49408
    ds_read_b128 v[164:167], v3 offset:40960
    v_mfma_f32_16x16x32_bf16 v[248:251], v[204:207], v[188:191], v[248:251]
    ds_read_b64_tr_b16 v[168:169], v4 offset:41984
    ds_read_b64_tr_b16 v[170:171], v4 offset:42240
    ds_read_b64_tr_b16 v[172:173], v4 offset:44032
    v_mfma_f32_16x16x32_bf16 v[252:255], v[208:211], v[188:191], v[252:255]
    ds_read_b64_tr_b16 v[174:175], v4 offset:44288
    ds_read_b64_tr_b16 v[176:177], v4 offset:46080
    ds_read_b64_tr_b16 v[178:179], v4 offset:46336
    v_mfma_f32_16x16x32_bf16 v[236:239], v[216:219], v[212:215], v[236:239]
    ds_read_b64_tr_b16 v[180:181], v4 offset:48128
    ds_read_b64_tr_b16 v[182:183], v4 offset:48384
    ds_read_b64_tr_b16 v[184:185], v4 offset:50176
    v_mfma_f32_16x16x32_bf16 v[240:243], v[220:223], v[212:215], v[240:243]
    ds_read_b64_tr_b16 v[186:187], v4 offset:50432
    v_mfma_f32_16x16x32_bf16 v[244:247], v[224:227], v[212:215], v[244:247]
    v_mfma_f32_16x16x32_bf16 v[248:251], v[228:231], v[212:215], v[248:251]
    v_mfma_f32_16x16x32_bf16 v[252:255], v[232:235], v[212:215], v[252:255]
    s_waitcnt lgkmcnt(0)
    s_barrier
    ds_read_b128 v[188:191], v5 offset:0
    ds_read_b64_tr_b16 v[192:193], v7 offset:0
    ds_read_b64_tr_b16 v[194:195], v7 offset:256
    v_mfma_f32_16x16x32_bf16 v[236:239], v[144:147], v[140:143], v[236:239]
    ds_read_b64_tr_b16 v[196:197], v7 offset:2048
    ds_read_b64_tr_b16 v[198:199], v7 offset:2304
    ds_read_b64_tr_b16 v[200:201], v7 offset:4096
    v_mfma_f32_16x16x32_bf16 v[240:243], v[148:151], v[140:143], v[240:243]
    ds_read_b64_tr_b16 v[202:203], v7 offset:4352
    ds_read_b64_tr_b16 v[204:205], v7 offset:6144
    ds_read_b64_tr_b16 v[206:207], v7 offset:6400
    v_mfma_f32_16x16x32_bf16 v[244:247], v[152:155], v[140:143], v[244:247]
    ds_read_b64_tr_b16 v[208:209], v7 offset:8192
    ds_read_b64_tr_b16 v[210:211], v7 offset:8448
    ds_read_b128 v[212:215], v6 offset:0
    v_mfma_f32_16x16x32_bf16 v[248:251], v[156:159], v[140:143], v[248:251]
    ds_read_b64_tr_b16 v[216:217], v7 offset:1024
    ds_read_b64_tr_b16 v[218:219], v7 offset:1280
    ds_read_b64_tr_b16 v[220:221], v7 offset:3072
    v_mfma_f32_16x16x32_bf16 v[252:255], v[160:163], v[140:143], v[252:255]
    ds_read_b64_tr_b16 v[222:223], v7 offset:3328
    ds_read_b64_tr_b16 v[224:225], v7 offset:5120
    ds_read_b64_tr_b16 v[226:227], v7 offset:5376
    v_mfma_f32_16x16x32_bf16 v[236:239], v[168:171], v[164:167], v[236:239]
    ds_read_b64_tr_b16 v[228:229], v7 offset:7168
    ds_read_b64_tr_b16 v[230:231], v7 offset:7424
    ds_read_b64_tr_b16 v[232:233], v7 offset:9216
    v_mfma_f32_16x16x32_bf16 v[240:243], v[172:175], v[164:167], v[240:243]
    ds_read_b64_tr_b16 v[234:235], v7 offset:9472
    v_mfma_f32_16x16x32_bf16 v[244:247], v[176:179], v[164:167], v[244:247]
    v_mfma_f32_16x16x32_bf16 v[248:251], v[180:183], v[164:167], v[248:251]
    v_mfma_f32_16x16x32_bf16 v[252:255], v[184:187], v[164:167], v[252:255]
    s_waitcnt lgkmcnt(0)
    s_barrier
    ds_read_b128 v[140:143], v5 offset:20480
    ds_read_b64_tr_b16 v[144:145], v7 offset:20480
    ds_read_b64_tr_b16 v[146:147], v7 offset:20736
    v_mfma_f32_16x16x32_bf16 v[236:239], v[192:195], v[188:191], v[236:239]
    ds_read_b64_tr_b16 v[148:149], v7 offset:22528
    ds_read_b64_tr_b16 v[150:151], v7 offset:22784
    ds_read_b64_tr_b16 v[152:153], v7 offset:24576
    v_mfma_f32_16x16x32_bf16 v[240:243], v[196:199], v[188:191], v[240:243]
    ds_read_b64_tr_b16 v[154:155], v7 offset:24832
    ds_read_b64_tr_b16 v[156:157], v7 offset:26624
    ds_read_b64_tr_b16 v[158:159], v7 offset:26880
    v_mfma_f32_16x16x32_bf16 v[244:247], v[200:203], v[188:191], v[244:247]
    ds_read_b64_tr_b16 v[160:161], v7 offset:28672
    ds_read_b64_tr_b16 v[162:163], v7 offset:28928
    ds_read_b128 v[164:167], v6 offset:20480
    v_mfma_f32_16x16x32_bf16 v[248:251], v[204:207], v[188:191], v[248:251]
    ds_read_b64_tr_b16 v[168:169], v7 offset:21504
    ds_read_b64_tr_b16 v[170:171], v7 offset:21760
    ds_read_b64_tr_b16 v[172:173], v7 offset:23552
    v_mfma_f32_16x16x32_bf16 v[252:255], v[208:211], v[188:191], v[252:255]
    ds_read_b64_tr_b16 v[174:175], v7 offset:23808
    ds_read_b64_tr_b16 v[176:177], v7 offset:25600
    ds_read_b64_tr_b16 v[178:179], v7 offset:25856
    v_mfma_f32_16x16x32_bf16 v[236:239], v[216:219], v[212:215], v[236:239]
    ds_read_b64_tr_b16 v[180:181], v7 offset:27648
    ds_read_b64_tr_b16 v[182:183], v7 offset:27904
    ds_read_b64_tr_b16 v[184:185], v7 offset:29696
    v_mfma_f32_16x16x32_bf16 v[240:243], v[220:223], v[212:215], v[240:243]
    ds_read_b64_tr_b16 v[186:187], v7 offset:29952
    v_mfma_f32_16x16x32_bf16 v[244:247], v[224:227], v[212:215], v[244:247]
    v_mfma_f32_16x16x32_bf16 v[248:251], v[228:231], v[212:215], v[248:251]
    v_mfma_f32_16x16x32_bf16 v[252:255], v[232:235], v[212:215], v[252:255]
    s_waitcnt lgkmcnt(0)
    s_barrier
    ds_read_b128 v[188:191], v5 offset:40960
    ds_read_b64_tr_b16 v[192:193], v7 offset:40960
    ds_read_b64_tr_b16 v[194:195], v7 offset:41216
    v_mfma_f32_16x16x32_bf16 v[236:239], v[144:147], v[140:143], v[236:239]
    ds_read_b64_tr_b16 v[196:197], v7 offset:43008
    ds_read_b64_tr_b16 v[198:199], v7 offset:43264
    ds_read_b64_tr_b16 v[200:201], v7 offset:45056
    v_mfma_f32_16x16x32_bf16 v[240:243], v[148:151], v[140:143], v[240:243]
    ds_read_b64_tr_b16 v[202:203], v7 offset:45312
    ds_read_b64_tr_b16 v[204:205], v7 offset:47104
    ds_read_b64_tr_b16 v[206:207], v7 offset:47360
    v_mfma_f32_16x16x32_bf16 v[244:247], v[152:155], v[140:143], v[244:247]
    ds_read_b64_tr_b16 v[208:209], v7 offset:49152
    ds_read_b64_tr_b16 v[210:211], v7 offset:49408
    ds_read_b128 v[212:215], v6 offset:40960
    v_mfma_f32_16x16x32_bf16 v[248:251], v[156:159], v[140:143], v[248:251]
    ds_read_b64_tr_b16 v[216:217], v7 offset:41984
    ds_read_b64_tr_b16 v[218:219], v7 offset:42240
    ds_read_b64_tr_b16 v[220:221], v7 offset:44032
    v_mfma_f32_16x16x32_bf16 v[252:255], v[160:163], v[140:143], v[252:255]
    ds_read_b64_tr_b16 v[222:223], v7 offset:44288
    ds_read_b64_tr_b16 v[224:225], v7 offset:46080
    ds_read_b64_tr_b16 v[226:227], v7 offset:46336
    v_mfma_f32_16x16x32_bf16 v[236:239], v[168:171], v[164:167], v[236:239]
    ds_read_b64_tr_b16 v[228:229], v7 offset:48128
    ds_read_b64_tr_b16 v[230:231], v7 offset:48384
    ds_read_b64_tr_b16 v[232:233], v7 offset:50176
    v_mfma_f32_16x16x32_bf16 v[240:243], v[172:175], v[164:167], v[240:243]
    ds_read_b64_tr_b16 v[234:235], v7 offset:50432
    v_mfma_f32_16x16x32_bf16 v[244:247], v[176:179], v[164:167], v[244:247]
    v_mfma_f32_16x16x32_bf16 v[248:251], v[180:183], v[164:167], v[248:251]
    v_mfma_f32_16x16x32_bf16 v[252:255], v[184:187], v[164:167], v[252:255]
    s_waitcnt lgkmcnt(0)
    s_barrier
    v_mfma_f32_16x16x32_bf16 v[236:239], v[192:195], v[188:191], v[236:239]
    v_mfma_f32_16x16x32_bf16 v[240:243], v[196:199], v[188:191], v[240:243]
    v_mfma_f32_16x16x32_bf16 v[244:247], v[200:203], v[188:191], v[244:247]
    v_mfma_f32_16x16x32_bf16 v[248:251], v[204:207], v[188:191], v[248:251]
    v_mfma_f32_16x16x32_bf16 v[252:255], v[208:211], v[188:191], v[252:255]
    v_mfma_f32_16x16x32_bf16 v[236:239], v[216:219], v[212:215], v[236:239]
    v_mfma_f32_16x16x32_bf16 v[240:243], v[220:223], v[212:215], v[240:243]
    v_mfma_f32_16x16x32_bf16 v[244:247], v[224:227], v[212:215], v[244:247]
    v_mfma_f32_16x16x32_bf16 v[248:251], v[228:231], v[212:215], v[248:251]
    v_mfma_f32_16x16x32_bf16 v[252:255], v[232:235], v[212:215], v[252:255]
    s_waitcnt lgkmcnt(0)
    s_mov_b32 s12, s36
    s_mov_b32 s13, s37
    s_mov_b32 s14, 2621440
    s_mov_b32 s15, 0x20000
    v_cvt_pk_bf16_f32 v8, v236, v237
    v_cvt_pk_bf16_f32 v9, v238, v239
    v_cvt_pk_bf16_f32 v10, v240, v241
    v_cvt_pk_bf16_f32 v11, v242, v243
    v_cvt_pk_bf16_f32 v12, v244, v245
    v_cvt_pk_bf16_f32 v13, v246, v247
    v_cvt_pk_bf16_f32 v14, v248, v249
    v_cvt_pk_bf16_f32 v15, v250, v251
    v_cvt_pk_bf16_f32 v16, v252, v253
    v_cvt_pk_bf16_f32 v17, v254, v255
    v_lshrrev_b32 v3, 4, v0
    s_mov_b32 s45, 1280
    v_mul_lo_u32 v4, v137, s45
    s_mul_i32 s46, s41, 160
    v_add_u32 v4, s46, v4
    v_and_b32 v5, 1, v3
    v_lshlrev_b32 v5, 5, v5
    v_lshrrev_b32 v6, 1, v3
    v_lshl_add_u32 v5, v6, 4, v5
    v_add_u32 v5, v5, v4
    v_lshl_add_u32 v4, v3, 3, v4
    v_permlane16_swap_b32 v8, v10
    v_permlane16_swap_b32 v9, v11
    v_permlane16_swap_b32 v12, v14
    v_permlane16_swap_b32 v13, v15
    buffer_store_dwordx4 v[8:11], v5, s[12:15], 0 offen offset:0
    buffer_store_dwordx4 v[12:15], v5, s[12:15], 0 offen offset:64
    buffer_store_dwordx2 v[16:17], v4, s[12:15], 0 offen offset:128
    s_or_b32 s20, s2, s16
    s_cmp_lg_u32 s20, 0
    s_cbranch_scc1 K34_end
    s_add_u32 s12, s32, 24641536
    s_addc_u32 s13, s33, 0
    s_mov_b32 s14, 1024
    s_mov_b32 s15, 0x20000
    v_lshlrev_b32 v14, 4, v0
    s_add_u32 s45, s98, 1
    s_mov_b32 s47, 0
K34_ep:
    buffer_load_dwordx4 v[16:19], v14, s[12:15], 0 offen sc1
    s_waitcnt vmcnt(0)
    v_xor_b32 v16, s45, v16
    v_xor_b32 v17, s99, v17
    v_xor_b32 v18, s45, v18
    v_xor_b32 v19, s99, v19
    v_or3_b32 v16, v16, v17, v18
    v_or_b32 v16, v16, v19
    v_cmp_ne_u32 vcc, 0, v16
    s_add_u32 s47, s47, 1
    s_nop 3
    s_cbranch_vccz K34_epok
    s_cmp_lt_u32 s47, 0x10000
    s_cbranch_scc1 K34_ep
K34_epok:
    s_add_u32 s12, s32, 24510464
    s_addc_u32 s13, s33, 0
    s_mov_b32 s14, 128
    s_mov_b32 s15, 0x20000
    v_mov_b32 v16, s45
    v_mov_b32 v17, s99
    v_mov_b32 v14, 0
    s_mov_b64 exec, 1
    buffer_store_dwordx2 v[16:17], v14, s[12:15], 0 offen sc1
K34_end:
    s_endpgm
.section .rodata,"a"
.p2align 6
.amdhsa_kernel gated_mix__sliding_local_dilated__mixer_gmlp__prompt_kernel
  .amdhsa_next_free_vgpr 256
  .amdhsa_next_free_sgpr 102
  .amdhsa_accum_offset 256
  .amdhsa_group_segment_fixed_size 0
  .amdhsa_kernarg_size 96
  .amdhsa_user_sgpr_count 2
  .amdhsa_user_sgpr_kernarg_segment_ptr 1
  .amdhsa_system_sgpr_workgroup_id_x 1
  .amdhsa_float_denorm_mode_32 3
  .amdhsa_float_denorm_mode_16_64 3
.end_amdhsa_kernel
```
